```python
import torch

def _softmax(x, axis=-1):
    return torch.softmax(x, dim=axis)

def _gelu(x):
    return torch.nn.functional.gelu(x, approximate='tanh')

def _silu(x):
    return torch.nn.functional.silu(x)

def _sigmoid(x):
    return torch.sigmoid(x)

def _layernorm(x, axis=-1, eps=1e-05):
    m = x.mean(dim=axis, keepdim=True)
    v = x.var(dim=axis, keepdim=True, unbiased=False)
    return (x - m) / torch.sqrt(v + eps)

def _scatter_add(tgt, idx, src, axis=0):
    return tgt.clone().index_add_(axis, idx, src)

def _segment_sum(src, seg, n):
    out = torch.zeros((n,) + src.shape[1:], dtype=src.dtype)
    return out.index_add_(0, seg, src)

def _pad(x, pw):
    flat = tuple((v for pair in reversed(pw) for v in pair))
    return torch.nn.functional.pad(x, flat)
kernel_name = 'adaLN_cond__ssm_conv_h3__mixer_gmlp__prompt'

def setup_inputs():

    _w = lambda a: (lambda t: t.to(torch.bfloat16) if t.is_floating_point() else t)(torch.as_tensor(a))

    def _A_setup():
        B, S, D = (1, 2048, 448)
        ks = 4
        return {'q': _w((lambda *s: torch.randn(*s, dtype=torch.bfloat16) * 0.05)(B, S, D)), 'k': _w((lambda *s: torch.randn(*s, dtype=torch.bfloat16) * 1.6)(B, S, D)), 'v': _w((lambda *s: torch.randn(*s, dtype=torch.bfloat16) * 1.6)(B, S, D)), 'shift_k': _w((lambda *s: torch.randn(*s, dtype=torch.bfloat16) * 1.6)(D, ks) * 0.5), 'ssm_k': _w((lambda *s: torch.randn(*s, dtype=torch.bfloat16) * 1.6)(D, S) * (1.0 / S ** 0.5)), 'ssm_D': _w((lambda *s: torch.randn(*s, dtype=torch.bfloat16) * 1.6)(D))}
    _A_in = _A_setup()

    def _B_setup():
        B, S, D, F = (1, 2048, 448, 1792)
        Fh = F // 2
        return {'x': _w((lambda *s: torch.randn(*s, dtype=torch.bfloat16) * 0.05)(B, S, D)), 'w_in': _w((lambda *s: torch.randn(*s, dtype=torch.bfloat16) * 0.8)(D, 2 * Fh)), 'w_sp': _w(0.01 * (lambda *s: torch.randn(*s, dtype=torch.bfloat16) * 0.8)(S, S)), 'b_sp': _w(1.0 + 0.01 * (lambda *s: torch.randn(*s, dtype=torch.bfloat16) * 0.1)(S)), 'w_out': _w((lambda *s: torch.randn(*s, dtype=torch.bfloat16) * 0.1)(Fh, D))}
    _B_in = _B_setup()
    return {'A_q': _A_in['q'], 'A_k': _A_in['k'], 'A_v': _A_in['v'], 'A_shift_k': _A_in['shift_k'], 'A_ssm_k': _A_in['ssm_k'], 'A_ssm_D': _A_in['ssm_D'], 'B_x': _B_in['x'], 'B_w_in': _B_in['w_in'], 'B_w_sp': _B_in['w_sp'], 'B_b_sp': _B_in['b_sp'], 'B_w_out': _B_in['w_out'], 'c': _w((lambda *s: torch.randn(*s, dtype=torch.bfloat16) * 0.1)(1, 448) * 8.0), 'w_mod': _w((lambda *s: torch.randn(*s, dtype=torch.bfloat16) * 0.1)(448, 6 * 448) * 448 ** (-0.5) * 8.0)}

def reference(A_q, A_k, A_v, A_shift_k, A_ssm_k, A_ssm_D, B_x, B_w_in, B_w_sp, B_b_sp, B_w_out, c, w_mod):

    def _A_ref(q, k, v, shift_k, ssm_k, ssm_D):
        B, S, D = q.shape
        ks = shift_k.shape[-1]
        k_pad = _pad(k, ((0, 0), (ks - 1, 0), (0, 0)))
        k_shift = torch.zeros_like(k)
        for t in range(ks):
            k_shift = k_shift + k_pad[:, t:t + S, :] * shift_k[:, ks - 1 - t][None, None, :]
        kv = k_shift * v
        L = 2 * S
        kv_pad = _pad(kv, ((0, 0), (0, S), (0, 0)))
        kf_pad = _pad(ssm_k, ((0, 0), (0, S)))
        kv_f = (lambda x, axes=(-2, -1): torch.fft.rfft2(x.float(), dim=axes))(kv_pad[:, None, :, :], axes=(1, 2))
        kf_f = (lambda x, axes=(-2, -1): torch.fft.rfft2(x.float(), dim=axes))(kf_pad[:, None, :], axes=(1, 2))
        kf_f = (lambda x, *d: x.permute(*d))(kf_f, 1, 2, 0)
        y_f = kv_f * kf_f[None, :, :, :]
        y = (lambda x, s, axes=(-2, -1): torch.fft.irfft2(x, s=s, dim=axes).to(torch.bfloat16))(y_f, (1, L), axes=(1, 2))[:, 0, :S, :]
        y = y + kv * ssm_D[None, None, :]
        return q * y

    def _B_ref(x, w_in, w_sp, b_sp, w_out):
        B, S, D = x.shape
        F = w_in.shape[-1]
        Fh = F // 2
        z = _gelu(torch.einsum('bsd,df->bsf', x, w_in))
        z1 = z[..., :Fh].clone()
        z2 = _layernorm(z[..., Fh:], axis=-1)
        g = torch.einsum('ts,bsf->btf', w_sp, z2) + b_sp[None, :, None]
        return torch.einsum('bsf,fd->bsd', z1 * g, w_out)
    x = A_q
    mod = (_silu(c) @ w_mod).reshape(c.shape[0], 6, 1, -1)
    sa, ca, ga, sb, cb, gb = (mod[:, 0].clone(), mod[:, 1].clone(), mod[:, 2].clone(), mod[:, 3].clone(), mod[:, 4].clone(), mod[:, 5].clone())
    h = _layernorm(x, axis=-1) * (1 + ca) + sa
    x = x + ga * _A_ref(h, A_k, A_v, A_shift_k, A_ssm_k, A_ssm_D)
    h = _layernorm(x, axis=-1) * (1 + cb) + sb
    x = x + gb * _B_ref(h, B_w_in, B_w_sp, B_b_sp, B_w_out)
    return x
```

```asm
; @launch kernel=k1_conv_kernel grid=(539,1,1) block=(256,1,1) lds=86016
; @launch kernel=k2_gemm1_kernel grid=(256,1,1) block=(256,1,1) lds=105984
; @launch kernel=k3_gemm2_kernel grid=(224,1,1) block=(256,1,1) lds=71680
; @launch kernel=k4_gemm3_kernel grid=(224,1,1) block=(256,1,1) lds=36864
.amdgcn_target "amdgcn-amd-amdhsa--gfx950"
.text
.globl k1_conv_kernel
.p2align 8
.type k1_conv_kernel,@function
k1_conv_kernel:
    s_cmp_ge_u32 s2, 539
    s_cbranch_scc1 K1_END
    s_cmp_ge_u32 s2, 245
    s_cbranch_scc1 K1_TRANS
    s_cmp_ge_u32 s2, 224
    s_cbranch_scc1 K1_MOD
    s_load_dwordx4 s[4:7], s[0:1], 8
    s_load_dwordx4 s[8:11], s[0:1], 24
    s_load_dwordx2 s[12:13], s[0:1], 40
    s_load_dwordx2 s[14:15], s[0:1], 120
    s_lshl_b32 s40, s2, 4
    s_lshl_b32 s41, s2, 2
    s_waitcnt lgkmcnt(0)
    s_load_dwordx4 s[32:35], s[8:9], s40
    s_load_dword s36, s[12:13], s41
    s_mov_b32 s16, s4
    s_and_b32 s17, s5, 0xffff
    s_mov_b32 s18, 1835008
    s_mov_b32 s19, 0x00020000
    s_mov_b32 s20, s6
    s_and_b32 s21, s7, 0xffff
    s_mov_b32 s22, 1835008
    s_mov_b32 s23, 0x00020000
    s_mov_b32 s24, s10
    s_and_b32 s25, s11, 0xffff
    s_mov_b32 s26, 1835008
    s_mov_b32 s27, 0x00020000
    s_mov_b32 s28, s14
    s_and_b32 s29, s15, 0xffff
    s_mov_b32 s30, 268435456
    s_mov_b32 s31, 0x00020000
    v_mul_u32_u24 v1, 7168, v0
    v_add_u32 v1, s41, v1
    s_mov_b32 s42, 0x7ffffff0
    v_add_u32 v2, 4294964608, v1
    v_cmp_gt_i32 vcc, 0, v2
    v_mov_b32 v3, s42
    v_cndmask_b32 v2, v2, v3, vcc
    buffer_load_dword v10, v2, s[16:19], 0 offen
    v_add_u32 v2, 4294965504, v1
    v_cmp_gt_i32 vcc, 0, v2
    v_mov_b32 v3, s42
    v_cndmask_b32 v2, v2, v3, vcc
    buffer_load_dword v11, v2, s[16:19], 0 offen
    v_add_u32 v2, 4294966400, v1
    v_cmp_gt_i32 vcc, 0, v2
    v_mov_b32 v3, s42
    v_cndmask_b32 v2, v2, v3, vcc
    buffer_load_dword v12, v2, s[16:19], 0 offen
    v_add_u32 v2, 0, v1
    buffer_load_dword v13, v2, s[16:19], 0 offen
    v_add_u32 v2, 896, v1
    buffer_load_dword v14, v2, s[16:19], 0 offen
    v_add_u32 v2, 1792, v1
    buffer_load_dword v15, v2, s[16:19], 0 offen
    v_add_u32 v2, 2688, v1
    buffer_load_dword v16, v2, s[16:19], 0 offen
    v_add_u32 v2, 3584, v1
    buffer_load_dword v17, v2, s[16:19], 0 offen
    v_add_u32 v2, 4480, v1
    buffer_load_dword v18, v2, s[16:19], 0 offen
    v_add_u32 v2, 5376, v1
    buffer_load_dword v19, v2, s[16:19], 0 offen
    v_add_u32 v2, 6272, v1
    buffer_load_dword v20, v2, s[16:19], 0 offen
    v_add_u32 v2, 0, v1
    buffer_load_dword v21, v2, s[20:23], 0 offen
    v_add_u32 v2, 896, v1
    buffer_load_dword v22, v2, s[20:23], 0 offen
    v_add_u32 v2, 1792, v1
    buffer_load_dword v23, v2, s[20:23], 0 offen
    v_add_u32 v2, 2688, v1
    buffer_load_dword v24, v2, s[20:23], 0 offen
    v_add_u32 v2, 3584, v1
    buffer_load_dword v25, v2, s[20:23], 0 offen
    v_add_u32 v2, 4480, v1
    buffer_load_dword v26, v2, s[20:23], 0 offen
    v_add_u32 v2, 5376, v1
    buffer_load_dword v27, v2, s[20:23], 0 offen
    v_add_u32 v2, 6272, v1
    buffer_load_dword v28, v2, s[20:23], 0 offen
    s_lshl_b32 s43, s2, 13
    v_lshlrev_b32 v4, 4, v0
    v_add_u32 v4, s43, v4
    v_subrev_u32 v5, 16, v4
    v_cmp_eq_u32 vcc, 0, v0
    v_mov_b32 v3, s42
    v_cndmask_b32 v5, v5, v3, vcc
    buffer_load_dwordx4 v[30:33], v5, s[24:27], 0 offen
    buffer_load_dwordx4 v[34:37], v4, s[24:27], 0 offen
    v_add_u32 v6, 4096, v4
    v_add_u32 v5, 4096, v5
    v_cndmask_b32 v5, v5, v3, vcc
    buffer_load_dwordx4 v[38:41], v5, s[24:27], 0 offen
    buffer_load_dwordx4 v[42:45], v6, s[24:27], 0 offen
    v_mov_b32 v46, 0
    v_mov_b32 v47, 0
    v_mov_b32 v48, 0
    v_mov_b32 v49, 0
    v_lshlrev_b32 v6, 4, v0
    v_cmp_gt_u32 vcc, 160, v0
    s_and_saveexec_b64 s[44:45], vcc
    v_add_u32 v7, 70656, v6
    ds_write_b128 v7, v[46:49]
    ds_write_b128 v7, v[46:49] offset:7680
    s_mov_b64 exec, s[44:45]
    v_cmp_gt_u32 vcc, 48, v0
    s_and_saveexec_b64 s[44:45], vcc
    v_mul_u32_u24 v6, 0x5556, v0
    v_lshrrev_b32 v6, 16, v6
    v_mul_u32_u24 v7, 3, v6
    v_sub_u32 v7, v0, v7
    v_mul_u32_u24 v6, 4416, v6
    v_lshlrev_b32 v7, 4, v7
    v_add_u32 v6, v6, v7
    ds_write_b128 v6, v[46:49] offset:4096
    s_mov_b64 exec, s[44:45]
    s_waitcnt lgkmcnt(0)
    s_lshl_b32 s44, s32, 16
    s_and_b32 s45, s32, 0xffff0000
    s_lshl_b32 s46, s33, 16
    s_and_b32 s47, s33, 0xffff0000
    s_lshl_b32 s48, s34, 16
    s_and_b32 s49, s34, 0xffff0000
    s_lshl_b32 s50, s35, 16
    s_and_b32 s51, s35, 0xffff0000
    s_lshl_b32 s52, s36, 16
    s_and_b32 s53, s36, 0xffff0000
    s_waitcnt vmcnt(4)
    v_lshlrev_b32 v50, 16, v10
    v_and_b32 v61, 0xffff0000, v10
    v_lshlrev_b32 v51, 16, v11
    v_and_b32 v62, 0xffff0000, v11
    v_lshlrev_b32 v52, 16, v12
    v_and_b32 v63, 0xffff0000, v12
    v_lshlrev_b32 v53, 16, v13
    v_and_b32 v64, 0xffff0000, v13
    v_lshlrev_b32 v54, 16, v14
    v_and_b32 v65, 0xffff0000, v14
    v_lshlrev_b32 v55, 16, v15
    v_and_b32 v66, 0xffff0000, v15
    v_lshlrev_b32 v56, 16, v16
    v_and_b32 v67, 0xffff0000, v16
    v_lshlrev_b32 v57, 16, v17
    v_and_b32 v68, 0xffff0000, v17
    v_lshlrev_b32 v58, 16, v18
    v_and_b32 v69, 0xffff0000, v18
    v_lshlrev_b32 v59, 16, v19
    v_and_b32 v70, 0xffff0000, v19
    v_lshlrev_b32 v60, 16, v20
    v_and_b32 v71, 0xffff0000, v20
    v_mul_f32 v90, s47, v50
    v_mul_f32 v91, s51, v61
    v_cvt_pk_bf16_f32 v92, v90, v91
    v_lshlrev_b32 v90, 16, v92
    v_and_b32 v91, 0xffff0000, v92
    v_mul_f32 v93, s46, v51
    v_mul_f32 v94, s50, v62
    v_cvt_pk_bf16_f32 v92, v93, v94
    v_lshlrev_b32 v93, 16, v92
    v_and_b32 v94, 0xffff0000, v92
    v_add_f32 v90, v90, v93
    v_add_f32 v91, v91, v94
    v_cvt_pk_bf16_f32 v92, v90, v91
    v_lshlrev_b32 v90, 16, v92
    v_and_b32 v91, 0xffff0000, v92
    v_mul_f32 v93, s45, v52
    v_mul_f32 v94, s49, v63
    v_cvt_pk_bf16_f32 v92, v93, v94
    v_lshlrev_b32 v93, 16, v92
    v_and_b32 v94, 0xffff0000, v92
    v_add_f32 v90, v90, v93
    v_add_f32 v91, v91, v94
    v_cvt_pk_bf16_f32 v92, v90, v91
    v_lshlrev_b32 v90, 16, v92
    v_and_b32 v91, 0xffff0000, v92
    v_mul_f32 v93, s44, v53
    v_mul_f32 v94, s48, v64
    v_cvt_pk_bf16_f32 v92, v93, v94
    v_lshlrev_b32 v93, 16, v92
    v_and_b32 v94, 0xffff0000, v92
    v_add_f32 v90, v90, v93
    v_add_f32 v91, v91, v94
    v_cvt_pk_bf16_f32 v92, v90, v91
    v_lshlrev_b32 v90, 16, v92
    v_and_b32 v91, 0xffff0000, v92
    v_lshlrev_b32 v93, 16, v21
    v_and_b32 v94, 0xffff0000, v21
    v_mul_f32 v72, v90, v93
    v_mul_f32 v80, v91, v94
    v_mul_f32 v90, s47, v51
    v_mul_f32 v91, s51, v62
    v_cvt_pk_bf16_f32 v92, v90, v91
    v_lshlrev_b32 v90, 16, v92
    v_and_b32 v91, 0xffff0000, v92
    v_mul_f32 v93, s46, v52
    v_mul_f32 v94, s50, v63
    v_cvt_pk_bf16_f32 v92, v93, v94
    v_lshlrev_b32 v93, 16, v92
    v_and_b32 v94, 0xffff0000, v92
    v_add_f32 v90, v90, v93
    v_add_f32 v91, v91, v94
    v_cvt_pk_bf16_f32 v92, v90, v91
    v_lshlrev_b32 v90, 16, v92
    v_and_b32 v91, 0xffff0000, v92
    v_mul_f32 v93, s45, v53
    v_mul_f32 v94, s49, v64
    v_cvt_pk_bf16_f32 v92, v93, v94
    v_lshlrev_b32 v93, 16, v92
    v_and_b32 v94, 0xffff0000, v92
    v_add_f32 v90, v90, v93
    v_add_f32 v91, v91, v94
    v_cvt_pk_bf16_f32 v92, v90, v91
    v_lshlrev_b32 v90, 16, v92
    v_and_b32 v91, 0xffff0000, v92
    v_mul_f32 v93, s44, v54
    v_mul_f32 v94, s48, v65
    v_cvt_pk_bf16_f32 v92, v93, v94
    v_lshlrev_b32 v93, 16, v92
    v_and_b32 v94, 0xffff0000, v92
    v_add_f32 v90, v90, v93
    v_add_f32 v91, v91, v94
    v_cvt_pk_bf16_f32 v92, v90, v91
    v_lshlrev_b32 v90, 16, v92
    v_and_b32 v91, 0xffff0000, v92
    v_lshlrev_b32 v93, 16, v22
    v_and_b32 v94, 0xffff0000, v22
    v_mul_f32 v73, v90, v93
    v_mul_f32 v81, v91, v94
    v_mul_f32 v90, s47, v52
    v_mul_f32 v91, s51, v63
    v_cvt_pk_bf16_f32 v92, v90, v91
    v_lshlrev_b32 v90, 16, v92
    v_and_b32 v91, 0xffff0000, v92
    v_mul_f32 v93, s46, v53
    v_mul_f32 v94, s50, v64
    v_cvt_pk_bf16_f32 v92, v93, v94
    v_lshlrev_b32 v93, 16, v92
    v_and_b32 v94, 0xffff0000, v92
    v_add_f32 v90, v90, v93
    v_add_f32 v91, v91, v94
    v_cvt_pk_bf16_f32 v92, v90, v91
    v_lshlrev_b32 v90, 16, v92
    v_and_b32 v91, 0xffff0000, v92
    v_mul_f32 v93, s45, v54
    v_mul_f32 v94, s49, v65
    v_cvt_pk_bf16_f32 v92, v93, v94
    v_lshlrev_b32 v93, 16, v92
    v_and_b32 v94, 0xffff0000, v92
    v_add_f32 v90, v90, v93
    v_add_f32 v91, v91, v94
    v_cvt_pk_bf16_f32 v92, v90, v91
    v_lshlrev_b32 v90, 16, v92
    v_and_b32 v91, 0xffff0000, v92
    v_mul_f32 v93, s44, v55
    v_mul_f32 v94, s48, v66
    v_cvt_pk_bf16_f32 v92, v93, v94
    v_lshlrev_b32 v93, 16, v92
    v_and_b32 v94, 0xffff0000, v92
    v_add_f32 v90, v90, v93
    v_add_f32 v91, v91, v94
    v_cvt_pk_bf16_f32 v92, v90, v91
    v_lshlrev_b32 v90, 16, v92
    v_and_b32 v91, 0xffff0000, v92
    v_lshlrev_b32 v93, 16, v23
    v_and_b32 v94, 0xffff0000, v23
    v_mul_f32 v74, v90, v93
    v_mul_f32 v82, v91, v94
    v_mul_f32 v90, s47, v53
    v_mul_f32 v91, s51, v64
    v_cvt_pk_bf16_f32 v92, v90, v91
    v_lshlrev_b32 v90, 16, v92
    v_and_b32 v91, 0xffff0000, v92
    v_mul_f32 v93, s46, v54
    v_mul_f32 v94, s50, v65
    v_cvt_pk_bf16_f32 v92, v93, v94
    v_lshlrev_b32 v93, 16, v92
    v_and_b32 v94, 0xffff0000, v92
    v_add_f32 v90, v90, v93
    v_add_f32 v91, v91, v94
    v_cvt_pk_bf16_f32 v92, v90, v91
    v_lshlrev_b32 v90, 16, v92
    v_and_b32 v91, 0xffff0000, v92
    v_mul_f32 v93, s45, v55
    v_mul_f32 v94, s49, v66
    v_cvt_pk_bf16_f32 v92, v93, v94
    v_lshlrev_b32 v93, 16, v92
    v_and_b32 v94, 0xffff0000, v92
    v_add_f32 v90, v90, v93
    v_add_f32 v91, v91, v94
    v_cvt_pk_bf16_f32 v92, v90, v91
    v_lshlrev_b32 v90, 16, v92
    v_and_b32 v91, 0xffff0000, v92
    v_mul_f32 v93, s44, v56
    v_mul_f32 v94, s48, v67
    v_cvt_pk_bf16_f32 v92, v93, v94
    v_lshlrev_b32 v93, 16, v92
    v_and_b32 v94, 0xffff0000, v92
    v_add_f32 v90, v90, v93
    v_add_f32 v91, v91, v94
    v_cvt_pk_bf16_f32 v92, v90, v91
    v_lshlrev_b32 v90, 16, v92
    v_and_b32 v91, 0xffff0000, v92
    v_lshlrev_b32 v93, 16, v24
    v_and_b32 v94, 0xffff0000, v24
    v_mul_f32 v75, v90, v93
    v_mul_f32 v83, v91, v94
    v_mul_f32 v90, s47, v54
    v_mul_f32 v91, s51, v65
    v_cvt_pk_bf16_f32 v92, v90, v91
    v_lshlrev_b32 v90, 16, v92
    v_and_b32 v91, 0xffff0000, v92
    v_mul_f32 v93, s46, v55
    v_mul_f32 v94, s50, v66
    v_cvt_pk_bf16_f32 v92, v93, v94
    v_lshlrev_b32 v93, 16, v92
    v_and_b32 v94, 0xffff0000, v92
    v_add_f32 v90, v90, v93
    v_add_f32 v91, v91, v94
    v_cvt_pk_bf16_f32 v92, v90, v91
    v_lshlrev_b32 v90, 16, v92
    v_and_b32 v91, 0xffff0000, v92
    v_mul_f32 v93, s45, v56
    v_mul_f32 v94, s49, v67
    v_cvt_pk_bf16_f32 v92, v93, v94
    v_lshlrev_b32 v93, 16, v92
    v_and_b32 v94, 0xffff0000, v92
    v_add_f32 v90, v90, v93
    v_add_f32 v91, v91, v94
    v_cvt_pk_bf16_f32 v92, v90, v91
    v_lshlrev_b32 v90, 16, v92
    v_and_b32 v91, 0xffff0000, v92
    v_mul_f32 v93, s44, v57
    v_mul_f32 v94, s48, v68
    v_cvt_pk_bf16_f32 v92, v93, v94
    v_lshlrev_b32 v93, 16, v92
    v_and_b32 v94, 0xffff0000, v92
    v_add_f32 v90, v90, v93
    v_add_f32 v91, v91, v94
    v_cvt_pk_bf16_f32 v92, v90, v91
    v_lshlrev_b32 v90, 16, v92
    v_and_b32 v91, 0xffff0000, v92
    v_lshlrev_b32 v93, 16, v25
    v_and_b32 v94, 0xffff0000, v25
    v_mul_f32 v76, v90, v93
    v_mul_f32 v84, v91, v94
    v_mul_f32 v90, s47, v55
    v_mul_f32 v91, s51, v66
    v_cvt_pk_bf16_f32 v92, v90, v91
    v_lshlrev_b32 v90, 16, v92
    v_and_b32 v91, 0xffff0000, v92
    v_mul_f32 v93, s46, v56
    v_mul_f32 v94, s50, v67
    v_cvt_pk_bf16_f32 v92, v93, v94
    v_lshlrev_b32 v93, 16, v92
    v_and_b32 v94, 0xffff0000, v92
    v_add_f32 v90, v90, v93
    v_add_f32 v91, v91, v94
    v_cvt_pk_bf16_f32 v92, v90, v91
    v_lshlrev_b32 v90, 16, v92
    v_and_b32 v91, 0xffff0000, v92
    v_mul_f32 v93, s45, v57
    v_mul_f32 v94, s49, v68
    v_cvt_pk_bf16_f32 v92, v93, v94
    v_lshlrev_b32 v93, 16, v92
    v_and_b32 v94, 0xffff0000, v92
    v_add_f32 v90, v90, v93
    v_add_f32 v91, v91, v94
    v_cvt_pk_bf16_f32 v92, v90, v91
    v_lshlrev_b32 v90, 16, v92
    v_and_b32 v91, 0xffff0000, v92
    v_mul_f32 v93, s44, v58
    v_mul_f32 v94, s48, v69
    v_cvt_pk_bf16_f32 v92, v93, v94
    v_lshlrev_b32 v93, 16, v92
    v_and_b32 v94, 0xffff0000, v92
    v_add_f32 v90, v90, v93
    v_add_f32 v91, v91, v94
    v_cvt_pk_bf16_f32 v92, v90, v91
    v_lshlrev_b32 v90, 16, v92
    v_and_b32 v91, 0xffff0000, v92
    v_lshlrev_b32 v93, 16, v26
    v_and_b32 v94, 0xffff0000, v26
    v_mul_f32 v77, v90, v93
    v_mul_f32 v85, v91, v94
    v_mul_f32 v90, s47, v56
    v_mul_f32 v91, s51, v67
    v_cvt_pk_bf16_f32 v92, v90, v91
    v_lshlrev_b32 v90, 16, v92
    v_and_b32 v91, 0xffff0000, v92
    v_mul_f32 v93, s46, v57
    v_mul_f32 v94, s50, v68
    v_cvt_pk_bf16_f32 v92, v93, v94
    v_lshlrev_b32 v93, 16, v92
    v_and_b32 v94, 0xffff0000, v92
    v_add_f32 v90, v90, v93
    v_add_f32 v91, v91, v94
    v_cvt_pk_bf16_f32 v92, v90, v91
    v_lshlrev_b32 v90, 16, v92
    v_and_b32 v91, 0xffff0000, v92
    v_mul_f32 v93, s45, v58
    v_mul_f32 v94, s49, v69
    v_cvt_pk_bf16_f32 v92, v93, v94
    v_lshlrev_b32 v93, 16, v92
    v_and_b32 v94, 0xffff0000, v92
    v_add_f32 v90, v90, v93
    v_add_f32 v91, v91, v94
    v_cvt_pk_bf16_f32 v92, v90, v91
    v_lshlrev_b32 v90, 16, v92
    v_and_b32 v91, 0xffff0000, v92
    v_mul_f32 v93, s44, v59
    v_mul_f32 v94, s48, v70
    v_cvt_pk_bf16_f32 v92, v93, v94
    v_lshlrev_b32 v93, 16, v92
    v_and_b32 v94, 0xffff0000, v92
    v_add_f32 v90, v90, v93
    v_add_f32 v91, v91, v94
    v_cvt_pk_bf16_f32 v92, v90, v91
    v_lshlrev_b32 v90, 16, v92
    v_and_b32 v91, 0xffff0000, v92
    v_lshlrev_b32 v93, 16, v27
    v_and_b32 v94, 0xffff0000, v27
    v_mul_f32 v78, v90, v93
    v_mul_f32 v86, v91, v94
    v_mul_f32 v90, s47, v57
    v_mul_f32 v91, s51, v68
    v_cvt_pk_bf16_f32 v92, v90, v91
    v_lshlrev_b32 v90, 16, v92
    v_and_b32 v91, 0xffff0000, v92
    v_mul_f32 v93, s46, v58
    v_mul_f32 v94, s50, v69
    v_cvt_pk_bf16_f32 v92, v93, v94
    v_lshlrev_b32 v93, 16, v92
    v_and_b32 v94, 0xffff0000, v92
    v_add_f32 v90, v90, v93
    v_add_f32 v91, v91, v94
    v_cvt_pk_bf16_f32 v92, v90, v91
    v_lshlrev_b32 v90, 16, v92
    v_and_b32 v91, 0xffff0000, v92
    v_mul_f32 v93, s45, v59
    v_mul_f32 v94, s49, v70
    v_cvt_pk_bf16_f32 v92, v93, v94
    v_lshlrev_b32 v93, 16, v92
    v_and_b32 v94, 0xffff0000, v92
    v_add_f32 v90, v90, v93
    v_add_f32 v91, v91, v94
    v_cvt_pk_bf16_f32 v92, v90, v91
    v_lshlrev_b32 v90, 16, v92
    v_and_b32 v91, 0xffff0000, v92
    v_mul_f32 v93, s44, v60
    v_mul_f32 v94, s48, v71
    v_cvt_pk_bf16_f32 v92, v93, v94
    v_lshlrev_b32 v93, 16, v92
    v_and_b32 v94, 0xffff0000, v92
    v_add_f32 v90, v90, v93
    v_add_f32 v91, v91, v94
    v_cvt_pk_bf16_f32 v92, v90, v91
    v_lshlrev_b32 v90, 16, v92
    v_and_b32 v91, 0xffff0000, v92
    v_lshlrev_b32 v93, 16, v28
    v_and_b32 v94, 0xffff0000, v28
    v_mul_f32 v79, v90, v93
    v_mul_f32 v87, v91, v94
    v_cvt_pk_bf16_f32 v88, v72, v73
    v_cvt_pk_bf16_f32 v89, v74, v75
    v_cvt_pk_bf16_f32 v90, v76, v77
    v_cvt_pk_bf16_f32 v91, v78, v79
    v_cvt_pk_bf16_f32 v92, v80, v81
    v_cvt_pk_bf16_f32 v93, v82, v83
    v_cvt_pk_bf16_f32 v94, v84, v85
    v_cvt_pk_bf16_f32 v95, v86, v87
    v_lshrrev_b32 v6, 2, v0
    v_mul_u32_u24 v6, 80, v6
    v_and_b32 v7, 3, v0
    v_lshlrev_b32 v7, 4, v7
    v_add_u32 v6, v6, v7
    v_add_u32 v6, 70656, v6
    ds_write_b128 v6, v[88:91] offset:2560
    ds_write_b128 v6, v[92:95] offset:10240
    s_waitcnt vmcnt(0)
    v_sub_u32 v6, 255, v0
    v_lshlrev_b32 v6, 4, v6
    v_alignbit_b32 v50, v37, v37, 16
    v_alignbit_b32 v51, v36, v36, 16
    v_alignbit_b32 v52, v35, v35, 16
    v_alignbit_b32 v53, v34, v34, 16
    v_alignbit_b32 v54, v33, v33, 16
    v_alignbit_b32 v55, v32, v32, 16
    v_alignbit_b32 v56, v31, v31, 16
    v_alignbit_b32 v57, v30, v30, 16
    v_mov_b32 v60, v51
    v_alignbit_b32 v70, v51, v50, 16
    v_mov_b32 v61, v52
    v_alignbit_b32 v71, v52, v51, 16
    v_mov_b32 v62, v53
    v_alignbit_b32 v72, v53, v52, 16
    v_mov_b32 v63, v54
    v_alignbit_b32 v73, v54, v53, 16
    v_mov_b32 v64, v55
    v_alignbit_b32 v74, v55, v54, 16
    v_mov_b32 v65, v56
    v_alignbit_b32 v75, v56, v55, 16
    v_mov_b32 v66, v57
    v_alignbit_b32 v76, v57, v56, 16
    v_mov_b32 v80, v71
    v_mov_b32 v81, v72
    v_mov_b32 v82, v73
    v_mov_b32 v83, v74
    v_mov_b32 v84, v75
    v_mov_b32 v85, v76
    ds_write_b128 v6, v[50:53] offset:0
    ds_write_b128 v6, v[70:73] offset:4416
    ds_write_b128 v6, v[60:63] offset:8832
    ds_write_b128 v6, v[80:83] offset:13248
    ds_write_b128 v6, v[52:55] offset:17664
    ds_write_b128 v6, v[72:75] offset:22080
    ds_write_b128 v6, v[62:65] offset:26496
    ds_write_b128 v6, v[82:85] offset:30912
    v_alignbit_b32 v50, v45, v45, 16
    v_alignbit_b32 v51, v44, v44, 16
    v_alignbit_b32 v52, v43, v43, 16
    v_alignbit_b32 v53, v42, v42, 16
    v_alignbit_b32 v54, v41, v41, 16
    v_alignbit_b32 v55, v40, v40, 16
    v_alignbit_b32 v56, v39, v39, 16
    v_alignbit_b32 v57, v38, v38, 16
    v_mov_b32 v60, v51
    v_alignbit_b32 v70, v51, v50, 16
    v_mov_b32 v61, v52
    v_alignbit_b32 v71, v52, v51, 16
    v_mov_b32 v62, v53
    v_alignbit_b32 v72, v53, v52, 16
    v_mov_b32 v63, v54
    v_alignbit_b32 v73, v54, v53, 16
    v_mov_b32 v64, v55
    v_alignbit_b32 v74, v55, v54, 16
    v_mov_b32 v65, v56
    v_alignbit_b32 v75, v56, v55, 16
    v_mov_b32 v66, v57
    v_alignbit_b32 v76, v57, v56, 16
    v_mov_b32 v80, v71
    v_mov_b32 v81, v72
    v_mov_b32 v82, v73
    v_mov_b32 v83, v74
    v_mov_b32 v84, v75
    v_mov_b32 v85, v76
    ds_write_b128 v6, v[50:53] offset:35328
    ds_write_b128 v6, v[70:73] offset:39744
    ds_write_b128 v6, v[60:63] offset:44160
    ds_write_b128 v6, v[80:83] offset:48576
    ds_write_b128 v6, v[52:55] offset:52992
    ds_write_b128 v6, v[72:75] offset:57408
    ds_write_b128 v6, v[62:65] offset:61824
    v_add_u32 v7, 0x8000, v6
    ds_write_b128 v7, v[82:85] offset:33472
    s_waitcnt lgkmcnt(0)
    s_barrier
    v_lshrrev_b32 v1, 6, v0
    s_nop 0
    v_readfirstlane_b32 s54, v1
    s_lshr_b32 s55, s54, 1
    s_and_b32 s56, s54, 1
    v_and_b32 v1, 63, v0
    v_and_b32 v2, 31, v1
    v_lshrrev_b32 v3, 5, v1
    v_sub_u32 v4, 7, v2
    v_and_b32 v4, 7, v4
    v_mul_u32_u24 v4, 4416, v4
    v_lshrrev_b32 v5, 3, v2
    v_sub_u32 v5, v3, v5
    v_add_u32 v5, 255, v5
    v_lshlrev_b32 v5, 4, v5
    v_add_u32 v4, v4, v5
    s_mul_i32 s57, s55, 35328
    v_add_u32 v4, s57, v4
    s_lshl_b32 s58, s56, 5
    s_add_u32 s58, s58, 32
    v_add_u32 v5, s58, v2
    v_mul_u32_u24 v5, 80, v5
    v_lshlrev_b32 v6, 4, v3
    v_add_u32 v5, v5, v6
    s_mul_i32 s57, s55, 7680
    s_add_u32 s57, s57, 70656
    v_add_u32 v5, s57, v5
    v_mov_b32 v100, 0
    v_mov_b32 v101, 0
    v_mov_b32 v102, 0
    v_mov_b32 v103, 0
    v_mov_b32 v104, 0
    v_mov_b32 v105, 0
    v_mov_b32 v106, 0
    v_mov_b32 v107, 0
    v_mov_b32 v108, 0
    v_mov_b32 v109, 0
    v_mov_b32 v110, 0
    v_mov_b32 v111, 0
    v_mov_b32 v112, 0
    v_mov_b32 v113, 0
    v_mov_b32 v114, 0
    v_mov_b32 v115, 0
    s_lshl_b32 s59, s56, 5
    s_add_u32 s59, s59, 32
    ds_read_b128 v[10:13], v4
    ds_read_b128 v[14:17], v4 offset:32
    ds_read_b128 v[18:21], v5
    ds_read_b128 v[22:25], v5 offset:32
    v_subrev_u32 v4, 64, v4
    v_subrev_u32 v5, 80, v5
K1_LOOP:
    ds_read_b128 v[26:29], v4
    ds_read_b128 v[30:33], v4 offset:32
    ds_read_b128 v[34:37], v5
    ds_read_b128 v[38:41], v5 offset:32
    v_subrev_u32 v4, 64, v4
    v_subrev_u32 v5, 80, v5
    s_waitcnt lgkmcnt(4)
    v_mfma_f32_32x32x16_bf16 v[100:115], v[10:13], v[18:21], v[100:115]
    v_mfma_f32_32x32x16_bf16 v[100:115], v[14:17], v[22:25], v[100:115]
    ds_read_b128 v[10:13], v4
    ds_read_b128 v[14:17], v4 offset:32
    ds_read_b128 v[18:21], v5
    ds_read_b128 v[22:25], v5 offset:32
    v_subrev_u32 v4, 64, v4
    v_subrev_u32 v5, 80, v5
    s_waitcnt lgkmcnt(4)
    v_mfma_f32_32x32x16_bf16 v[100:115], v[26:29], v[34:37], v[100:115]
    v_mfma_f32_32x32x16_bf16 v[100:115], v[30:33], v[38:41], v[100:115]
    s_sub_u32 s59, s59, 2
    s_cmp_gt_u32 s59, 0
    s_cbranch_scc1 K1_LOOP
    s_waitcnt lgkmcnt(0)
    s_nop 15
    s_nop 7
    v_add_u32 v5, s58, v2
    v_mul_u32_u24 v5, 80, v5
    v_lshlrev_b32 v6, 3, v3
    v_add_u32 v5, v5, v6
    v_add_u32 v5, s57, v5
    ds_read_b64 v[10:11], v5 offset:0
    ds_read_b64 v[12:13], v5 offset:16
    ds_read_b64 v[14:15], v5 offset:32
    ds_read_b64 v[16:17], v5 offset:48
    s_lshl_b32 s60, s2, 1
    s_add_u32 s60, s60, s55
    s_lshl_b32 s60, s60, 12
    s_add_u32 s60, s60, 16384
    s_sub_u32 s61, s58, 32
    v_add_u32 v6, s61, v2
    v_lshlrev_b32 v6, 6, v6
    v_lshlrev_b32 v7, 3, v3
    v_add_u32 v6, v6, v7
    s_cmp_eq_u32 s55, 0
    s_cselect_b32 s62, s52, s53
    s_waitcnt lgkmcnt(0)
    v_lshlrev_b32 v20, 16, v10
    v_and_b32 v21, 0xffff0000, v10
    v_mul_f32 v20, s62, v20
    v_mul_f32 v21, s62, v21
    v_cvt_pk_bf16_f32 v22, v20, v21
    v_lshlrev_b32 v20, 16, v22
    v_and_b32 v21, 0xffff0000, v22
    v_cvt_pk_bf16_f32 v22, v100, v101
    v_lshlrev_b32 v24, 16, v22
    v_and_b32 v25, 0xffff0000, v22
    v_add_f32 v20, v20, v24
    v_add_f32 v21, v21, v25
    v_cvt_pk_bf16_f32 v30, v20, v21
    v_lshlrev_b32 v20, 16, v11
    v_and_b32 v21, 0xffff0000, v11
    v_mul_f32 v20, s62, v20
    v_mul_f32 v21, s62, v21
    v_cvt_pk_bf16_f32 v22, v20, v21
    v_lshlrev_b32 v20, 16, v22
    v_and_b32 v21, 0xffff0000, v22
    v_cvt_pk_bf16_f32 v22, v102, v103
    v_lshlrev_b32 v24, 16, v22
    v_and_b32 v25, 0xffff0000, v22
    v_add_f32 v20, v20, v24
    v_add_f32 v21, v21, v25
    v_cvt_pk_bf16_f32 v31, v20, v21
    buffer_store_dwordx2 v[30:31], v6, s[28:31], s60 offen offset:0
    v_lshlrev_b32 v20, 16, v12
    v_and_b32 v21, 0xffff0000, v12
    v_mul_f32 v20, s62, v20
    v_mul_f32 v21, s62, v21
    v_cvt_pk_bf16_f32 v22, v20, v21
    v_lshlrev_b32 v20, 16, v22
    v_and_b32 v21, 0xffff0000, v22
    v_cvt_pk_bf16_f32 v22, v104, v105
    v_lshlrev_b32 v24, 16, v22
    v_and_b32 v25, 0xffff0000, v22
    v_add_f32 v20, v20, v24
    v_add_f32 v21, v21, v25
    v_cvt_pk_bf16_f32 v32, v20, v21
    v_lshlrev_b32 v20, 16, v13
    v_and_b32 v21, 0xffff0000, v13
    v_mul_f32 v20, s62, v20
    v_mul_f32 v21, s62, v21
    v_cvt_pk_bf16_f32 v22, v20, v21
    v_lshlrev_b32 v20, 16, v22
    v_and_b32 v21, 0xffff0000, v22
    v_cvt_pk_bf16_f32 v22, v106, v107
    v_lshlrev_b32 v24, 16, v22
    v_and_b32 v25, 0xffff0000, v22
    v_add_f32 v20, v20, v24
    v_add_f32 v21, v21, v25
    v_cvt_pk_bf16_f32 v33, v20, v21
    buffer_store_dwordx2 v[32:33], v6, s[28:31], s60 offen offset:16
    v_lshlrev_b32 v20, 16, v14
    v_and_b32 v21, 0xffff0000, v14
    v_mul_f32 v20, s62, v20
    v_mul_f32 v21, s62, v21
    v_cvt_pk_bf16_f32 v22, v20, v21
    v_lshlrev_b32 v20, 16, v22
    v_and_b32 v21, 0xffff0000, v22
    v_cvt_pk_bf16_f32 v22, v108, v109
    v_lshlrev_b32 v24, 16, v22
    v_and_b32 v25, 0xffff0000, v22
    v_add_f32 v20, v20, v24
    v_add_f32 v21, v21, v25
    v_cvt_pk_bf16_f32 v34, v20, v21
    v_lshlrev_b32 v20, 16, v15
    v_and_b32 v21, 0xffff0000, v15
    v_mul_f32 v20, s62, v20
    v_mul_f32 v21, s62, v21
    v_cvt_pk_bf16_f32 v22, v20, v21
    v_lshlrev_b32 v20, 16, v22
    v_and_b32 v21, 0xffff0000, v22
    v_cvt_pk_bf16_f32 v22, v110, v111
    v_lshlrev_b32 v24, 16, v22
    v_and_b32 v25, 0xffff0000, v22
    v_add_f32 v20, v20, v24
    v_add_f32 v21, v21, v25
    v_cvt_pk_bf16_f32 v35, v20, v21
    buffer_store_dwordx2 v[34:35], v6, s[28:31], s60 offen offset:32
    v_lshlrev_b32 v20, 16, v16
    v_and_b32 v21, 0xffff0000, v16
    v_mul_f32 v20, s62, v20
    v_mul_f32 v21, s62, v21
    v_cvt_pk_bf16_f32 v22, v20, v21
    v_lshlrev_b32 v20, 16, v22
    v_and_b32 v21, 0xffff0000, v22
    v_cvt_pk_bf16_f32 v22, v112, v113
    v_lshlrev_b32 v24, 16, v22
    v_and_b32 v25, 0xffff0000, v22
    v_add_f32 v20, v20, v24
    v_add_f32 v21, v21, v25
    v_cvt_pk_bf16_f32 v36, v20, v21
    v_lshlrev_b32 v20, 16, v17
    v_and_b32 v21, 0xffff0000, v17
    v_mul_f32 v20, s62, v20
    v_mul_f32 v21, s62, v21
    v_cvt_pk_bf16_f32 v22, v20, v21
    v_lshlrev_b32 v20, 16, v22
    v_and_b32 v21, 0xffff0000, v22
    v_cvt_pk_bf16_f32 v22, v114, v115
    v_lshlrev_b32 v24, 16, v22
    v_and_b32 v25, 0xffff0000, v22
    v_add_f32 v20, v20, v24
    v_add_f32 v21, v21, v25
    v_cvt_pk_bf16_f32 v37, v20, v21
    buffer_store_dwordx2 v[36:37], v6, s[28:31], s60 offen offset:48
    s_waitcnt vmcnt(0)
    s_branch K1_END
K1_MOD:
    s_load_dwordx4 s[4:7], s[0:1], 88
    s_load_dwordx2 s[14:15], s[0:1], 120
    s_sub_u32 s3, s2, 224
    s_waitcnt lgkmcnt(0)
    s_mov_b32 s16, s4
    s_and_b32 s17, s5, 0xffff
    s_mov_b32 s18, 896
    s_mov_b32 s19, 0x00020000
    s_mov_b32 s20, s6
    s_and_b32 s21, s7, 0xffff
    s_mov_b32 s22, 2408448
    s_mov_b32 s23, 0x00020000
    s_mov_b32 s28, s14
    s_and_b32 s29, s15, 0xffff
    s_mov_b32 s30, 268435456
    s_mov_b32 s31, 0x00020000
    v_lshlrev_b32 v1, 2, v0
    buffer_load_dword v2, v1, s[16:19], 0 offen
    s_mov_b32 s40, 0xbfb8aa3b
    s_waitcnt vmcnt(0)
    v_lshlrev_b32 v3, 16, v2
    v_and_b32 v4, 0xffff0000, v2
    v_mul_f32 v5, s40, v3
    v_exp_f32 v5, v5
    s_nop 0
    v_add_f32 v5, 1.0, v5
    v_rcp_f32 v5, v5
    s_nop 0
    v_mul_f32 v3, v3, v5
    v_mul_f32 v5, s40, v4
    v_exp_f32 v5, v5
    s_nop 0
    v_add_f32 v5, 1.0, v5
    v_rcp_f32 v5, v5
    s_nop 0
    v_mul_f32 v4, v4, v5
    v_cvt_pk_bf16_f32 v5, v3, v4
    v_lshlrev_b32 v6, 16, v5
    v_and_b32 v7, 0xffff0000, v5
    v_lshlrev_b32 v1, 3, v0
    ds_write_b64 v1, v[6:7]
    s_waitcnt lgkmcnt(0)
    s_barrier
    v_lshrrev_b32 v1, 6, v0
    s_nop 0
    v_readfirstlane_b32 s54, v1
    v_and_b32 v1, 63, v0
    s_mul_i32 s55, s54, 112
    s_lshl_b32 s56, s3, 8
    v_lshlrev_b32 v2, 2, v1
    v_add_u32 v2, s56, v2
    s_mul_i32 s57, s55, 5376
    v_add_u32 v2, s57, v2
    s_lshl_b32 s58, s55, 2
    v_mov_b32 v3, s58
    v_mov_b32 v4, 0
    v_mov_b32 v5, 0
    s_mov_b32 s59, 14
K1_MODLOOP:
    ds_read_b128 v[8:11], v3
    ds_read_b128 v[12:15], v3 offset:16
    v_add_u32 v6, 0, v2
    buffer_load_dword v16, v6, s[20:23], 0 offen
    v_add_u32 v6, 5376, v2
    buffer_load_dword v17, v6, s[20:23], 0 offen
    v_add_u32 v6, 10752, v2
    buffer_load_dword v18, v6, s[20:23], 0 offen
    v_add_u32 v6, 16128, v2
    buffer_load_dword v19, v6, s[20:23], 0 offen
    v_add_u32 v6, 21504, v2
    buffer_load_dword v20, v6, s[20:23], 0 offen
    v_add_u32 v6, 26880, v2
    buffer_load_dword v21, v6, s[20:23], 0 offen
    v_add_u32 v6, 32256, v2
    buffer_load_dword v22, v6, s[20:23], 0 offen
    v_add_u32 v6, 37632, v2
    buffer_load_dword v23, v6, s[20:23], 0 offen
    v_add_u32 v2, 43008, v2
    v_add_u32 v3, 32, v3
    s_waitcnt vmcnt(0) lgkmcnt(0)
    v_lshlrev_b32 v6, 16, v16
    v_and_b32 v7, 0xffff0000, v16
    v_fmac_f32 v4, v8, v6
    v_fmac_f32 v5, v8, v7
    v_lshlrev_b32 v6, 16, v17
    v_and_b32 v7, 0xffff0000, v17
    v_fmac_f32 v4, v9, v6
    v_fmac_f32 v5, v9, v7
    v_lshlrev_b32 v6, 16, v18
    v_and_b32 v7, 0xffff0000, v18
    v_fmac_f32 v4, v10, v6
    v_fmac_f32 v5, v10, v7
    v_lshlrev_b32 v6, 16, v19
    v_and_b32 v7, 0xffff0000, v19
    v_fmac_f32 v4, v11, v6
    v_fmac_f32 v5, v11, v7
    v_lshlrev_b32 v6, 16, v20
    v_and_b32 v7, 0xffff0000, v20
    v_fmac_f32 v4, v12, v6
    v_fmac_f32 v5, v12, v7
    v_lshlrev_b32 v6, 16, v21
    v_and_b32 v7, 0xffff0000, v21
    v_fmac_f32 v4, v13, v6
    v_fmac_f32 v5, v13, v7
    v_lshlrev_b32 v6, 16, v22
    v_and_b32 v7, 0xffff0000, v22
    v_fmac_f32 v4, v14, v6
    v_fmac_f32 v5, v14, v7
    v_lshlrev_b32 v6, 16, v23
    v_and_b32 v7, 0xffff0000, v23
    v_fmac_f32 v4, v15, v6
    v_fmac_f32 v5, v15, v7
    s_sub_u32 s59, s59, 1
    s_cmp_gt_u32 s59, 0
    s_cbranch_scc1 K1_MODLOOP
    v_lshlrev_b32 v6, 3, v0
    ds_write_b64 v6, v[4:5] offset:2048
    s_waitcnt lgkmcnt(0)
    s_barrier
    v_cmp_gt_u32 vcc, 64, v0
    s_and_saveexec_b64 s[44:45], vcc
    s_cbranch_execz K1_END
    ds_read_b64 v[8:9], v6 offset:2048
    ds_read_b64 v[10:11], v6 offset:2560
    ds_read_b64 v[12:13], v6 offset:3072
    ds_read_b64 v[14:15], v6 offset:3584
    s_waitcnt lgkmcnt(0)
    v_add_f32 v4, v8, v10
    v_add_f32 v4, v4, v12
    v_add_f32 v4, v4, v14
    v_add_f32 v5, v9, v11
    v_add_f32 v5, v5, v13
    v_add_f32 v5, v5, v15
    v_cvt_pk_bf16_f32 v6, v4, v5
    v_lshlrev_b32 v4, 16, v6
    v_and_b32 v5, 0xffff0000, v6
    s_lshl_b32 s56, s3, 7
    v_lshlrev_b32 v7, 1, v0
    v_add_u32 v7, s56, v7
    v_add_f32 v8, 1.0, v4
    v_add_f32 v9, 1.0, v5
    v_cvt_pk_bf16_f32 v6, v8, v9
    v_lshlrev_b32 v8, 16, v6
    v_and_b32 v9, 0xffff0000, v6
    v_subrev_u32 v10, 448, v7
    v_cmp_gt_u32 vcc, 448, v10
    v_subrev_u32 v10, 1792, v7
    s_movk_i32 s48, 448
    v_cmp_gt_u32 s[46:47], s48, v10
    s_or_b64 vcc, vcc, s[46:47]
    s_nop 1
    v_cndmask_b32 v4, v4, v8, vcc
    v_cndmask_b32 v5, v5, v9, vcc
    v_lshlrev_b32 v7, 2, v7
    buffer_store_dwordx2 v[4:5], v7, s[28:31], 0 offen offset:0
    s_branch K1_END
K1_TRANS:
    s_load_dwordx2 s[4:5], s[0:1], 56
    s_load_dwordx2 s[6:7], s[0:1], 80
    s_load_dwordx2 s[14:15], s[0:1], 120
    s_sub_u32 s3, s2, 245
    s_waitcnt lgkmcnt(0)
    s_mov_b32 s28, s14
    s_and_b32 s29, s15, 0xffff
    s_mov_b32 s30, 268435456
    s_mov_b32 s31, 0x00020000
    s_cmp_ge_u32 s3, 196
    s_cbranch_scc1 K1_TOUT
    s_mov_b32 s16, s4
    s_and_b32 s17, s5, 0xffff
    s_mov_b32 s18, 1605632
    s_mov_b32 s19, 0x00020000
    s_mov_b32 s40, 4793491
    s_mov_b32 s41, 896
    s_mov_b32 s42, 3584
    s_mov_b32 s43, 896
    s_mov_b32 s44, 1851392
    s_branch K1_TGO
K1_TOUT:
    s_sub_u32 s3, s3, 196
    s_mov_b32 s16, s6
    s_and_b32 s17, s7, 0xffff
    s_mov_b32 s18, 802816
    s_mov_b32 s19, 0x00020000
    s_mov_b32 s40, 19173962
    s_mov_b32 s41, 224
    s_mov_b32 s42, 896
    s_mov_b32 s43, 1792
    s_mov_b32 s44, 3457024
K1_TGO:
    s_lshl_b32 s45, s3, 8
    v_add_u32 v1, s45, v0
    v_mul_hi_u32 v2, v1, s40
    v_mul_lo_u32 v3, v2, s41
    v_sub_u32 v3, v1, v3
    v_mul_lo_u32 v4, v2, s42
    v_lshlrev_b32 v4, 3, v4
    v_lshlrev_b32 v5, 2, v3
    v_add_u32 v4, v4, v5
    buffer_load_dword v10, v4, s[16:19], 0 offen
    v_add_u32 v4, s42, v4
    buffer_load_dword v11, v4, s[16:19], 0 offen
    v_add_u32 v4, s42, v4
    buffer_load_dword v12, v4, s[16:19], 0 offen
    v_add_u32 v4, s42, v4
    buffer_load_dword v13, v4, s[16:19], 0 offen
    v_add_u32 v4, s42, v4
    buffer_load_dword v14, v4, s[16:19], 0 offen
    v_add_u32 v4, s42, v4
    buffer_load_dword v15, v4, s[16:19], 0 offen
    v_add_u32 v4, s42, v4
    buffer_load_dword v16, v4, s[16:19], 0 offen
    v_add_u32 v4, s42, v4
    buffer_load_dword v17, v4, s[16:19], 0 offen
    v_mul_lo_u32 v5, v3, s43
    v_lshlrev_b32 v5, 1, v5
    v_lshlrev_b32 v6, 4, v2
    v_add_u32 v5, v5, v6
    s_mov_b32 s46, 0xffff0000
    s_waitcnt vmcnt(0)
    v_and_b32 v7, 0xffff, v10
    v_lshl_or_b32 v20, v11, 16, v7
    v_lshrrev_b32 v7, 16, v10
    v_and_or_b32 v24, v11, s46, v7
    v_and_b32 v7, 0xffff, v12
    v_lshl_or_b32 v21, v13, 16, v7
    v_lshrrev_b32 v7, 16, v12
    v_and_or_b32 v25, v13, s46, v7
    v_and_b32 v7, 0xffff, v14
    v_lshl_or_b32 v22, v15, 16, v7
    v_lshrrev_b32 v7, 16, v14
    v_and_or_b32 v26, v15, s46, v7
    v_and_b32 v7, 0xffff, v16
    v_lshl_or_b32 v23, v17, 16, v7
    v_lshrrev_b32 v7, 16, v16
    v_and_or_b32 v27, v17, s46, v7
    buffer_store_dwordx4 v[20:23], v5, s[28:31], s44 offen
    v_add_u32 v5, s43, v5
    buffer_store_dwordx4 v[24:27], v5, s[28:31], s44 offen
K1_END:
    s_endpgm
.globl k2_gemm1_kernel
.p2align 8
.type k2_gemm1_kernel,@function
k2_gemm1_kernel:
    s_cmp_ge_u32 s2, 256
    s_cbranch_scc1 K2_END
    s_load_dwordx2 s[4:5], s[0:1], 0
    s_load_dwordx2 s[14:15], s[0:1], 120
    s_and_b32 s40, s2, 3
    s_lshr_b32 s41, s2, 2
    s_lshl_b32 s42, s41, 5
    s_waitcnt lgkmcnt(0)
    s_mov_b32 s16, s4
    s_and_b32 s17, s5, 0xffff
    s_mov_b32 s18, 1835008
    s_mov_b32 s19, 0x00020000
    s_mov_b32 s28, s14
    s_and_b32 s29, s15, 0xffff
    s_mov_b32 s30, 268435456
    s_mov_b32 s31, 0x00020000
    v_lshrrev_b32 v1, 3, v0
    v_and_b32 v2, 7, v0
    v_add_u32 v3, s42, v1
    v_mul_u32_u24 v3, 896, v3
    v_mul_u32_u24 v4, 112, v2
    v_add_u32 v3, v3, v4
    buffer_load_dwordx4 v[100:103], v3, s[16:19], 0 offen offset:0
    buffer_load_dwordx4 v[104:107], v3, s[16:19], 0 offen offset:16
    buffer_load_dwordx4 v[108:111], v3, s[16:19], 0 offen offset:32
    buffer_load_dwordx4 v[112:115], v3, s[16:19], 0 offen offset:48
    buffer_load_dwordx4 v[116:119], v3, s[16:19], 0 offen offset:64
    buffer_load_dwordx4 v[120:123], v3, s[16:19], 0 offen offset:80
    buffer_load_dwordx4 v[124:127], v3, s[16:19], 0 offen offset:96
    v_lshrrev_b32 v5, 2, v0
    v_lshlrev_b32 v5, 12, v5
    v_and_b32 v6, 3, v0
    v_lshlrev_b32 v6, 4, v6
    v_add_u32 v5, v5, v6
    s_lshl_b32 s43, s42, 1
    s_add_u32 s43, s43, 16384
    v_add_u32 v6, 0, v5
    buffer_load_dwordx4 v[130:133], v6, s[28:31], s43 offen
    v_add_u32 v6, 262144, v5
    buffer_load_dwordx4 v[134:137], v6, s[28:31], s43 offen
    v_add_u32 v6, 524288, v5
    buffer_load_dwordx4 v[138:141], v6, s[28:31], s43 offen
    v_add_u32 v6, 786432, v5
    buffer_load_dwordx4 v[142:145], v6, s[28:31], s43 offen
    v_add_u32 v6, 1048576, v5
    buffer_load_dwordx4 v[146:149], v6, s[28:31], s43 offen
    v_add_u32 v6, 1310720, v5
    buffer_load_dwordx4 v[150:153], v6, s[28:31], s43 offen
    v_add_u32 v6, 1572864, v5
    buffer_load_dwordx4 v[154:157], v6, s[28:31], s43 offen
    v_lshlrev_b32 v7, 4, v0
    buffer_load_dwordx4 v[160:163], v7, s[28:31], 0 offen offset:0
    v_add_u32 v8, 4096, v7
    buffer_load_dwordx4 v[164:167], v8, s[28:31], 0 offen
    v_add_u32 v8, 8192, v7
    buffer_load_dwordx4 v[168:171], v8, s[28:31], 0 offen
    v_and_b32 v6, 3, v0
    v_mul_u32_u24 v6, 7424, v6
    v_lshrrev_b32 v8, 2, v0
    v_lshlrev_b32 v8, 1, v8
    v_add_u32 v6, v6, v8
    s_waitcnt vmcnt(3)
    ds_write_b16 v6, v130 offset:0
    ds_write_b16_d16_hi v6, v130 offset:928
    ds_write_b16 v6, v131 offset:1856
    ds_write_b16_d16_hi v6, v131 offset:2784
    ds_write_b16 v6, v132 offset:3712
    ds_write_b16_d16_hi v6, v132 offset:4640
    ds_write_b16 v6, v133 offset:5568
    ds_write_b16_d16_hi v6, v133 offset:6496
    ds_write_b16 v6, v134 offset:128
    ds_write_b16_d16_hi v6, v134 offset:1056
    ds_write_b16 v6, v135 offset:1984
    ds_write_b16_d16_hi v6, v135 offset:2912
    ds_write_b16 v6, v136 offset:3840
    ds_write_b16_d16_hi v6, v136 offset:4768
    ds_write_b16 v6, v137 offset:5696
    ds_write_b16_d16_hi v6, v137 offset:6624
    ds_write_b16 v6, v138 offset:256
    ds_write_b16_d16_hi v6, v138 offset:1184
    ds_write_b16 v6, v139 offset:2112
    ds_write_b16_d16_hi v6, v139 offset:3040
    ds_write_b16 v6, v140 offset:3968
    ds_write_b16_d16_hi v6, v140 offset:4896
    ds_write_b16 v6, v141 offset:5824
    ds_write_b16_d16_hi v6, v141 offset:6752
    ds_write_b16 v6, v142 offset:384
    ds_write_b16_d16_hi v6, v142 offset:1312
    ds_write_b16 v6, v143 offset:2240
    ds_write_b16_d16_hi v6, v143 offset:3168
    ds_write_b16 v6, v144 offset:4096
    ds_write_b16_d16_hi v6, v144 offset:5024
    ds_write_b16 v6, v145 offset:5952
    ds_write_b16_d16_hi v6, v145 offset:6880
    ds_write_b16 v6, v146 offset:512
    ds_write_b16_d16_hi v6, v146 offset:1440
    ds_write_b16 v6, v147 offset:2368
    ds_write_b16_d16_hi v6, v147 offset:3296
    ds_write_b16 v6, v148 offset:4224
    ds_write_b16_d16_hi v6, v148 offset:5152
    ds_write_b16 v6, v149 offset:6080
    ds_write_b16_d16_hi v6, v149 offset:7008
    ds_write_b16 v6, v150 offset:640
    ds_write_b16_d16_hi v6, v150 offset:1568
    ds_write_b16 v6, v151 offset:2496
    ds_write_b16_d16_hi v6, v151 offset:3424
    ds_write_b16 v6, v152 offset:4352
    ds_write_b16_d16_hi v6, v152 offset:5280
    ds_write_b16 v6, v153 offset:6208
    ds_write_b16_d16_hi v6, v153 offset:7136
    ds_write_b16 v6, v154 offset:768
    ds_write_b16_d16_hi v6, v154 offset:1696
    ds_write_b16 v6, v155 offset:2624
    ds_write_b16_d16_hi v6, v155 offset:3552
    ds_write_b16 v6, v156 offset:4480
    ds_write_b16_d16_hi v6, v156 offset:5408
    ds_write_b16 v6, v157 offset:6336
    ds_write_b16_d16_hi v6, v157 offset:7264
    s_waitcnt vmcnt(0)
    v_add_u32 v7, 29696, v7
    ds_write_b128 v7, v[160:163]
    ds_write_b128 v7, v[164:167] offset:4096
    v_cmp_gt_u32 vcc, 160, v0
    s_and_saveexec_b64 s[44:45], vcc
    ds_write_b128 v7, v[168:171] offset:8192
    s_mov_b64 exec, s[44:45]
    s_waitcnt lgkmcnt(0)
    s_barrier
    v_lshlrev_b32 v170, 16, v100
    v_and_b32 v171, 0xffff0000, v100
    v_lshlrev_b32 v172, 16, v101
    v_and_b32 v173, 0xffff0000, v101
    v_lshlrev_b32 v174, 16, v102
    v_and_b32 v175, 0xffff0000, v102
    v_lshlrev_b32 v176, 16, v103
    v_and_b32 v177, 0xffff0000, v103
    v_lshlrev_b32 v178, 16, v104
    v_and_b32 v179, 0xffff0000, v104
    v_lshlrev_b32 v180, 16, v105
    v_and_b32 v181, 0xffff0000, v105
    v_lshlrev_b32 v182, 16, v106
    v_and_b32 v183, 0xffff0000, v106
    v_lshlrev_b32 v184, 16, v107
    v_and_b32 v185, 0xffff0000, v107
    v_lshlrev_b32 v186, 16, v108
    v_and_b32 v187, 0xffff0000, v108
    v_lshlrev_b32 v188, 16, v109
    v_and_b32 v189, 0xffff0000, v109
    v_lshlrev_b32 v190, 16, v110
    v_and_b32 v191, 0xffff0000, v110
    v_lshlrev_b32 v192, 16, v111
    v_and_b32 v193, 0xffff0000, v111
    v_lshlrev_b32 v194, 16, v112
    v_and_b32 v195, 0xffff0000, v112
    v_lshlrev_b32 v196, 16, v113
    v_and_b32 v197, 0xffff0000, v113
    v_lshlrev_b32 v198, 16, v114
    v_and_b32 v199, 0xffff0000, v114
    v_lshlrev_b32 v200, 16, v115
    v_and_b32 v201, 0xffff0000, v115
    v_lshlrev_b32 v202, 16, v116
    v_and_b32 v203, 0xffff0000, v116
    v_lshlrev_b32 v204, 16, v117
    v_and_b32 v205, 0xffff0000, v117
    v_lshlrev_b32 v206, 16, v118
    v_and_b32 v207, 0xffff0000, v118
    v_lshlrev_b32 v208, 16, v119
    v_and_b32 v209, 0xffff0000, v119
    v_lshlrev_b32 v210, 16, v120
    v_and_b32 v211, 0xffff0000, v120
    v_lshlrev_b32 v212, 16, v121
    v_and_b32 v213, 0xffff0000, v121
    v_lshlrev_b32 v214, 16, v122
    v_and_b32 v215, 0xffff0000, v122
    v_lshlrev_b32 v216, 16, v123
    v_and_b32 v217, 0xffff0000, v123
    v_lshlrev_b32 v218, 16, v124
    v_and_b32 v219, 0xffff0000, v124
    v_lshlrev_b32 v220, 16, v125
    v_and_b32 v221, 0xffff0000, v125
    v_lshlrev_b32 v222, 16, v126
    v_and_b32 v223, 0xffff0000, v126
    v_lshlrev_b32 v224, 16, v127
    v_and_b32 v225, 0xffff0000, v127
    v_add_f32 v10, v170, v171
    v_add_f32 v10, v10, v172
    v_add_f32 v10, v10, v173
    v_add_f32 v10, v10, v174
    v_add_f32 v10, v10, v175
    v_add_f32 v10, v10, v176
    v_add_f32 v10, v10, v177
    v_add_f32 v10, v10, v178
    v_add_f32 v10, v10, v179
    v_add_f32 v10, v10, v180
    v_add_f32 v10, v10, v181
    v_add_f32 v10, v10, v182
    v_add_f32 v10, v10, v183
    v_add_f32 v10, v10, v184
    v_add_f32 v10, v10, v185
    v_add_f32 v10, v10, v186
    v_add_f32 v10, v10, v187
    v_add_f32 v10, v10, v188
    v_add_f32 v10, v10, v189
    v_add_f32 v10, v10, v190
    v_add_f32 v10, v10, v191
    v_add_f32 v10, v10, v192
    v_add_f32 v10, v10, v193
    v_add_f32 v10, v10, v194
    v_add_f32 v10, v10, v195
    v_add_f32 v10, v10, v196
    v_add_f32 v10, v10, v197
    v_add_f32 v10, v10, v198
    v_add_f32 v10, v10, v199
    v_add_f32 v10, v10, v200
    v_add_f32 v10, v10, v201
    v_add_f32 v10, v10, v202
    v_add_f32 v10, v10, v203
    v_add_f32 v10, v10, v204
    v_add_f32 v10, v10, v205
    v_add_f32 v10, v10, v206
    v_add_f32 v10, v10, v207
    v_add_f32 v10, v10, v208
    v_add_f32 v10, v10, v209
    v_add_f32 v10, v10, v210
    v_add_f32 v10, v10, v211
    v_add_f32 v10, v10, v212
    v_add_f32 v10, v10, v213
    v_add_f32 v10, v10, v214
    v_add_f32 v10, v10, v215
    v_add_f32 v10, v10, v216
    v_add_f32 v10, v10, v217
    v_add_f32 v10, v10, v218
    v_add_f32 v10, v10, v219
    v_add_f32 v10, v10, v220
    v_add_f32 v10, v10, v221
    v_add_f32 v10, v10, v222
    v_add_f32 v10, v10, v223
    v_add_f32 v10, v10, v224
    v_add_f32 v10, v10, v225
    s_nop 1
    v_add_f32_dpp v10, v10, v10 quad_perm:[1,0,3,2] row_mask:0xf bank_mask:0xf
    s_nop 1
    v_add_f32_dpp v10, v10, v10 quad_perm:[2,3,0,1] row_mask:0xf bank_mask:0xf
    s_nop 1
    v_add_f32_dpp v10, v10, v10 row_half_mirror row_mask:0xf bank_mask:0xf
    s_nop 1
    v_mul_f32 v10, 0x3b124925, v10
    v_mov_b32 v11, 0
    v_sub_f32 v12, v170, v10
    v_fmac_f32 v11, v12, v12
    v_sub_f32 v12, v171, v10
    v_fmac_f32 v11, v12, v12
    v_sub_f32 v12, v172, v10
    v_fmac_f32 v11, v12, v12
    v_sub_f32 v12, v173, v10
    v_fmac_f32 v11, v12, v12
    v_sub_f32 v12, v174, v10
    v_fmac_f32 v11, v12, v12
    v_sub_f32 v12, v175, v10
    v_fmac_f32 v11, v12, v12
    v_sub_f32 v12, v176, v10
    v_fmac_f32 v11, v12, v12
    v_sub_f32 v12, v177, v10
    v_fmac_f32 v11, v12, v12
    v_sub_f32 v12, v178, v10
    v_fmac_f32 v11, v12, v12
    v_sub_f32 v12, v179, v10
    v_fmac_f32 v11, v12, v12
    v_sub_f32 v12, v180, v10
    v_fmac_f32 v11, v12, v12
    v_sub_f32 v12, v181, v10
    v_fmac_f32 v11, v12, v12
    v_sub_f32 v12, v182, v10
    v_fmac_f32 v11, v12, v12
    v_sub_f32 v12, v183, v10
    v_fmac_f32 v11, v12, v12
    v_sub_f32 v12, v184, v10
    v_fmac_f32 v11, v12, v12
    v_sub_f32 v12, v185, v10
    v_fmac_f32 v11, v12, v12
    v_sub_f32 v12, v186, v10
    v_fmac_f32 v11, v12, v12
    v_sub_f32 v12, v187, v10
    v_fmac_f32 v11, v12, v12
    v_sub_f32 v12, v188, v10
    v_fmac_f32 v11, v12, v12
    v_sub_f32 v12, v189, v10
    v_fmac_f32 v11, v12, v12
    v_sub_f32 v12, v190, v10
    v_fmac_f32 v11, v12, v12
    v_sub_f32 v12, v191, v10
    v_fmac_f32 v11, v12, v12
    v_sub_f32 v12, v192, v10
    v_fmac_f32 v11, v12, v12
    v_sub_f32 v12, v193, v10
    v_fmac_f32 v11, v12, v12
    v_sub_f32 v12, v194, v10
    v_fmac_f32 v11, v12, v12
    v_sub_f32 v12, v195, v10
    v_fmac_f32 v11, v12, v12
    v_sub_f32 v12, v196, v10
    v_fmac_f32 v11, v12, v12
    v_sub_f32 v12, v197, v10
    v_fmac_f32 v11, v12, v12
    v_sub_f32 v12, v198, v10
    v_fmac_f32 v11, v12, v12
    v_sub_f32 v12, v199, v10
    v_fmac_f32 v11, v12, v12
    v_sub_f32 v12, v200, v10
    v_fmac_f32 v11, v12, v12
    v_sub_f32 v12, v201, v10
    v_fmac_f32 v11, v12, v12
    v_sub_f32 v12, v202, v10
    v_fmac_f32 v11, v12, v12
    v_sub_f32 v12, v203, v10
    v_fmac_f32 v11, v12, v12
    v_sub_f32 v12, v204, v10
    v_fmac_f32 v11, v12, v12
    v_sub_f32 v12, v205, v10
    v_fmac_f32 v11, v12, v12
    v_sub_f32 v12, v206, v10
    v_fmac_f32 v11, v12, v12
    v_sub_f32 v12, v207, v10
    v_fmac_f32 v11, v12, v12
    v_sub_f32 v12, v208, v10
    v_fmac_f32 v11, v12, v12
    v_sub_f32 v12, v209, v10
    v_fmac_f32 v11, v12, v12
    v_sub_f32 v12, v210, v10
    v_fmac_f32 v11, v12, v12
    v_sub_f32 v12, v211, v10
    v_fmac_f32 v11, v12, v12
    v_sub_f32 v12, v212, v10
    v_fmac_f32 v11, v12, v12
    v_sub_f32 v12, v213, v10
    v_fmac_f32 v11, v12, v12
    v_sub_f32 v12, v214, v10
    v_fmac_f32 v11, v12, v12
    v_sub_f32 v12, v215, v10
    v_fmac_f32 v11, v12, v12
    v_sub_f32 v12, v216, v10
    v_fmac_f32 v11, v12, v12
    v_sub_f32 v12, v217, v10
    v_fmac_f32 v11, v12, v12
    v_sub_f32 v12, v218, v10
    v_fmac_f32 v11, v12, v12
    v_sub_f32 v12, v219, v10
    v_fmac_f32 v11, v12, v12
    v_sub_f32 v12, v220, v10
    v_fmac_f32 v11, v12, v12
    v_sub_f32 v12, v221, v10
    v_fmac_f32 v11, v12, v12
    v_sub_f32 v12, v222, v10
    v_fmac_f32 v11, v12, v12
    v_sub_f32 v12, v223, v10
    v_fmac_f32 v11, v12, v12
    v_sub_f32 v12, v224, v10
    v_fmac_f32 v11, v12, v12
    v_sub_f32 v12, v225, v10
    v_fmac_f32 v11, v12, v12
    s_nop 1
    v_add_f32_dpp v11, v11, v11 quad_perm:[1,0,3,2] row_mask:0xf bank_mask:0xf
    s_nop 1
    v_add_f32_dpp v11, v11, v11 quad_perm:[2,3,0,1] row_mask:0xf bank_mask:0xf
    s_nop 1
    v_add_f32_dpp v11, v11, v11 row_half_mirror row_mask:0xf bank_mask:0xf
    s_nop 1
    v_mov_b32 v12, 0x3727c5ac
    v_fmac_f32 v12, 0x3b124925, v11
    v_rsq_f32 v12, v12
    s_nop 1
    v_mul_f32 v11, v10, v12
    v_sub_f32 v11, 0, v11
    v_mov_b32 v10, v12
    v_mul_u32_u24 v3, 928, v1
    v_mul_u32_u24 v4, 112, v2
    v_add_u32 v3, v3, v4
    v_mul_u32_u24 v4, 224, v2
    v_add_u32 v4, 29696, v4
    ds_read_b128 v[20:23], v3 offset:0
    ds_read_b128 v[24:27], v4 offset:0
    ds_read_b128 v[28:31], v4 offset:16
    ds_read_b128 v[32:35], v4 offset:1792
    ds_read_b128 v[36:39], v4 offset:1808
    ds_read_b128 v[40:43], v4 offset:3584
    ds_read_b128 v[44:47], v4 offset:3600
    s_waitcnt lgkmcnt(0)
    v_fma_f32 v12, v170, v10, v11
    v_fma_f32 v12, v12, v32, v24
    v_lshlrev_b32 v13, 16, v20
    v_mul_f32 v12, v12, v13
    v_fma_f32 v170, v12, v40, v170
    v_fma_f32 v12, v171, v10, v11
    v_fma_f32 v12, v12, v33, v25
    v_and_b32 v13, 0xffff0000, v20
    v_mul_f32 v12, v12, v13
    v_fma_f32 v171, v12, v41, v171
    v_fma_f32 v12, v172, v10, v11
    v_fma_f32 v12, v12, v34, v26
    v_lshlrev_b32 v13, 16, v21
    v_mul_f32 v12, v12, v13
    v_fma_f32 v172, v12, v42, v172
    v_fma_f32 v12, v173, v10, v11
    v_fma_f32 v12, v12, v35, v27
    v_and_b32 v13, 0xffff0000, v21
    v_mul_f32 v12, v12, v13
    v_fma_f32 v173, v12, v43, v173
    v_fma_f32 v12, v174, v10, v11
    v_fma_f32 v12, v12, v36, v28
    v_lshlrev_b32 v13, 16, v22
    v_mul_f32 v12, v12, v13
    v_fma_f32 v174, v12, v44, v174
    v_fma_f32 v12, v175, v10, v11
    v_fma_f32 v12, v12, v37, v29
    v_and_b32 v13, 0xffff0000, v22
    v_mul_f32 v12, v12, v13
    v_fma_f32 v175, v12, v45, v175
    v_fma_f32 v12, v176, v10, v11
    v_fma_f32 v12, v12, v38, v30
    v_lshlrev_b32 v13, 16, v23
    v_mul_f32 v12, v12, v13
    v_fma_f32 v176, v12, v46, v176
    v_fma_f32 v12, v177, v10, v11
    v_fma_f32 v12, v12, v39, v31
    v_and_b32 v13, 0xffff0000, v23
    v_mul_f32 v12, v12, v13
    v_fma_f32 v177, v12, v47, v177
    v_cvt_pk_bf16_f32 v100, v170, v171
    v_lshlrev_b32 v170, 16, v100
    v_and_b32 v171, 0xffff0000, v100
    v_cvt_pk_bf16_f32 v101, v172, v173
    v_lshlrev_b32 v172, 16, v101
    v_and_b32 v173, 0xffff0000, v101
    v_cvt_pk_bf16_f32 v102, v174, v175
    v_lshlrev_b32 v174, 16, v102
    v_and_b32 v175, 0xffff0000, v102
    v_cvt_pk_bf16_f32 v103, v176, v177
    v_lshlrev_b32 v176, 16, v103
    v_and_b32 v177, 0xffff0000, v103
    ds_read_b128 v[20:23], v3 offset:16
    ds_read_b128 v[24:27], v4 offset:32
    ds_read_b128 v[28:31], v4 offset:48
    ds_read_b128 v[32:35], v4 offset:1824
    ds_read_b128 v[36:39], v4 offset:1840
    ds_read_b128 v[40:43], v4 offset:3616
    ds_read_b128 v[44:47], v4 offset:3632
    s_waitcnt lgkmcnt(0)
    v_fma_f32 v12, v178, v10, v11
    v_fma_f32 v12, v12, v32, v24
    v_lshlrev_b32 v13, 16, v20
    v_mul_f32 v12, v12, v13
    v_fma_f32 v178, v12, v40, v178
    v_fma_f32 v12, v179, v10, v11
    v_fma_f32 v12, v12, v33, v25
    v_and_b32 v13, 0xffff0000, v20
    v_mul_f32 v12, v12, v13
    v_fma_f32 v179, v12, v41, v179
    v_fma_f32 v12, v180, v10, v11
    v_fma_f32 v12, v12, v34, v26
    v_lshlrev_b32 v13, 16, v21
    v_mul_f32 v12, v12, v13
    v_fma_f32 v180, v12, v42, v180
    v_fma_f32 v12, v181, v10, v11
    v_fma_f32 v12, v12, v35, v27
    v_and_b32 v13, 0xffff0000, v21
    v_mul_f32 v12, v12, v13
    v_fma_f32 v181, v12, v43, v181
    v_fma_f32 v12, v182, v10, v11
    v_fma_f32 v12, v12, v36, v28
    v_lshlrev_b32 v13, 16, v22
    v_mul_f32 v12, v12, v13
    v_fma_f32 v182, v12, v44, v182
    v_fma_f32 v12, v183, v10, v11
    v_fma_f32 v12, v12, v37, v29
    v_and_b32 v13, 0xffff0000, v22
    v_mul_f32 v12, v12, v13
    v_fma_f32 v183, v12, v45, v183
    v_fma_f32 v12, v184, v10, v11
    v_fma_f32 v12, v12, v38, v30
    v_lshlrev_b32 v13, 16, v23
    v_mul_f32 v12, v12, v13
    v_fma_f32 v184, v12, v46, v184
    v_fma_f32 v12, v185, v10, v11
    v_fma_f32 v12, v12, v39, v31
    v_and_b32 v13, 0xffff0000, v23
    v_mul_f32 v12, v12, v13
    v_fma_f32 v185, v12, v47, v185
    v_cvt_pk_bf16_f32 v104, v178, v179
    v_lshlrev_b32 v178, 16, v104
    v_and_b32 v179, 0xffff0000, v104
    v_cvt_pk_bf16_f32 v105, v180, v181
    v_lshlrev_b32 v180, 16, v105
    v_and_b32 v181, 0xffff0000, v105
    v_cvt_pk_bf16_f32 v106, v182, v183
    v_lshlrev_b32 v182, 16, v106
    v_and_b32 v183, 0xffff0000, v106
    v_cvt_pk_bf16_f32 v107, v184, v185
    v_lshlrev_b32 v184, 16, v107
    v_and_b32 v185, 0xffff0000, v107
    ds_read_b128 v[20:23], v3 offset:32
    ds_read_b128 v[24:27], v4 offset:64
    ds_read_b128 v[28:31], v4 offset:80
    ds_read_b128 v[32:35], v4 offset:1856
    ds_read_b128 v[36:39], v4 offset:1872
    ds_read_b128 v[40:43], v4 offset:3648
    ds_read_b128 v[44:47], v4 offset:3664
    s_waitcnt lgkmcnt(0)
    v_fma_f32 v12, v186, v10, v11
    v_fma_f32 v12, v12, v32, v24
    v_lshlrev_b32 v13, 16, v20
    v_mul_f32 v12, v12, v13
    v_fma_f32 v186, v12, v40, v186
    v_fma_f32 v12, v187, v10, v11
    v_fma_f32 v12, v12, v33, v25
    v_and_b32 v13, 0xffff0000, v20
    v_mul_f32 v12, v12, v13
    v_fma_f32 v187, v12, v41, v187
    v_fma_f32 v12, v188, v10, v11
    v_fma_f32 v12, v12, v34, v26
    v_lshlrev_b32 v13, 16, v21
    v_mul_f32 v12, v12, v13
    v_fma_f32 v188, v12, v42, v188
    v_fma_f32 v12, v189, v10, v11
    v_fma_f32 v12, v12, v35, v27
    v_and_b32 v13, 0xffff0000, v21
    v_mul_f32 v12, v12, v13
    v_fma_f32 v189, v12, v43, v189
    v_fma_f32 v12, v190, v10, v11
    v_fma_f32 v12, v12, v36, v28
    v_lshlrev_b32 v13, 16, v22
    v_mul_f32 v12, v12, v13
    v_fma_f32 v190, v12, v44, v190
    v_fma_f32 v12, v191, v10, v11
    v_fma_f32 v12, v12, v37, v29
    v_and_b32 v13, 0xffff0000, v22
    v_mul_f32 v12, v12, v13
    v_fma_f32 v191, v12, v45, v191
    v_fma_f32 v12, v192, v10, v11
    v_fma_f32 v12, v12, v38, v30
    v_lshlrev_b32 v13, 16, v23
    v_mul_f32 v12, v12, v13
    v_fma_f32 v192, v12, v46, v192
    v_fma_f32 v12, v193, v10, v11
    v_fma_f32 v12, v12, v39, v31
    v_and_b32 v13, 0xffff0000, v23
    v_mul_f32 v12, v12, v13
    v_fma_f32 v193, v12, v47, v193
    v_cvt_pk_bf16_f32 v108, v186, v187
    v_lshlrev_b32 v186, 16, v108
    v_and_b32 v187, 0xffff0000, v108
    v_cvt_pk_bf16_f32 v109, v188, v189
    v_lshlrev_b32 v188, 16, v109
    v_and_b32 v189, 0xffff0000, v109
    v_cvt_pk_bf16_f32 v110, v190, v191
    v_lshlrev_b32 v190, 16, v110
    v_and_b32 v191, 0xffff0000, v110
    v_cvt_pk_bf16_f32 v111, v192, v193
    v_lshlrev_b32 v192, 16, v111
    v_and_b32 v193, 0xffff0000, v111
    ds_read_b128 v[20:23], v3 offset:48
    ds_read_b128 v[24:27], v4 offset:96
    ds_read_b128 v[28:31], v4 offset:112
    ds_read_b128 v[32:35], v4 offset:1888
    ds_read_b128 v[36:39], v4 offset:1904
    ds_read_b128 v[40:43], v4 offset:3680
    ds_read_b128 v[44:47], v4 offset:3696
    s_waitcnt lgkmcnt(0)
    v_fma_f32 v12, v194, v10, v11
    v_fma_f32 v12, v12, v32, v24
    v_lshlrev_b32 v13, 16, v20
    v_mul_f32 v12, v12, v13
    v_fma_f32 v194, v12, v40, v194
    v_fma_f32 v12, v195, v10, v11
    v_fma_f32 v12, v12, v33, v25
    v_and_b32 v13, 0xffff0000, v20
    v_mul_f32 v12, v12, v13
    v_fma_f32 v195, v12, v41, v195
    v_fma_f32 v12, v196, v10, v11
    v_fma_f32 v12, v12, v34, v26
    v_lshlrev_b32 v13, 16, v21
    v_mul_f32 v12, v12, v13
    v_fma_f32 v196, v12, v42, v196
    v_fma_f32 v12, v197, v10, v11
    v_fma_f32 v12, v12, v35, v27
    v_and_b32 v13, 0xffff0000, v21
    v_mul_f32 v12, v12, v13
    v_fma_f32 v197, v12, v43, v197
    v_fma_f32 v12, v198, v10, v11
    v_fma_f32 v12, v12, v36, v28
    v_lshlrev_b32 v13, 16, v22
    v_mul_f32 v12, v12, v13
    v_fma_f32 v198, v12, v44, v198
    v_fma_f32 v12, v199, v10, v11
    v_fma_f32 v12, v12, v37, v29
    v_and_b32 v13, 0xffff0000, v22
    v_mul_f32 v12, v12, v13
    v_fma_f32 v199, v12, v45, v199
    v_fma_f32 v12, v200, v10, v11
    v_fma_f32 v12, v12, v38, v30
    v_lshlrev_b32 v13, 16, v23
    v_mul_f32 v12, v12, v13
    v_fma_f32 v200, v12, v46, v200
    v_fma_f32 v12, v201, v10, v11
    v_fma_f32 v12, v12, v39, v31
    v_and_b32 v13, 0xffff0000, v23
    v_mul_f32 v12, v12, v13
    v_fma_f32 v201, v12, v47, v201
    v_cvt_pk_bf16_f32 v112, v194, v195
    v_lshlrev_b32 v194, 16, v112
    v_and_b32 v195, 0xffff0000, v112
    v_cvt_pk_bf16_f32 v113, v196, v197
    v_lshlrev_b32 v196, 16, v113
    v_and_b32 v197, 0xffff0000, v113
    v_cvt_pk_bf16_f32 v114, v198, v199
    v_lshlrev_b32 v198, 16, v114
    v_and_b32 v199, 0xffff0000, v114
    v_cvt_pk_bf16_f32 v115, v200, v201
    v_lshlrev_b32 v200, 16, v115
    v_and_b32 v201, 0xffff0000, v115
    ds_read_b128 v[20:23], v3 offset:64
    ds_read_b128 v[24:27], v4 offset:128
    ds_read_b128 v[28:31], v4 offset:144
    ds_read_b128 v[32:35], v4 offset:1920
    ds_read_b128 v[36:39], v4 offset:1936
    ds_read_b128 v[40:43], v4 offset:3712
    ds_read_b128 v[44:47], v4 offset:3728
    s_waitcnt lgkmcnt(0)
    v_fma_f32 v12, v202, v10, v11
    v_fma_f32 v12, v12, v32, v24
    v_lshlrev_b32 v13, 16, v20
    v_mul_f32 v12, v12, v13
    v_fma_f32 v202, v12, v40, v202
    v_fma_f32 v12, v203, v10, v11
    v_fma_f32 v12, v12, v33, v25
    v_and_b32 v13, 0xffff0000, v20
    v_mul_f32 v12, v12, v13
    v_fma_f32 v203, v12, v41, v203
    v_fma_f32 v12, v204, v10, v11
    v_fma_f32 v12, v12, v34, v26
    v_lshlrev_b32 v13, 16, v21
    v_mul_f32 v12, v12, v13
    v_fma_f32 v204, v12, v42, v204
    v_fma_f32 v12, v205, v10, v11
    v_fma_f32 v12, v12, v35, v27
    v_and_b32 v13, 0xffff0000, v21
    v_mul_f32 v12, v12, v13
    v_fma_f32 v205, v12, v43, v205
    v_fma_f32 v12, v206, v10, v11
    v_fma_f32 v12, v12, v36, v28
    v_lshlrev_b32 v13, 16, v22
    v_mul_f32 v12, v12, v13
    v_fma_f32 v206, v12, v44, v206
    v_fma_f32 v12, v207, v10, v11
    v_fma_f32 v12, v12, v37, v29
    v_and_b32 v13, 0xffff0000, v22
    v_mul_f32 v12, v12, v13
    v_fma_f32 v207, v12, v45, v207
    v_fma_f32 v12, v208, v10, v11
    v_fma_f32 v12, v12, v38, v30
    v_lshlrev_b32 v13, 16, v23
    v_mul_f32 v12, v12, v13
    v_fma_f32 v208, v12, v46, v208
    v_fma_f32 v12, v209, v10, v11
    v_fma_f32 v12, v12, v39, v31
    v_and_b32 v13, 0xffff0000, v23
    v_mul_f32 v12, v12, v13
    v_fma_f32 v209, v12, v47, v209
    v_cvt_pk_bf16_f32 v116, v202, v203
    v_lshlrev_b32 v202, 16, v116
    v_and_b32 v203, 0xffff0000, v116
    v_cvt_pk_bf16_f32 v117, v204, v205
    v_lshlrev_b32 v204, 16, v117
    v_and_b32 v205, 0xffff0000, v117
    v_cvt_pk_bf16_f32 v118, v206, v207
    v_lshlrev_b32 v206, 16, v118
    v_and_b32 v207, 0xffff0000, v118
    v_cvt_pk_bf16_f32 v119, v208, v209
    v_lshlrev_b32 v208, 16, v119
    v_and_b32 v209, 0xffff0000, v119
    ds_read_b128 v[20:23], v3 offset:80
    ds_read_b128 v[24:27], v4 offset:160
    ds_read_b128 v[28:31], v4 offset:176
    ds_read_b128 v[32:35], v4 offset:1952
    ds_read_b128 v[36:39], v4 offset:1968
    ds_read_b128 v[40:43], v4 offset:3744
    ds_read_b128 v[44:47], v4 offset:3760
    s_waitcnt lgkmcnt(0)
    v_fma_f32 v12, v210, v10, v11
    v_fma_f32 v12, v12, v32, v24
    v_lshlrev_b32 v13, 16, v20
    v_mul_f32 v12, v12, v13
    v_fma_f32 v210, v12, v40, v210
    v_fma_f32 v12, v211, v10, v11
    v_fma_f32 v12, v12, v33, v25
    v_and_b32 v13, 0xffff0000, v20
    v_mul_f32 v12, v12, v13
    v_fma_f32 v211, v12, v41, v211
    v_fma_f32 v12, v212, v10, v11
    v_fma_f32 v12, v12, v34, v26
    v_lshlrev_b32 v13, 16, v21
    v_mul_f32 v12, v12, v13
    v_fma_f32 v212, v12, v42, v212
    v_fma_f32 v12, v213, v10, v11
    v_fma_f32 v12, v12, v35, v27
    v_and_b32 v13, 0xffff0000, v21
    v_mul_f32 v12, v12, v13
    v_fma_f32 v213, v12, v43, v213
    v_fma_f32 v12, v214, v10, v11
    v_fma_f32 v12, v12, v36, v28
    v_lshlrev_b32 v13, 16, v22
    v_mul_f32 v12, v12, v13
    v_fma_f32 v214, v12, v44, v214
    v_fma_f32 v12, v215, v10, v11
    v_fma_f32 v12, v12, v37, v29
    v_and_b32 v13, 0xffff0000, v22
    v_mul_f32 v12, v12, v13
    v_fma_f32 v215, v12, v45, v215
    v_fma_f32 v12, v216, v10, v11
    v_fma_f32 v12, v12, v38, v30
    v_lshlrev_b32 v13, 16, v23
    v_mul_f32 v12, v12, v13
    v_fma_f32 v216, v12, v46, v216
    v_fma_f32 v12, v217, v10, v11
    v_fma_f32 v12, v12, v39, v31
    v_and_b32 v13, 0xffff0000, v23
    v_mul_f32 v12, v12, v13
    v_fma_f32 v217, v12, v47, v217
    v_cvt_pk_bf16_f32 v120, v210, v211
    v_lshlrev_b32 v210, 16, v120
    v_and_b32 v211, 0xffff0000, v120
    v_cvt_pk_bf16_f32 v121, v212, v213
    v_lshlrev_b32 v212, 16, v121
    v_and_b32 v213, 0xffff0000, v121
    v_cvt_pk_bf16_f32 v122, v214, v215
    v_lshlrev_b32 v214, 16, v122
    v_and_b32 v215, 0xffff0000, v122
    v_cvt_pk_bf16_f32 v123, v216, v217
    v_lshlrev_b32 v216, 16, v123
    v_and_b32 v217, 0xffff0000, v123
    ds_read_b128 v[20:23], v3 offset:96
    ds_read_b128 v[24:27], v4 offset:192
    ds_read_b128 v[28:31], v4 offset:208
    ds_read_b128 v[32:35], v4 offset:1984
    ds_read_b128 v[36:39], v4 offset:2000
    ds_read_b128 v[40:43], v4 offset:3776
    ds_read_b128 v[44:47], v4 offset:3792
    s_waitcnt lgkmcnt(0)
    v_fma_f32 v12, v218, v10, v11
    v_fma_f32 v12, v12, v32, v24
    v_lshlrev_b32 v13, 16, v20
    v_mul_f32 v12, v12, v13
    v_fma_f32 v218, v12, v40, v218
    v_fma_f32 v12, v219, v10, v11
    v_fma_f32 v12, v12, v33, v25
    v_and_b32 v13, 0xffff0000, v20
    v_mul_f32 v12, v12, v13
    v_fma_f32 v219, v12, v41, v219
    v_fma_f32 v12, v220, v10, v11
    v_fma_f32 v12, v12, v34, v26
    v_lshlrev_b32 v13, 16, v21
    v_mul_f32 v12, v12, v13
    v_fma_f32 v220, v12, v42, v220
    v_fma_f32 v12, v221, v10, v11
    v_fma_f32 v12, v12, v35, v27
    v_and_b32 v13, 0xffff0000, v21
    v_mul_f32 v12, v12, v13
    v_fma_f32 v221, v12, v43, v221
    v_fma_f32 v12, v222, v10, v11
    v_fma_f32 v12, v12, v36, v28
    v_lshlrev_b32 v13, 16, v22
    v_mul_f32 v12, v12, v13
    v_fma_f32 v222, v12, v44, v222
    v_fma_f32 v12, v223, v10, v11
    v_fma_f32 v12, v12, v37, v29
    v_and_b32 v13, 0xffff0000, v22
    v_mul_f32 v12, v12, v13
    v_fma_f32 v223, v12, v45, v223
    v_fma_f32 v12, v224, v10, v11
    v_fma_f32 v12, v12, v38, v30
    v_lshlrev_b32 v13, 16, v23
    v_mul_f32 v12, v12, v13
    v_fma_f32 v224, v12, v46, v224
    v_fma_f32 v12, v225, v10, v11
    v_fma_f32 v12, v12, v39, v31
    v_and_b32 v13, 0xffff0000, v23
    v_mul_f32 v12, v12, v13
    v_fma_f32 v225, v12, v47, v225
    v_cvt_pk_bf16_f32 v124, v218, v219
    v_lshlrev_b32 v218, 16, v124
    v_and_b32 v219, 0xffff0000, v124
    v_cvt_pk_bf16_f32 v125, v220, v221
    v_lshlrev_b32 v220, 16, v125
    v_and_b32 v221, 0xffff0000, v125
    v_cvt_pk_bf16_f32 v126, v222, v223
    v_lshlrev_b32 v222, 16, v126
    v_and_b32 v223, 0xffff0000, v126
    v_cvt_pk_bf16_f32 v127, v224, v225
    v_lshlrev_b32 v224, 16, v127
    v_and_b32 v225, 0xffff0000, v127
    s_cmp_lg_u32 s40, 0
    s_cbranch_scc1 K2_NOX1
    v_add_u32 v5, s42, v1
    v_mul_u32_u24 v5, 896, v5
    v_mul_u32_u24 v6, 112, v2
    v_add_u32 v5, v5, v6
    s_mov_b32 s43, 4259840
    buffer_store_dwordx4 v[100:103], v5, s[28:31], s43 offen offset:0
    buffer_store_dwordx4 v[104:107], v5, s[28:31], s43 offen offset:16
    buffer_store_dwordx4 v[108:111], v5, s[28:31], s43 offen offset:32
    buffer_store_dwordx4 v[112:115], v5, s[28:31], s43 offen offset:48
    buffer_store_dwordx4 v[116:119], v5, s[28:31], s43 offen offset:64
    buffer_store_dwordx4 v[120:123], v5, s[28:31], s43 offen offset:80
    buffer_store_dwordx4 v[124:127], v5, s[28:31], s43 offen offset:96
K2_NOX1:
    v_add_f32 v10, v170, v171
    v_add_f32 v10, v10, v172
    v_add_f32 v10, v10, v173
    v_add_f32 v10, v10, v174
    v_add_f32 v10, v10, v175
    v_add_f32 v10, v10, v176
    v_add_f32 v10, v10, v177
    v_add_f32 v10, v10, v178
    v_add_f32 v10, v10, v179
    v_add_f32 v10, v10, v180
    v_add_f32 v10, v10, v181
    v_add_f32 v10, v10, v182
    v_add_f32 v10, v10, v183
    v_add_f32 v10, v10, v184
    v_add_f32 v10, v10, v185
    v_add_f32 v10, v10, v186
    v_add_f32 v10, v10, v187
    v_add_f32 v10, v10, v188
    v_add_f32 v10, v10, v189
    v_add_f32 v10, v10, v190
    v_add_f32 v10, v10, v191
    v_add_f32 v10, v10, v192
    v_add_f32 v10, v10, v193
    v_add_f32 v10, v10, v194
    v_add_f32 v10, v10, v195
    v_add_f32 v10, v10, v196
    v_add_f32 v10, v10, v197
    v_add_f32 v10, v10, v198
    v_add_f32 v10, v10, v199
    v_add_f32 v10, v10, v200
    v_add_f32 v10, v10, v201
    v_add_f32 v10, v10, v202
    v_add_f32 v10, v10, v203
    v_add_f32 v10, v10, v204
    v_add_f32 v10, v10, v205
    v_add_f32 v10, v10, v206
    v_add_f32 v10, v10, v207
    v_add_f32 v10, v10, v208
    v_add_f32 v10, v10, v209
    v_add_f32 v10, v10, v210
    v_add_f32 v10, v10, v211
    v_add_f32 v10, v10, v212
    v_add_f32 v10, v10, v213
    v_add_f32 v10, v10, v214
    v_add_f32 v10, v10, v215
    v_add_f32 v10, v10, v216
    v_add_f32 v10, v10, v217
    v_add_f32 v10, v10, v218
    v_add_f32 v10, v10, v219
    v_add_f32 v10, v10, v220
    v_add_f32 v10, v10, v221
    v_add_f32 v10, v10, v222
    v_add_f32 v10, v10, v223
    v_add_f32 v10, v10, v224
    v_add_f32 v10, v10, v225
    s_nop 1
    v_add_f32_dpp v10, v10, v10 quad_perm:[1,0,3,2] row_mask:0xf bank_mask:0xf
    s_nop 1
    v_add_f32_dpp v10, v10, v10 quad_perm:[2,3,0,1] row_mask:0xf bank_mask:0xf
    s_nop 1
    v_add_f32_dpp v10, v10, v10 row_half_mirror row_mask:0xf bank_mask:0xf
    s_nop 1
    v_mul_f32 v10, 0x3b124925, v10
    v_mov_b32 v11, 0
    v_sub_f32 v12, v170, v10
    v_fmac_f32 v11, v12, v12
    v_sub_f32 v12, v171, v10
    v_fmac_f32 v11, v12, v12
    v_sub_f32 v12, v172, v10
    v_fmac_f32 v11, v12, v12
    v_sub_f32 v12, v173, v10
    v_fmac_f32 v11, v12, v12
    v_sub_f32 v12, v174, v10
    v_fmac_f32 v11, v12, v12
    v_sub_f32 v12, v175, v10
    v_fmac_f32 v11, v12, v12
    v_sub_f32 v12, v176, v10
    v_fmac_f32 v11, v12, v12
    v_sub_f32 v12, v177, v10
    v_fmac_f32 v11, v12, v12
    v_sub_f32 v12, v178, v10
    v_fmac_f32 v11, v12, v12
    v_sub_f32 v12, v179, v10
    v_fmac_f32 v11, v12, v12
    v_sub_f32 v12, v180, v10
    v_fmac_f32 v11, v12, v12
    v_sub_f32 v12, v181, v10
    v_fmac_f32 v11, v12, v12
    v_sub_f32 v12, v182, v10
    v_fmac_f32 v11, v12, v12
    v_sub_f32 v12, v183, v10
    v_fmac_f32 v11, v12, v12
    v_sub_f32 v12, v184, v10
    v_fmac_f32 v11, v12, v12
    v_sub_f32 v12, v185, v10
    v_fmac_f32 v11, v12, v12
    v_sub_f32 v12, v186, v10
    v_fmac_f32 v11, v12, v12
    v_sub_f32 v12, v187, v10
    v_fmac_f32 v11, v12, v12
    v_sub_f32 v12, v188, v10
    v_fmac_f32 v11, v12, v12
    v_sub_f32 v12, v189, v10
    v_fmac_f32 v11, v12, v12
    v_sub_f32 v12, v190, v10
    v_fmac_f32 v11, v12, v12
    v_sub_f32 v12, v191, v10
    v_fmac_f32 v11, v12, v12
    v_sub_f32 v12, v192, v10
    v_fmac_f32 v11, v12, v12
    v_sub_f32 v12, v193, v10
    v_fmac_f32 v11, v12, v12
    v_sub_f32 v12, v194, v10
    v_fmac_f32 v11, v12, v12
    v_sub_f32 v12, v195, v10
    v_fmac_f32 v11, v12, v12
    v_sub_f32 v12, v196, v10
    v_fmac_f32 v11, v12, v12
    v_sub_f32 v12, v197, v10
    v_fmac_f32 v11, v12, v12
    v_sub_f32 v12, v198, v10
    v_fmac_f32 v11, v12, v12
    v_sub_f32 v12, v199, v10
    v_fmac_f32 v11, v12, v12
    v_sub_f32 v12, v200, v10
    v_fmac_f32 v11, v12, v12
    v_sub_f32 v12, v201, v10
    v_fmac_f32 v11, v12, v12
    v_sub_f32 v12, v202, v10
    v_fmac_f32 v11, v12, v12
    v_sub_f32 v12, v203, v10
    v_fmac_f32 v11, v12, v12
    v_sub_f32 v12, v204, v10
    v_fmac_f32 v11, v12, v12
    v_sub_f32 v12, v205, v10
    v_fmac_f32 v11, v12, v12
    v_sub_f32 v12, v206, v10
    v_fmac_f32 v11, v12, v12
    v_sub_f32 v12, v207, v10
    v_fmac_f32 v11, v12, v12
    v_sub_f32 v12, v208, v10
    v_fmac_f32 v11, v12, v12
    v_sub_f32 v12, v209, v10
    v_fmac_f32 v11, v12, v12
    v_sub_f32 v12, v210, v10
    v_fmac_f32 v11, v12, v12
    v_sub_f32 v12, v211, v10
    v_fmac_f32 v11, v12, v12
    v_sub_f32 v12, v212, v10
    v_fmac_f32 v11, v12, v12
    v_sub_f32 v12, v213, v10
    v_fmac_f32 v11, v12, v12
    v_sub_f32 v12, v214, v10
    v_fmac_f32 v11, v12, v12
    v_sub_f32 v12, v215, v10
    v_fmac_f32 v11, v12, v12
    v_sub_f32 v12, v216, v10
    v_fmac_f32 v11, v12, v12
    v_sub_f32 v12, v217, v10
    v_fmac_f32 v11, v12, v12
    v_sub_f32 v12, v218, v10
    v_fmac_f32 v11, v12, v12
    v_sub_f32 v12, v219, v10
    v_fmac_f32 v11, v12, v12
    v_sub_f32 v12, v220, v10
    v_fmac_f32 v11, v12, v12
    v_sub_f32 v12, v221, v10
    v_fmac_f32 v11, v12, v12
    v_sub_f32 v12, v222, v10
    v_fmac_f32 v11, v12, v12
    v_sub_f32 v12, v223, v10
    v_fmac_f32 v11, v12, v12
    v_sub_f32 v12, v224, v10
    v_fmac_f32 v11, v12, v12
    v_sub_f32 v12, v225, v10
    v_fmac_f32 v11, v12, v12
    s_nop 1
    v_add_f32_dpp v11, v11, v11 quad_perm:[1,0,3,2] row_mask:0xf bank_mask:0xf
    s_nop 1
    v_add_f32_dpp v11, v11, v11 quad_perm:[2,3,0,1] row_mask:0xf bank_mask:0xf
    s_nop 1
    v_add_f32_dpp v11, v11, v11 row_half_mirror row_mask:0xf bank_mask:0xf
    s_nop 1
    v_mov_b32 v12, 0x3727c5ac
    v_fmac_f32 v12, 0x3b124925, v11
    v_rsq_f32 v12, v12
    s_nop 1
    v_mul_f32 v11, v10, v12
    v_sub_f32 v11, 0, v11
    v_mov_b32 v10, v12
    ds_read_b128 v[24:27], v4 offset:5376
    ds_read_b128 v[28:31], v4 offset:5392
    ds_read_b128 v[32:35], v4 offset:7168
    ds_read_b128 v[36:39], v4 offset:7184
    s_waitcnt lgkmcnt(0)
    v_fma_f32 v12, v170, v10, v11
    v_fma_f32 v170, v12, v32, v24
    v_fma_f32 v12, v171, v10, v11
    v_fma_f32 v171, v12, v33, v25
    v_fma_f32 v12, v172, v10, v11
    v_fma_f32 v172, v12, v34, v26
    v_fma_f32 v12, v173, v10, v11
    v_fma_f32 v173, v12, v35, v27
    v_fma_f32 v12, v174, v10, v11
    v_fma_f32 v174, v12, v36, v28
    v_fma_f32 v12, v175, v10, v11
    v_fma_f32 v175, v12, v37, v29
    v_fma_f32 v12, v176, v10, v11
    v_fma_f32 v176, v12, v38, v30
    v_fma_f32 v12, v177, v10, v11
    v_fma_f32 v177, v12, v39, v31
    v_cvt_pk_bf16_f32 v20, v170, v171
    v_cvt_pk_bf16_f32 v21, v172, v173
    v_cvt_pk_bf16_f32 v22, v174, v175
    v_cvt_pk_bf16_f32 v23, v176, v177
    ds_write_b128 v3, v[20:23] offset:0
    ds_read_b128 v[24:27], v4 offset:5408
    ds_read_b128 v[28:31], v4 offset:5424
    ds_read_b128 v[32:35], v4 offset:7200
    ds_read_b128 v[36:39], v4 offset:7216
    s_waitcnt lgkmcnt(0)
    v_fma_f32 v12, v178, v10, v11
    v_fma_f32 v178, v12, v32, v24
    v_fma_f32 v12, v179, v10, v11
    v_fma_f32 v179, v12, v33, v25
    v_fma_f32 v12, v180, v10, v11
    v_fma_f32 v180, v12, v34, v26
    v_fma_f32 v12, v181, v10, v11
    v_fma_f32 v181, v12, v35, v27
    v_fma_f32 v12, v182, v10, v11
    v_fma_f32 v182, v12, v36, v28
    v_fma_f32 v12, v183, v10, v11
    v_fma_f32 v183, v12, v37, v29
    v_fma_f32 v12, v184, v10, v11
    v_fma_f32 v184, v12, v38, v30
    v_fma_f32 v12, v185, v10, v11
    v_fma_f32 v185, v12, v39, v31
    v_cvt_pk_bf16_f32 v20, v178, v179
    v_cvt_pk_bf16_f32 v21, v180, v181
    v_cvt_pk_bf16_f32 v22, v182, v183
    v_cvt_pk_bf16_f32 v23, v184, v185
    ds_write_b128 v3, v[20:23] offset:16
    ds_read_b128 v[24:27], v4 offset:5440
    ds_read_b128 v[28:31], v4 offset:5456
    ds_read_b128 v[32:35], v4 offset:7232
    ds_read_b128 v[36:39], v4 offset:7248
    s_waitcnt lgkmcnt(0)
    v_fma_f32 v12, v186, v10, v11
    v_fma_f32 v186, v12, v32, v24
    v_fma_f32 v12, v187, v10, v11
    v_fma_f32 v187, v12, v33, v25
    v_fma_f32 v12, v188, v10, v11
    v_fma_f32 v188, v12, v34, v26
    v_fma_f32 v12, v189, v10, v11
    v_fma_f32 v189, v12, v35, v27
    v_fma_f32 v12, v190, v10, v11
    v_fma_f32 v190, v12, v36, v28
    v_fma_f32 v12, v191, v10, v11
    v_fma_f32 v191, v12, v37, v29
    v_fma_f32 v12, v192, v10, v11
    v_fma_f32 v192, v12, v38, v30
    v_fma_f32 v12, v193, v10, v11
    v_fma_f32 v193, v12, v39, v31
    v_cvt_pk_bf16_f32 v20, v186, v187
    v_cvt_pk_bf16_f32 v21, v188, v189
    v_cvt_pk_bf16_f32 v22, v190, v191
    v_cvt_pk_bf16_f32 v23, v192, v193
    ds_write_b128 v3, v[20:23] offset:32
    ds_read_b128 v[24:27], v4 offset:5472
    ds_read_b128 v[28:31], v4 offset:5488
    ds_read_b128 v[32:35], v4 offset:7264
    ds_read_b128 v[36:39], v4 offset:7280
    s_waitcnt lgkmcnt(0)
    v_fma_f32 v12, v194, v10, v11
    v_fma_f32 v194, v12, v32, v24
    v_fma_f32 v12, v195, v10, v11
    v_fma_f32 v195, v12, v33, v25
    v_fma_f32 v12, v196, v10, v11
    v_fma_f32 v196, v12, v34, v26
    v_fma_f32 v12, v197, v10, v11
    v_fma_f32 v197, v12, v35, v27
    v_fma_f32 v12, v198, v10, v11
    v_fma_f32 v198, v12, v36, v28
    v_fma_f32 v12, v199, v10, v11
    v_fma_f32 v199, v12, v37, v29
    v_fma_f32 v12, v200, v10, v11
    v_fma_f32 v200, v12, v38, v30
    v_fma_f32 v12, v201, v10, v11
    v_fma_f32 v201, v12, v39, v31
    v_cvt_pk_bf16_f32 v20, v194, v195
    v_cvt_pk_bf16_f32 v21, v196, v197
    v_cvt_pk_bf16_f32 v22, v198, v199
    v_cvt_pk_bf16_f32 v23, v200, v201
    ds_write_b128 v3, v[20:23] offset:48
    ds_read_b128 v[24:27], v4 offset:5504
    ds_read_b128 v[28:31], v4 offset:5520
    ds_read_b128 v[32:35], v4 offset:7296
    ds_read_b128 v[36:39], v4 offset:7312
    s_waitcnt lgkmcnt(0)
    v_fma_f32 v12, v202, v10, v11
    v_fma_f32 v202, v12, v32, v24
    v_fma_f32 v12, v203, v10, v11
    v_fma_f32 v203, v12, v33, v25
    v_fma_f32 v12, v204, v10, v11
    v_fma_f32 v204, v12, v34, v26
    v_fma_f32 v12, v205, v10, v11
    v_fma_f32 v205, v12, v35, v27
    v_fma_f32 v12, v206, v10, v11
    v_fma_f32 v206, v12, v36, v28
    v_fma_f32 v12, v207, v10, v11
    v_fma_f32 v207, v12, v37, v29
    v_fma_f32 v12, v208, v10, v11
    v_fma_f32 v208, v12, v38, v30
    v_fma_f32 v12, v209, v10, v11
    v_fma_f32 v209, v12, v39, v31
    v_cvt_pk_bf16_f32 v20, v202, v203
    v_cvt_pk_bf16_f32 v21, v204, v205
    v_cvt_pk_bf16_f32 v22, v206, v207
    v_cvt_pk_bf16_f32 v23, v208, v209
    ds_write_b128 v3, v[20:23] offset:64
    ds_read_b128 v[24:27], v4 offset:5536
    ds_read_b128 v[28:31], v4 offset:5552
    ds_read_b128 v[32:35], v4 offset:7328
    ds_read_b128 v[36:39], v4 offset:7344
    s_waitcnt lgkmcnt(0)
    v_fma_f32 v12, v210, v10, v11
    v_fma_f32 v210, v12, v32, v24
    v_fma_f32 v12, v211, v10, v11
    v_fma_f32 v211, v12, v33, v25
    v_fma_f32 v12, v212, v10, v11
    v_fma_f32 v212, v12, v34, v26
    v_fma_f32 v12, v213, v10, v11
    v_fma_f32 v213, v12, v35, v27
    v_fma_f32 v12, v214, v10, v11
    v_fma_f32 v214, v12, v36, v28
    v_fma_f32 v12, v215, v10, v11
    v_fma_f32 v215, v12, v37, v29
    v_fma_f32 v12, v216, v10, v11
    v_fma_f32 v216, v12, v38, v30
    v_fma_f32 v12, v217, v10, v11
    v_fma_f32 v217, v12, v39, v31
    v_cvt_pk_bf16_f32 v20, v210, v211
    v_cvt_pk_bf16_f32 v21, v212, v213
    v_cvt_pk_bf16_f32 v22, v214, v215
    v_cvt_pk_bf16_f32 v23, v216, v217
    ds_write_b128 v3, v[20:23] offset:80
    ds_read_b128 v[24:27], v4 offset:5568
    ds_read_b128 v[28:31], v4 offset:5584
    ds_read_b128 v[32:35], v4 offset:7360
    ds_read_b128 v[36:39], v4 offset:7376
    s_waitcnt lgkmcnt(0)
    v_fma_f32 v12, v218, v10, v11
    v_fma_f32 v218, v12, v32, v24
    v_fma_f32 v12, v219, v10, v11
    v_fma_f32 v219, v12, v33, v25
    v_fma_f32 v12, v220, v10, v11
    v_fma_f32 v220, v12, v34, v26
    v_fma_f32 v12, v221, v10, v11
    v_fma_f32 v221, v12, v35, v27
    v_fma_f32 v12, v222, v10, v11
    v_fma_f32 v222, v12, v36, v28
    v_fma_f32 v12, v223, v10, v11
    v_fma_f32 v223, v12, v37, v29
    v_fma_f32 v12, v224, v10, v11
    v_fma_f32 v224, v12, v38, v30
    v_fma_f32 v12, v225, v10, v11
    v_fma_f32 v225, v12, v39, v31
    v_cvt_pk_bf16_f32 v20, v218, v219
    v_cvt_pk_bf16_f32 v21, v220, v221
    v_cvt_pk_bf16_f32 v22, v222, v223
    v_cvt_pk_bf16_f32 v23, v224, v225
    ds_write_b128 v3, v[20:23] offset:96
    s_waitcnt vmcnt(0) lgkmcnt(0)
    s_barrier
    v_lshrrev_b32 v1, 6, v0
    s_nop 0
    v_readfirstlane_b32 s54, v1
    v_and_b32 v1, 63, v0
    v_and_b32 v2, 15, v1
    v_lshrrev_b32 v3, 4, v1
    s_mul_i32 s55, s40, 448
    s_mul_i32 s56, s54, 112
    s_add_u32 s55, s55, s56
    v_lshlrev_b32 v5, 4, v3
    v_mul_u32_u24 v6, 928, v2
    v_add_u32 v6, v6, v5
    s_mul_i32 s57, s54, 112*144
    s_add_u32 s57, s57, 41472
    v_mul_u32_u24 v4, 144, v2
    v_add_u32 v4, v4, v5
    v_add_u32 v4, s57, v4
    v_lshrrev_b32 v7, 3, v0
    v_and_b32 v8, 7, v0
    v_lshlrev_b32 v8, 4, v8
    v_mul_u32_u24 v9, 144, v7
    v_add_u32 v9, v9, v8
    v_add_u32 v9, 41472, v9
    s_mul_i32 s57, s40, 448
    v_add_u32 v7, s57, v7
    v_mul_u32_u24 v7, 896, v7
    v_add_u32 v7, v7, v8
    v_mov_b32 v100, 0
    v_mov_b32 v101, 0
    v_mov_b32 v102, 0
    v_mov_b32 v103, 0
    v_mov_b32 v104, 0
    v_mov_b32 v105, 0
    v_mov_b32 v106, 0
    v_mov_b32 v107, 0
    v_mov_b32 v108, 0
    v_mov_b32 v109, 0
    v_mov_b32 v110, 0
    v_mov_b32 v111, 0
    v_mov_b32 v112, 0
    v_mov_b32 v113, 0
    v_mov_b32 v114, 0
    v_mov_b32 v115, 0
    v_mov_b32 v116, 0
    v_mov_b32 v117, 0
    v_mov_b32 v118, 0
    v_mov_b32 v119, 0
    v_mov_b32 v120, 0
    v_mov_b32 v121, 0
    v_mov_b32 v122, 0
    v_mov_b32 v123, 0
    v_mov_b32 v124, 0
    v_mov_b32 v125, 0
    v_mov_b32 v126, 0
    v_mov_b32 v127, 0
    v_mov_b32 v128, 0
    v_mov_b32 v129, 0
    v_mov_b32 v130, 0
    v_mov_b32 v131, 0
    v_mov_b32 v132, 0
    v_mov_b32 v133, 0
    v_mov_b32 v134, 0
    v_mov_b32 v135, 0
    v_mov_b32 v136, 0
    v_mov_b32 v137, 0
    v_mov_b32 v138, 0
    v_mov_b32 v139, 0
    v_mov_b32 v140, 0
    v_mov_b32 v141, 0
    v_mov_b32 v142, 0
    v_mov_b32 v143, 0
    v_mov_b32 v144, 0
    v_mov_b32 v145, 0
    v_mov_b32 v146, 0
    v_mov_b32 v147, 0
    v_mov_b32 v148, 0
    v_mov_b32 v149, 0
    v_mov_b32 v150, 0
    v_mov_b32 v151, 0
    v_mov_b32 v152, 0
    v_mov_b32 v153, 0
    v_mov_b32 v154, 0
    v_mov_b32 v155, 0
    s_mov_b32 s60, 0x3dd2d3e8
    s_mov_b32 s61, 0x40135761
    v_mov_b32 v31, s61
    s_cmp_ge_u32 s40, 2
    s_cbranch_scc1 K2_Z2
    s_mov_b32 s43, 1851392
    v_add_u32 v8, 0, v7
    buffer_load_dwordx4 v[160:163], v8, s[28:31], s43 offen
    v_add_u32 v8, 28672, v7
    buffer_load_dwordx4 v[164:167], v8, s[28:31], s43 offen
    v_add_u32 v8, 57344, v7
    buffer_load_dwordx4 v[168:171], v8, s[28:31], s43 offen
    v_add_u32 v8, 86016, v7
    buffer_load_dwordx4 v[172:175], v8, s[28:31], s43 offen
    v_add_u32 v8, 114688, v7
    buffer_load_dwordx4 v[176:179], v8, s[28:31], s43 offen
    v_add_u32 v8, 143360, v7
    buffer_load_dwordx4 v[180:183], v8, s[28:31], s43 offen
    v_add_u32 v8, 172032, v7
    buffer_load_dwordx4 v[184:187], v8, s[28:31], s43 offen
    v_add_u32 v8, 200704, v7
    buffer_load_dwordx4 v[188:191], v8, s[28:31], s43 offen
    v_add_u32 v8, 229376, v7
    buffer_load_dwordx4 v[192:195], v8, s[28:31], s43 offen
    v_add_u32 v8, 258048, v7
    buffer_load_dwordx4 v[196:199], v8, s[28:31], s43 offen
    v_add_u32 v8, 286720, v7
    buffer_load_dwordx4 v[200:203], v8, s[28:31], s43 offen
    v_add_u32 v8, 315392, v7
    buffer_load_dwordx4 v[204:207], v8, s[28:31], s43 offen
    v_add_u32 v8, 344064, v7
    buffer_load_dwordx4 v[208:211], v8, s[28:31], s43 offen
    v_add_u32 v8, 372736, v7
    buffer_load_dwordx4 v[212:215], v8, s[28:31], s43 offen
    s_add_u32 s43, s43, 128
    s_waitcnt vmcnt(0)
    ds_write_b128 v9, v[160:163] offset:0
    ds_write_b128 v9, v[164:167] offset:4608
    ds_write_b128 v9, v[168:171] offset:9216
    ds_write_b128 v9, v[172:175] offset:13824
    ds_write_b128 v9, v[176:179] offset:18432
    ds_write_b128 v9, v[180:183] offset:23040
    ds_write_b128 v9, v[184:187] offset:27648
    ds_write_b128 v9, v[188:191] offset:32256
    ds_write_b128 v9, v[192:195] offset:36864
    ds_write_b128 v9, v[196:199] offset:41472
    ds_write_b128 v9, v[200:203] offset:46080
    ds_write_b128 v9, v[204:207] offset:50688
    ds_write_b128 v9, v[208:211] offset:55296
    ds_write_b128 v9, v[212:215] offset:59904
    s_waitcnt lgkmcnt(0)
    s_barrier
    v_add_u32 v8, 0, v7
    buffer_load_dwordx4 v[160:163], v8, s[28:31], s43 offen
    v_add_u32 v8, 28672, v7
    buffer_load_dwordx4 v[164:167], v8, s[28:31], s43 offen
    v_add_u32 v8, 57344, v7
    buffer_load_dwordx4 v[168:171], v8, s[28:31], s43 offen
    v_add_u32 v8, 86016, v7
    buffer_load_dwordx4 v[172:175], v8, s[28:31], s43 offen
    v_add_u32 v8, 114688, v7
    buffer_load_dwordx4 v[176:179], v8, s[28:31], s43 offen
    v_add_u32 v8, 143360, v7
    buffer_load_dwordx4 v[180:183], v8, s[28:31], s43 offen
    v_add_u32 v8, 172032, v7
    buffer_load_dwordx4 v[184:187], v8, s[28:31], s43 offen
    v_add_u32 v8, 200704, v7
    buffer_load_dwordx4 v[188:191], v8, s[28:31], s43 offen
    v_add_u32 v8, 229376, v7
    buffer_load_dwordx4 v[192:195], v8, s[28:31], s43 offen
    v_add_u32 v8, 258048, v7
    buffer_load_dwordx4 v[196:199], v8, s[28:31], s43 offen
    v_add_u32 v8, 286720, v7
    buffer_load_dwordx4 v[200:203], v8, s[28:31], s43 offen
    v_add_u32 v8, 315392, v7
    buffer_load_dwordx4 v[204:207], v8, s[28:31], s43 offen
    v_add_u32 v8, 344064, v7
    buffer_load_dwordx4 v[208:211], v8, s[28:31], s43 offen
    v_add_u32 v8, 372736, v7
    buffer_load_dwordx4 v[212:215], v8, s[28:31], s43 offen
    s_add_u32 s43, s43, 128
    ds_read_b128 v[20:23], v6 offset:0
    ds_read_b128 v[24:27], v6 offset:14848
    ds_read_b128 v[216:219], v4 offset:0
    ds_read_b128 v[220:223], v4 offset:2304
    ds_read_b128 v[224:227], v4 offset:4608
    ds_read_b128 v[228:231], v4 offset:6912
    ds_read_b128 v[232:235], v4 offset:9216
    ds_read_b128 v[236:239], v4 offset:11520
    ds_read_b128 v[240:243], v4 offset:13824
    s_waitcnt lgkmcnt(6)
    v_mfma_f32_16x16x32_bf16 v[100:103], v[216:219], v[20:23], v[100:103]
    v_mfma_f32_16x16x32_bf16 v[104:107], v[216:219], v[24:27], v[104:107]
    s_waitcnt lgkmcnt(5)
    v_mfma_f32_16x16x32_bf16 v[108:111], v[220:223], v[20:23], v[108:111]
    v_mfma_f32_16x16x32_bf16 v[112:115], v[220:223], v[24:27], v[112:115]
    s_waitcnt lgkmcnt(4)
    v_mfma_f32_16x16x32_bf16 v[116:119], v[224:227], v[20:23], v[116:119]
    v_mfma_f32_16x16x32_bf16 v[120:123], v[224:227], v[24:27], v[120:123]
    s_waitcnt lgkmcnt(3)
    v_mfma_f32_16x16x32_bf16 v[124:127], v[228:231], v[20:23], v[124:127]
    v_mfma_f32_16x16x32_bf16 v[128:131], v[228:231], v[24:27], v[128:131]
    s_waitcnt lgkmcnt(2)
    v_mfma_f32_16x16x32_bf16 v[132:135], v[232:235], v[20:23], v[132:135]
    v_mfma_f32_16x16x32_bf16 v[136:139], v[232:235], v[24:27], v[136:139]
    s_waitcnt lgkmcnt(1)
    v_mfma_f32_16x16x32_bf16 v[140:143], v[236:239], v[20:23], v[140:143]
    v_mfma_f32_16x16x32_bf16 v[144:147], v[236:239], v[24:27], v[144:147]
    s_waitcnt lgkmcnt(0)
    v_mfma_f32_16x16x32_bf16 v[148:151], v[240:243], v[20:23], v[148:151]
    v_mfma_f32_16x16x32_bf16 v[152:155], v[240:243], v[24:27], v[152:155]
    s_nop 7
    ds_read_b128 v[20:23], v6 offset:64
    ds_read_b128 v[24:27], v6 offset:14912
    ds_read_b128 v[216:219], v4 offset:64
    ds_read_b128 v[220:223], v4 offset:2368
    ds_read_b128 v[224:227], v4 offset:4672
    ds_read_b128 v[228:231], v4 offset:6976
    ds_read_b128 v[232:235], v4 offset:9280
    ds_read_b128 v[236:239], v4 offset:11584
    ds_read_b128 v[240:243], v4 offset:13888
    s_waitcnt lgkmcnt(6)
    v_mfma_f32_16x16x32_bf16 v[100:103], v[216:219], v[20:23], v[100:103]
    v_mfma_f32_16x16x32_bf16 v[104:107], v[216:219], v[24:27], v[104:107]
    s_waitcnt lgkmcnt(5)
    v_mfma_f32_16x16x32_bf16 v[108:111], v[220:223], v[20:23], v[108:111]
    v_mfma_f32_16x16x32_bf16 v[112:115], v[220:223], v[24:27], v[112:115]
    s_waitcnt lgkmcnt(4)
    v_mfma_f32_16x16x32_bf16 v[116:119], v[224:227], v[20:23], v[116:119]
    v_mfma_f32_16x16x32_bf16 v[120:123], v[224:227], v[24:27], v[120:123]
    s_waitcnt lgkmcnt(3)
    v_mfma_f32_16x16x32_bf16 v[124:127], v[228:231], v[20:23], v[124:127]
    v_mfma_f32_16x16x32_bf16 v[128:131], v[228:231], v[24:27], v[128:131]
    s_waitcnt lgkmcnt(2)
    v_mfma_f32_16x16x32_bf16 v[132:135], v[232:235], v[20:23], v[132:135]
    v_mfma_f32_16x16x32_bf16 v[136:139], v[232:235], v[24:27], v[136:139]
    s_waitcnt lgkmcnt(1)
    v_mfma_f32_16x16x32_bf16 v[140:143], v[236:239], v[20:23], v[140:143]
    v_mfma_f32_16x16x32_bf16 v[144:147], v[236:239], v[24:27], v[144:147]
    s_waitcnt lgkmcnt(0)
    v_mfma_f32_16x16x32_bf16 v[148:151], v[240:243], v[20:23], v[148:151]
    v_mfma_f32_16x16x32_bf16 v[152:155], v[240:243], v[24:27], v[152:155]
    s_nop 7
    s_barrier
    s_waitcnt vmcnt(0)
    ds_write_b128 v9, v[160:163] offset:0
    ds_write_b128 v9, v[164:167] offset:4608
    ds_write_b128 v9, v[168:171] offset:9216
    ds_write_b128 v9, v[172:175] offset:13824
    ds_write_b128 v9, v[176:179] offset:18432
    ds_write_b128 v9, v[180:183] offset:23040
    ds_write_b128 v9, v[184:187] offset:27648
    ds_write_b128 v9, v[188:191] offset:32256
    ds_write_b128 v9, v[192:195] offset:36864
    ds_write_b128 v9, v[196:199] offset:41472
    ds_write_b128 v9, v[200:203] offset:46080
    ds_write_b128 v9, v[204:207] offset:50688
    ds_write_b128 v9, v[208:211] offset:55296
    ds_write_b128 v9, v[212:215] offset:59904
    s_waitcnt lgkmcnt(0)
    s_barrier
    v_add_u32 v8, 0, v7
    buffer_load_dwordx4 v[160:163], v8, s[28:31], s43 offen
    v_add_u32 v8, 28672, v7
    buffer_load_dwordx4 v[164:167], v8, s[28:31], s43 offen
    v_add_u32 v8, 57344, v7
    buffer_load_dwordx4 v[168:171], v8, s[28:31], s43 offen
    v_add_u32 v8, 86016, v7
    buffer_load_dwordx4 v[172:175], v8, s[28:31], s43 offen
    v_add_u32 v8, 114688, v7
    buffer_load_dwordx4 v[176:179], v8, s[28:31], s43 offen
    v_add_u32 v8, 143360, v7
    buffer_load_dwordx4 v[180:183], v8, s[28:31], s43 offen
    v_add_u32 v8, 172032, v7
    buffer_load_dwordx4 v[184:187], v8, s[28:31], s43 offen
    v_add_u32 v8, 200704, v7
    buffer_load_dwordx4 v[188:191], v8, s[28:31], s43 offen
    v_add_u32 v8, 229376, v7
    buffer_load_dwordx4 v[192:195], v8, s[28:31], s43 offen
    v_add_u32 v8, 258048, v7
    buffer_load_dwordx4 v[196:199], v8, s[28:31], s43 offen
    v_add_u32 v8, 286720, v7
    buffer_load_dwordx4 v[200:203], v8, s[28:31], s43 offen
    v_add_u32 v8, 315392, v7
    buffer_load_dwordx4 v[204:207], v8, s[28:31], s43 offen
    v_add_u32 v8, 344064, v7
    buffer_load_dwordx4 v[208:211], v8, s[28:31], s43 offen
    v_add_u32 v8, 372736, v7
    buffer_load_dwordx4 v[212:215], v8, s[28:31], s43 offen
    s_add_u32 s43, s43, 128
    ds_read_b128 v[20:23], v6 offset:128
    ds_read_b128 v[24:27], v6 offset:14976
    ds_read_b128 v[216:219], v4 offset:0
    ds_read_b128 v[220:223], v4 offset:2304
    ds_read_b128 v[224:227], v4 offset:4608
    ds_read_b128 v[228:231], v4 offset:6912
    ds_read_b128 v[232:235], v4 offset:9216
    ds_read_b128 v[236:239], v4 offset:11520
    ds_read_b128 v[240:243], v4 offset:13824
    s_waitcnt lgkmcnt(6)
    v_mfma_f32_16x16x32_bf16 v[100:103], v[216:219], v[20:23], v[100:103]
    v_mfma_f32_16x16x32_bf16 v[104:107], v[216:219], v[24:27], v[104:107]
    s_waitcnt lgkmcnt(5)
    v_mfma_f32_16x16x32_bf16 v[108:111], v[220:223], v[20:23], v[108:111]
    v_mfma_f32_16x16x32_bf16 v[112:115], v[220:223], v[24:27], v[112:115]
    s_waitcnt lgkmcnt(4)
    v_mfma_f32_16x16x32_bf16 v[116:119], v[224:227], v[20:23], v[116:119]
    v_mfma_f32_16x16x32_bf16 v[120:123], v[224:227], v[24:27], v[120:123]
    s_waitcnt lgkmcnt(3)
    v_mfma_f32_16x16x32_bf16 v[124:127], v[228:231], v[20:23], v[124:127]
    v_mfma_f32_16x16x32_bf16 v[128:131], v[228:231], v[24:27], v[128:131]
    s_waitcnt lgkmcnt(2)
    v_mfma_f32_16x16x32_bf16 v[132:135], v[232:235], v[20:23], v[132:135]
    v_mfma_f32_16x16x32_bf16 v[136:139], v[232:235], v[24:27], v[136:139]
    s_waitcnt lgkmcnt(1)
    v_mfma_f32_16x16x32_bf16 v[140:143], v[236:239], v[20:23], v[140:143]
    v_mfma_f32_16x16x32_bf16 v[144:147], v[236:239], v[24:27], v[144:147]
    s_waitcnt lgkmcnt(0)
    v_mfma_f32_16x16x32_bf16 v[148:151], v[240:243], v[20:23], v[148:151]
    v_mfma_f32_16x16x32_bf16 v[152:155], v[240:243], v[24:27], v[152:155]
    s_nop 7
    ds_read_b128 v[20:23], v6 offset:192
    ds_read_b128 v[24:27], v6 offset:15040
    ds_read_b128 v[216:219], v4 offset:64
    ds_read_b128 v[220:223], v4 offset:2368
    ds_read_b128 v[224:227], v4 offset:4672
    ds_read_b128 v[228:231], v4 offset:6976
    ds_read_b128 v[232:235], v4 offset:9280
    ds_read_b128 v[236:239], v4 offset:11584
    ds_read_b128 v[240:243], v4 offset:13888
    s_waitcnt lgkmcnt(6)
    v_mfma_f32_16x16x32_bf16 v[100:103], v[216:219], v[20:23], v[100:103]
    v_mfma_f32_16x16x32_bf16 v[104:107], v[216:219], v[24:27], v[104:107]
    s_waitcnt lgkmcnt(5)
    v_mfma_f32_16x16x32_bf16 v[108:111], v[220:223], v[20:23], v[108:111]
    v_mfma_f32_16x16x32_bf16 v[112:115], v[220:223], v[24:27], v[112:115]
    s_waitcnt lgkmcnt(4)
    v_mfma_f32_16x16x32_bf16 v[116:119], v[224:227], v[20:23], v[116:119]
    v_mfma_f32_16x16x32_bf16 v[120:123], v[224:227], v[24:27], v[120:123]
    s_waitcnt lgkmcnt(3)
    v_mfma_f32_16x16x32_bf16 v[124:127], v[228:231], v[20:23], v[124:127]
    v_mfma_f32_16x16x32_bf16 v[128:131], v[228:231], v[24:27], v[128:131]
    s_waitcnt lgkmcnt(2)
    v_mfma_f32_16x16x32_bf16 v[132:135], v[232:235], v[20:23], v[132:135]
    v_mfma_f32_16x16x32_bf16 v[136:139], v[232:235], v[24:27], v[136:139]
    s_waitcnt lgkmcnt(1)
    v_mfma_f32_16x16x32_bf16 v[140:143], v[236:239], v[20:23], v[140:143]
    v_mfma_f32_16x16x32_bf16 v[144:147], v[236:239], v[24:27], v[144:147]
    s_waitcnt lgkmcnt(0)
    v_mfma_f32_16x16x32_bf16 v[148:151], v[240:243], v[20:23], v[148:151]
    v_mfma_f32_16x16x32_bf16 v[152:155], v[240:243], v[24:27], v[152:155]
    s_nop 7
    s_barrier
    s_waitcnt vmcnt(0)
    ds_write_b128 v9, v[160:163] offset:0
    ds_write_b128 v9, v[164:167] offset:4608
    ds_write_b128 v9, v[168:171] offset:9216
    ds_write_b128 v9, v[172:175] offset:13824
    ds_write_b128 v9, v[176:179] offset:18432
    ds_write_b128 v9, v[180:183] offset:23040
    ds_write_b128 v9, v[184:187] offset:27648
    ds_write_b128 v9, v[188:191] offset:32256
    ds_write_b128 v9, v[192:195] offset:36864
    ds_write_b128 v9, v[196:199] offset:41472
    ds_write_b128 v9, v[200:203] offset:46080
    ds_write_b128 v9, v[204:207] offset:50688
    ds_write_b128 v9, v[208:211] offset:55296
    ds_write_b128 v9, v[212:215] offset:59904
    s_waitcnt lgkmcnt(0)
    s_barrier
    v_add_u32 v8, 0, v7
    buffer_load_dwordx4 v[160:163], v8, s[28:31], s43 offen
    v_add_u32 v8, 28672, v7
    buffer_load_dwordx4 v[164:167], v8, s[28:31], s43 offen
    v_add_u32 v8, 57344, v7
    buffer_load_dwordx4 v[168:171], v8, s[28:31], s43 offen
    v_add_u32 v8, 86016, v7
    buffer_load_dwordx4 v[172:175], v8, s[28:31], s43 offen
    v_add_u32 v8, 114688, v7
    buffer_load_dwordx4 v[176:179], v8, s[28:31], s43 offen
    v_add_u32 v8, 143360, v7
    buffer_load_dwordx4 v[180:183], v8, s[28:31], s43 offen
    v_add_u32 v8, 172032, v7
    buffer_load_dwordx4 v[184:187], v8, s[28:31], s43 offen
    v_add_u32 v8, 200704, v7
    buffer_load_dwordx4 v[188:191], v8, s[28:31], s43 offen
    v_add_u32 v8, 229376, v7
    buffer_load_dwordx4 v[192:195], v8, s[28:31], s43 offen
    v_add_u32 v8, 258048, v7
    buffer_load_dwordx4 v[196:199], v8, s[28:31], s43 offen
    v_add_u32 v8, 286720, v7
    buffer_load_dwordx4 v[200:203], v8, s[28:31], s43 offen
    v_add_u32 v8, 315392, v7
    buffer_load_dwordx4 v[204:207], v8, s[28:31], s43 offen
    v_add_u32 v8, 344064, v7
    buffer_load_dwordx4 v[208:211], v8, s[28:31], s43 offen
    v_add_u32 v8, 372736, v7
    buffer_load_dwordx4 v[212:215], v8, s[28:31], s43 offen
    s_add_u32 s43, s43, 128
    ds_read_b128 v[20:23], v6 offset:256
    ds_read_b128 v[24:27], v6 offset:15104
    ds_read_b128 v[216:219], v4 offset:0
    ds_read_b128 v[220:223], v4 offset:2304
    ds_read_b128 v[224:227], v4 offset:4608
    ds_read_b128 v[228:231], v4 offset:6912
    ds_read_b128 v[232:235], v4 offset:9216
    ds_read_b128 v[236:239], v4 offset:11520
    ds_read_b128 v[240:243], v4 offset:13824
    s_waitcnt lgkmcnt(6)
    v_mfma_f32_16x16x32_bf16 v[100:103], v[216:219], v[20:23], v[100:103]
    v_mfma_f32_16x16x32_bf16 v[104:107], v[216:219], v[24:27], v[104:107]
    s_waitcnt lgkmcnt(5)
    v_mfma_f32_16x16x32_bf16 v[108:111], v[220:223], v[20:23], v[108:111]
    v_mfma_f32_16x16x32_bf16 v[112:115], v[220:223], v[24:27], v[112:115]
    s_waitcnt lgkmcnt(4)
    v_mfma_f32_16x16x32_bf16 v[116:119], v[224:227], v[20:23], v[116:119]
    v_mfma_f32_16x16x32_bf16 v[120:123], v[224:227], v[24:27], v[120:123]
    s_waitcnt lgkmcnt(3)
    v_mfma_f32_16x16x32_bf16 v[124:127], v[228:231], v[20:23], v[124:127]
    v_mfma_f32_16x16x32_bf16 v[128:131], v[228:231], v[24:27], v[128:131]
    s_waitcnt lgkmcnt(2)
    v_mfma_f32_16x16x32_bf16 v[132:135], v[232:235], v[20:23], v[132:135]
    v_mfma_f32_16x16x32_bf16 v[136:139], v[232:235], v[24:27], v[136:139]
    s_waitcnt lgkmcnt(1)
    v_mfma_f32_16x16x32_bf16 v[140:143], v[236:239], v[20:23], v[140:143]
    v_mfma_f32_16x16x32_bf16 v[144:147], v[236:239], v[24:27], v[144:147]
    s_waitcnt lgkmcnt(0)
    v_mfma_f32_16x16x32_bf16 v[148:151], v[240:243], v[20:23], v[148:151]
    v_mfma_f32_16x16x32_bf16 v[152:155], v[240:243], v[24:27], v[152:155]
    s_nop 7
    ds_read_b128 v[20:23], v6 offset:320
    ds_read_b128 v[24:27], v6 offset:15168
    ds_read_b128 v[216:219], v4 offset:64
    ds_read_b128 v[220:223], v4 offset:2368
    ds_read_b128 v[224:227], v4 offset:4672
    ds_read_b128 v[228:231], v4 offset:6976
    ds_read_b128 v[232:235], v4 offset:9280
    ds_read_b128 v[236:239], v4 offset:11584
    ds_read_b128 v[240:243], v4 offset:13888
    s_waitcnt lgkmcnt(6)
    v_mfma_f32_16x16x32_bf16 v[100:103], v[216:219], v[20:23], v[100:103]
    v_mfma_f32_16x16x32_bf16 v[104:107], v[216:219], v[24:27], v[104:107]
    s_waitcnt lgkmcnt(5)
    v_mfma_f32_16x16x32_bf16 v[108:111], v[220:223], v[20:23], v[108:111]
    v_mfma_f32_16x16x32_bf16 v[112:115], v[220:223], v[24:27], v[112:115]
    s_waitcnt lgkmcnt(4)
    v_mfma_f32_16x16x32_bf16 v[116:119], v[224:227], v[20:23], v[116:119]
    v_mfma_f32_16x16x32_bf16 v[120:123], v[224:227], v[24:27], v[120:123]
    s_waitcnt lgkmcnt(3)
    v_mfma_f32_16x16x32_bf16 v[124:127], v[228:231], v[20:23], v[124:127]
    v_mfma_f32_16x16x32_bf16 v[128:131], v[228:231], v[24:27], v[128:131]
    s_waitcnt lgkmcnt(2)
    v_mfma_f32_16x16x32_bf16 v[132:135], v[232:235], v[20:23], v[132:135]
    v_mfma_f32_16x16x32_bf16 v[136:139], v[232:235], v[24:27], v[136:139]
    s_waitcnt lgkmcnt(1)
    v_mfma_f32_16x16x32_bf16 v[140:143], v[236:239], v[20:23], v[140:143]
    v_mfma_f32_16x16x32_bf16 v[144:147], v[236:239], v[24:27], v[144:147]
    s_waitcnt lgkmcnt(0)
    v_mfma_f32_16x16x32_bf16 v[148:151], v[240:243], v[20:23], v[148:151]
    v_mfma_f32_16x16x32_bf16 v[152:155], v[240:243], v[24:27], v[152:155]
    s_nop 7
    s_barrier
    s_waitcnt vmcnt(0)
    ds_write_b128 v9, v[160:163] offset:0
    ds_write_b128 v9, v[164:167] offset:4608
    ds_write_b128 v9, v[168:171] offset:9216
    ds_write_b128 v9, v[172:175] offset:13824
    ds_write_b128 v9, v[176:179] offset:18432
    ds_write_b128 v9, v[180:183] offset:23040
    ds_write_b128 v9, v[184:187] offset:27648
    ds_write_b128 v9, v[188:191] offset:32256
    ds_write_b128 v9, v[192:195] offset:36864
    ds_write_b128 v9, v[196:199] offset:41472
    ds_write_b128 v9, v[200:203] offset:46080
    ds_write_b128 v9, v[204:207] offset:50688
    ds_write_b128 v9, v[208:211] offset:55296
    ds_write_b128 v9, v[212:215] offset:59904
    s_waitcnt lgkmcnt(0)
    s_barrier
    v_add_u32 v8, 0, v7
    buffer_load_dwordx4 v[160:163], v8, s[28:31], s43 offen
    v_add_u32 v8, 28672, v7
    buffer_load_dwordx4 v[164:167], v8, s[28:31], s43 offen
    v_add_u32 v8, 57344, v7
    buffer_load_dwordx4 v[168:171], v8, s[28:31], s43 offen
    v_add_u32 v8, 86016, v7
    buffer_load_dwordx4 v[172:175], v8, s[28:31], s43 offen
    v_add_u32 v8, 114688, v7
    buffer_load_dwordx4 v[176:179], v8, s[28:31], s43 offen
    v_add_u32 v8, 143360, v7
    buffer_load_dwordx4 v[180:183], v8, s[28:31], s43 offen
    v_add_u32 v8, 172032, v7
    buffer_load_dwordx4 v[184:187], v8, s[28:31], s43 offen
    v_add_u32 v8, 200704, v7
    buffer_load_dwordx4 v[188:191], v8, s[28:31], s43 offen
    v_add_u32 v8, 229376, v7
    buffer_load_dwordx4 v[192:195], v8, s[28:31], s43 offen
    v_add_u32 v8, 258048, v7
    buffer_load_dwordx4 v[196:199], v8, s[28:31], s43 offen
    v_add_u32 v8, 286720, v7
    buffer_load_dwordx4 v[200:203], v8, s[28:31], s43 offen
    v_add_u32 v8, 315392, v7
    buffer_load_dwordx4 v[204:207], v8, s[28:31], s43 offen
    v_add_u32 v8, 344064, v7
    buffer_load_dwordx4 v[208:211], v8, s[28:31], s43 offen
    v_add_u32 v8, 372736, v7
    buffer_load_dwordx4 v[212:215], v8, s[28:31], s43 offen
    s_add_u32 s43, s43, 128
    ds_read_b128 v[20:23], v6 offset:384
    ds_read_b128 v[24:27], v6 offset:15232
    ds_read_b128 v[216:219], v4 offset:0
    ds_read_b128 v[220:223], v4 offset:2304
    ds_read_b128 v[224:227], v4 offset:4608
    ds_read_b128 v[228:231], v4 offset:6912
    ds_read_b128 v[232:235], v4 offset:9216
    ds_read_b128 v[236:239], v4 offset:11520
    ds_read_b128 v[240:243], v4 offset:13824
    s_waitcnt lgkmcnt(6)
    v_mfma_f32_16x16x32_bf16 v[100:103], v[216:219], v[20:23], v[100:103]
    v_mfma_f32_16x16x32_bf16 v[104:107], v[216:219], v[24:27], v[104:107]
    s_waitcnt lgkmcnt(5)
    v_mfma_f32_16x16x32_bf16 v[108:111], v[220:223], v[20:23], v[108:111]
    v_mfma_f32_16x16x32_bf16 v[112:115], v[220:223], v[24:27], v[112:115]
    s_waitcnt lgkmcnt(4)
    v_mfma_f32_16x16x32_bf16 v[116:119], v[224:227], v[20:23], v[116:119]
    v_mfma_f32_16x16x32_bf16 v[120:123], v[224:227], v[24:27], v[120:123]
    s_waitcnt lgkmcnt(3)
    v_mfma_f32_16x16x32_bf16 v[124:127], v[228:231], v[20:23], v[124:127]
    v_mfma_f32_16x16x32_bf16 v[128:131], v[228:231], v[24:27], v[128:131]
    s_waitcnt lgkmcnt(2)
    v_mfma_f32_16x16x32_bf16 v[132:135], v[232:235], v[20:23], v[132:135]
    v_mfma_f32_16x16x32_bf16 v[136:139], v[232:235], v[24:27], v[136:139]
    s_waitcnt lgkmcnt(1)
    v_mfma_f32_16x16x32_bf16 v[140:143], v[236:239], v[20:23], v[140:143]
    v_mfma_f32_16x16x32_bf16 v[144:147], v[236:239], v[24:27], v[144:147]
    s_waitcnt lgkmcnt(0)
    v_mfma_f32_16x16x32_bf16 v[148:151], v[240:243], v[20:23], v[148:151]
    v_mfma_f32_16x16x32_bf16 v[152:155], v[240:243], v[24:27], v[152:155]
    s_nop 7
    ds_read_b128 v[20:23], v6 offset:448
    ds_read_b128 v[24:27], v6 offset:15296
    ds_read_b128 v[216:219], v4 offset:64
    ds_read_b128 v[220:223], v4 offset:2368
    ds_read_b128 v[224:227], v4 offset:4672
    ds_read_b128 v[228:231], v4 offset:6976
    ds_read_b128 v[232:235], v4 offset:9280
    ds_read_b128 v[236:239], v4 offset:11584
    ds_read_b128 v[240:243], v4 offset:13888
    s_waitcnt lgkmcnt(6)
    v_mfma_f32_16x16x32_bf16 v[100:103], v[216:219], v[20:23], v[100:103]
    v_mfma_f32_16x16x32_bf16 v[104:107], v[216:219], v[24:27], v[104:107]
    s_waitcnt lgkmcnt(5)
    v_mfma_f32_16x16x32_bf16 v[108:111], v[220:223], v[20:23], v[108:111]
    v_mfma_f32_16x16x32_bf16 v[112:115], v[220:223], v[24:27], v[112:115]
    s_waitcnt lgkmcnt(4)
    v_mfma_f32_16x16x32_bf16 v[116:119], v[224:227], v[20:23], v[116:119]
    v_mfma_f32_16x16x32_bf16 v[120:123], v[224:227], v[24:27], v[120:123]
    s_waitcnt lgkmcnt(3)
    v_mfma_f32_16x16x32_bf16 v[124:127], v[228:231], v[20:23], v[124:127]
    v_mfma_f32_16x16x32_bf16 v[128:131], v[228:231], v[24:27], v[128:131]
    s_waitcnt lgkmcnt(2)
    v_mfma_f32_16x16x32_bf16 v[132:135], v[232:235], v[20:23], v[132:135]
    v_mfma_f32_16x16x32_bf16 v[136:139], v[232:235], v[24:27], v[136:139]
    s_waitcnt lgkmcnt(1)
    v_mfma_f32_16x16x32_bf16 v[140:143], v[236:239], v[20:23], v[140:143]
    v_mfma_f32_16x16x32_bf16 v[144:147], v[236:239], v[24:27], v[144:147]
    s_waitcnt lgkmcnt(0)
    v_mfma_f32_16x16x32_bf16 v[148:151], v[240:243], v[20:23], v[148:151]
    v_mfma_f32_16x16x32_bf16 v[152:155], v[240:243], v[24:27], v[152:155]
    s_nop 7
    s_barrier
    s_waitcnt vmcnt(0)
    ds_write_b128 v9, v[160:163] offset:0
    ds_write_b128 v9, v[164:167] offset:4608
    ds_write_b128 v9, v[168:171] offset:9216
    ds_write_b128 v9, v[172:175] offset:13824
    ds_write_b128 v9, v[176:179] offset:18432
    ds_write_b128 v9, v[180:183] offset:23040
    ds_write_b128 v9, v[184:187] offset:27648
    ds_write_b128 v9, v[188:191] offset:32256
    ds_write_b128 v9, v[192:195] offset:36864
    ds_write_b128 v9, v[196:199] offset:41472
    ds_write_b128 v9, v[200:203] offset:46080
    ds_write_b128 v9, v[204:207] offset:50688
    ds_write_b128 v9, v[208:211] offset:55296
    ds_write_b128 v9, v[212:215] offset:59904
    s_waitcnt lgkmcnt(0)
    s_barrier
    v_add_u32 v8, 0, v7
    buffer_load_dwordx4 v[160:163], v8, s[28:31], s43 offen
    v_add_u32 v8, 28672, v7
    buffer_load_dwordx4 v[164:167], v8, s[28:31], s43 offen
    v_add_u32 v8, 57344, v7
    buffer_load_dwordx4 v[168:171], v8, s[28:31], s43 offen
    v_add_u32 v8, 86016, v7
    buffer_load_dwordx4 v[172:175], v8, s[28:31], s43 offen
    v_add_u32 v8, 114688, v7
    buffer_load_dwordx4 v[176:179], v8, s[28:31], s43 offen
    v_add_u32 v8, 143360, v7
    buffer_load_dwordx4 v[180:183], v8, s[28:31], s43 offen
    v_add_u32 v8, 172032, v7
    buffer_load_dwordx4 v[184:187], v8, s[28:31], s43 offen
    v_add_u32 v8, 200704, v7
    buffer_load_dwordx4 v[188:191], v8, s[28:31], s43 offen
    v_add_u32 v8, 229376, v7
    buffer_load_dwordx4 v[192:195], v8, s[28:31], s43 offen
    v_add_u32 v8, 258048, v7
    buffer_load_dwordx4 v[196:199], v8, s[28:31], s43 offen
    v_add_u32 v8, 286720, v7
    buffer_load_dwordx4 v[200:203], v8, s[28:31], s43 offen
    v_add_u32 v8, 315392, v7
    buffer_load_dwordx4 v[204:207], v8, s[28:31], s43 offen
    v_add_u32 v8, 344064, v7
    buffer_load_dwordx4 v[208:211], v8, s[28:31], s43 offen
    v_add_u32 v8, 372736, v7
    buffer_load_dwordx4 v[212:215], v8, s[28:31], s43 offen
    s_add_u32 s43, s43, 128
    ds_read_b128 v[20:23], v6 offset:512
    ds_read_b128 v[24:27], v6 offset:15360
    ds_read_b128 v[216:219], v4 offset:0
    ds_read_b128 v[220:223], v4 offset:2304
    ds_read_b128 v[224:227], v4 offset:4608
    ds_read_b128 v[228:231], v4 offset:6912
    ds_read_b128 v[232:235], v4 offset:9216
    ds_read_b128 v[236:239], v4 offset:11520
    ds_read_b128 v[240:243], v4 offset:13824
    s_waitcnt lgkmcnt(6)
    v_mfma_f32_16x16x32_bf16 v[100:103], v[216:219], v[20:23], v[100:103]
    v_mfma_f32_16x16x32_bf16 v[104:107], v[216:219], v[24:27], v[104:107]
    s_waitcnt lgkmcnt(5)
    v_mfma_f32_16x16x32_bf16 v[108:111], v[220:223], v[20:23], v[108:111]
    v_mfma_f32_16x16x32_bf16 v[112:115], v[220:223], v[24:27], v[112:115]
    s_waitcnt lgkmcnt(4)
    v_mfma_f32_16x16x32_bf16 v[116:119], v[224:227], v[20:23], v[116:119]
    v_mfma_f32_16x16x32_bf16 v[120:123], v[224:227], v[24:27], v[120:123]
    s_waitcnt lgkmcnt(3)
    v_mfma_f32_16x16x32_bf16 v[124:127], v[228:231], v[20:23], v[124:127]
    v_mfma_f32_16x16x32_bf16 v[128:131], v[228:231], v[24:27], v[128:131]
    s_waitcnt lgkmcnt(2)
    v_mfma_f32_16x16x32_bf16 v[132:135], v[232:235], v[20:23], v[132:135]
    v_mfma_f32_16x16x32_bf16 v[136:139], v[232:235], v[24:27], v[136:139]
    s_waitcnt lgkmcnt(1)
    v_mfma_f32_16x16x32_bf16 v[140:143], v[236:239], v[20:23], v[140:143]
    v_mfma_f32_16x16x32_bf16 v[144:147], v[236:239], v[24:27], v[144:147]
    s_waitcnt lgkmcnt(0)
    v_mfma_f32_16x16x32_bf16 v[148:151], v[240:243], v[20:23], v[148:151]
    v_mfma_f32_16x16x32_bf16 v[152:155], v[240:243], v[24:27], v[152:155]
    s_nop 7
    ds_read_b128 v[20:23], v6 offset:576
    ds_read_b128 v[24:27], v6 offset:15424
    ds_read_b128 v[216:219], v4 offset:64
    ds_read_b128 v[220:223], v4 offset:2368
    ds_read_b128 v[224:227], v4 offset:4672
    ds_read_b128 v[228:231], v4 offset:6976
    ds_read_b128 v[232:235], v4 offset:9280
    ds_read_b128 v[236:239], v4 offset:11584
    ds_read_b128 v[240:243], v4 offset:13888
    s_waitcnt lgkmcnt(6)
    v_mfma_f32_16x16x32_bf16 v[100:103], v[216:219], v[20:23], v[100:103]
    v_mfma_f32_16x16x32_bf16 v[104:107], v[216:219], v[24:27], v[104:107]
    s_waitcnt lgkmcnt(5)
    v_mfma_f32_16x16x32_bf16 v[108:111], v[220:223], v[20:23], v[108:111]
    v_mfma_f32_16x16x32_bf16 v[112:115], v[220:223], v[24:27], v[112:115]
    s_waitcnt lgkmcnt(4)
    v_mfma_f32_16x16x32_bf16 v[116:119], v[224:227], v[20:23], v[116:119]
    v_mfma_f32_16x16x32_bf16 v[120:123], v[224:227], v[24:27], v[120:123]
    s_waitcnt lgkmcnt(3)
    v_mfma_f32_16x16x32_bf16 v[124:127], v[228:231], v[20:23], v[124:127]
    v_mfma_f32_16x16x32_bf16 v[128:131], v[228:231], v[24:27], v[128:131]
    s_waitcnt lgkmcnt(2)
    v_mfma_f32_16x16x32_bf16 v[132:135], v[232:235], v[20:23], v[132:135]
    v_mfma_f32_16x16x32_bf16 v[136:139], v[232:235], v[24:27], v[136:139]
    s_waitcnt lgkmcnt(1)
    v_mfma_f32_16x16x32_bf16 v[140:143], v[236:239], v[20:23], v[140:143]
    v_mfma_f32_16x16x32_bf16 v[144:147], v[236:239], v[24:27], v[144:147]
    s_waitcnt lgkmcnt(0)
    v_mfma_f32_16x16x32_bf16 v[148:151], v[240:243], v[20:23], v[148:151]
    v_mfma_f32_16x16x32_bf16 v[152:155], v[240:243], v[24:27], v[152:155]
    s_nop 7
    s_barrier
    s_waitcnt vmcnt(0)
    ds_write_b128 v9, v[160:163] offset:0
    ds_write_b128 v9, v[164:167] offset:4608
    ds_write_b128 v9, v[168:171] offset:9216
    ds_write_b128 v9, v[172:175] offset:13824
    ds_write_b128 v9, v[176:179] offset:18432
    ds_write_b128 v9, v[180:183] offset:23040
    ds_write_b128 v9, v[184:187] offset:27648
    ds_write_b128 v9, v[188:191] offset:32256
    ds_write_b128 v9, v[192:195] offset:36864
    ds_write_b128 v9, v[196:199] offset:41472
    ds_write_b128 v9, v[200:203] offset:46080
    ds_write_b128 v9, v[204:207] offset:50688
    ds_write_b128 v9, v[208:211] offset:55296
    ds_write_b128 v9, v[212:215] offset:59904
    s_waitcnt lgkmcnt(0)
    s_barrier
    v_add_u32 v8, 0, v7
    buffer_load_dwordx4 v[160:163], v8, s[28:31], s43 offen
    v_add_u32 v8, 28672, v7
    buffer_load_dwordx4 v[164:167], v8, s[28:31], s43 offen
    v_add_u32 v8, 57344, v7
    buffer_load_dwordx4 v[168:171], v8, s[28:31], s43 offen
    v_add_u32 v8, 86016, v7
    buffer_load_dwordx4 v[172:175], v8, s[28:31], s43 offen
    v_add_u32 v8, 114688, v7
    buffer_load_dwordx4 v[176:179], v8, s[28:31], s43 offen
    v_add_u32 v8, 143360, v7
    buffer_load_dwordx4 v[180:183], v8, s[28:31], s43 offen
    v_add_u32 v8, 172032, v7
    buffer_load_dwordx4 v[184:187], v8, s[28:31], s43 offen
    v_add_u32 v8, 200704, v7
    buffer_load_dwordx4 v[188:191], v8, s[28:31], s43 offen
    v_add_u32 v8, 229376, v7
    buffer_load_dwordx4 v[192:195], v8, s[28:31], s43 offen
    v_add_u32 v8, 258048, v7
    buffer_load_dwordx4 v[196:199], v8, s[28:31], s43 offen
    v_add_u32 v8, 286720, v7
    buffer_load_dwordx4 v[200:203], v8, s[28:31], s43 offen
    v_add_u32 v8, 315392, v7
    buffer_load_dwordx4 v[204:207], v8, s[28:31], s43 offen
    v_add_u32 v8, 344064, v7
    buffer_load_dwordx4 v[208:211], v8, s[28:31], s43 offen
    v_add_u32 v8, 372736, v7
    buffer_load_dwordx4 v[212:215], v8, s[28:31], s43 offen
    s_add_u32 s43, s43, 128
    ds_read_b128 v[20:23], v6 offset:640
    ds_read_b128 v[24:27], v6 offset:15488
    ds_read_b128 v[216:219], v4 offset:0
    ds_read_b128 v[220:223], v4 offset:2304
    ds_read_b128 v[224:227], v4 offset:4608
    ds_read_b128 v[228:231], v4 offset:6912
    ds_read_b128 v[232:235], v4 offset:9216
    ds_read_b128 v[236:239], v4 offset:11520
    ds_read_b128 v[240:243], v4 offset:13824
    s_waitcnt lgkmcnt(6)
    v_mfma_f32_16x16x32_bf16 v[100:103], v[216:219], v[20:23], v[100:103]
    v_mfma_f32_16x16x32_bf16 v[104:107], v[216:219], v[24:27], v[104:107]
    s_waitcnt lgkmcnt(5)
    v_mfma_f32_16x16x32_bf16 v[108:111], v[220:223], v[20:23], v[108:111]
    v_mfma_f32_16x16x32_bf16 v[112:115], v[220:223], v[24:27], v[112:115]
    s_waitcnt lgkmcnt(4)
    v_mfma_f32_16x16x32_bf16 v[116:119], v[224:227], v[20:23], v[116:119]
    v_mfma_f32_16x16x32_bf16 v[120:123], v[224:227], v[24:27], v[120:123]
    s_waitcnt lgkmcnt(3)
    v_mfma_f32_16x16x32_bf16 v[124:127], v[228:231], v[20:23], v[124:127]
    v_mfma_f32_16x16x32_bf16 v[128:131], v[228:231], v[24:27], v[128:131]
    s_waitcnt lgkmcnt(2)
    v_mfma_f32_16x16x32_bf16 v[132:135], v[232:235], v[20:23], v[132:135]
    v_mfma_f32_16x16x32_bf16 v[136:139], v[232:235], v[24:27], v[136:139]
    s_waitcnt lgkmcnt(1)
    v_mfma_f32_16x16x32_bf16 v[140:143], v[236:239], v[20:23], v[140:143]
    v_mfma_f32_16x16x32_bf16 v[144:147], v[236:239], v[24:27], v[144:147]
    s_waitcnt lgkmcnt(0)
    v_mfma_f32_16x16x32_bf16 v[148:151], v[240:243], v[20:23], v[148:151]
    v_mfma_f32_16x16x32_bf16 v[152:155], v[240:243], v[24:27], v[152:155]
    s_nop 7
    ds_read_b128 v[20:23], v6 offset:704
    ds_read_b128 v[24:27], v6 offset:15552
    ds_read_b128 v[216:219], v4 offset:64
    ds_read_b128 v[220:223], v4 offset:2368
    ds_read_b128 v[224:227], v4 offset:4672
    ds_read_b128 v[228:231], v4 offset:6976
    ds_read_b128 v[232:235], v4 offset:9280
    ds_read_b128 v[236:239], v4 offset:11584
    ds_read_b128 v[240:243], v4 offset:13888
    s_waitcnt lgkmcnt(6)
    v_mfma_f32_16x16x32_bf16 v[100:103], v[216:219], v[20:23], v[100:103]
    v_mfma_f32_16x16x32_bf16 v[104:107], v[216:219], v[24:27], v[104:107]
    s_waitcnt lgkmcnt(5)
    v_mfma_f32_16x16x32_bf16 v[108:111], v[220:223], v[20:23], v[108:111]
    v_mfma_f32_16x16x32_bf16 v[112:115], v[220:223], v[24:27], v[112:115]
    s_waitcnt lgkmcnt(4)
    v_mfma_f32_16x16x32_bf16 v[116:119], v[224:227], v[20:23], v[116:119]
    v_mfma_f32_16x16x32_bf16 v[120:123], v[224:227], v[24:27], v[120:123]
    s_waitcnt lgkmcnt(3)
    v_mfma_f32_16x16x32_bf16 v[124:127], v[228:231], v[20:23], v[124:127]
    v_mfma_f32_16x16x32_bf16 v[128:131], v[228:231], v[24:27], v[128:131]
    s_waitcnt lgkmcnt(2)
    v_mfma_f32_16x16x32_bf16 v[132:135], v[232:235], v[20:23], v[132:135]
    v_mfma_f32_16x16x32_bf16 v[136:139], v[232:235], v[24:27], v[136:139]
    s_waitcnt lgkmcnt(1)
    v_mfma_f32_16x16x32_bf16 v[140:143], v[236:239], v[20:23], v[140:143]
    v_mfma_f32_16x16x32_bf16 v[144:147], v[236:239], v[24:27], v[144:147]
    s_waitcnt lgkmcnt(0)
    v_mfma_f32_16x16x32_bf16 v[148:151], v[240:243], v[20:23], v[148:151]
    v_mfma_f32_16x16x32_bf16 v[152:155], v[240:243], v[24:27], v[152:155]
    s_nop 7
    s_barrier
    s_waitcnt vmcnt(0)
    ds_write_b128 v9, v[160:163] offset:0
    ds_write_b128 v9, v[164:167] offset:4608
    ds_write_b128 v9, v[168:171] offset:9216
    ds_write_b128 v9, v[172:175] offset:13824
    ds_write_b128 v9, v[176:179] offset:18432
    ds_write_b128 v9, v[180:183] offset:23040
    ds_write_b128 v9, v[184:187] offset:27648
    ds_write_b128 v9, v[188:191] offset:32256
    ds_write_b128 v9, v[192:195] offset:36864
    ds_write_b128 v9, v[196:199] offset:41472
    ds_write_b128 v9, v[200:203] offset:46080
    ds_write_b128 v9, v[204:207] offset:50688
    ds_write_b128 v9, v[208:211] offset:55296
    ds_write_b128 v9, v[212:215] offset:59904
    s_waitcnt lgkmcnt(0)
    s_barrier
    ds_read_b128 v[20:23], v6 offset:768
    ds_read_b128 v[24:27], v6 offset:15616
    ds_read_b128 v[216:219], v4 offset:0
    ds_read_b128 v[220:223], v4 offset:2304
    ds_read_b128 v[224:227], v4 offset:4608
    ds_read_b128 v[228:231], v4 offset:6912
    ds_read_b128 v[232:235], v4 offset:9216
    ds_read_b128 v[236:239], v4 offset:11520
    ds_read_b128 v[240:243], v4 offset:13824
    s_waitcnt lgkmcnt(6)
    v_mfma_f32_16x16x32_bf16 v[100:103], v[216:219], v[20:23], v[100:103]
    v_mfma_f32_16x16x32_bf16 v[104:107], v[216:219], v[24:27], v[104:107]
    s_waitcnt lgkmcnt(5)
    v_mfma_f32_16x16x32_bf16 v[108:111], v[220:223], v[20:23], v[108:111]
    v_mfma_f32_16x16x32_bf16 v[112:115], v[220:223], v[24:27], v[112:115]
    s_waitcnt lgkmcnt(4)
    v_mfma_f32_16x16x32_bf16 v[116:119], v[224:227], v[20:23], v[116:119]
    v_mfma_f32_16x16x32_bf16 v[120:123], v[224:227], v[24:27], v[120:123]
    s_waitcnt lgkmcnt(3)
    v_mfma_f32_16x16x32_bf16 v[124:127], v[228:231], v[20:23], v[124:127]
    v_mfma_f32_16x16x32_bf16 v[128:131], v[228:231], v[24:27], v[128:131]
    s_waitcnt lgkmcnt(2)
    v_mfma_f32_16x16x32_bf16 v[132:135], v[232:235], v[20:23], v[132:135]
    v_mfma_f32_16x16x32_bf16 v[136:139], v[232:235], v[24:27], v[136:139]
    s_waitcnt lgkmcnt(1)
    v_mfma_f32_16x16x32_bf16 v[140:143], v[236:239], v[20:23], v[140:143]
    v_mfma_f32_16x16x32_bf16 v[144:147], v[236:239], v[24:27], v[144:147]
    s_waitcnt lgkmcnt(0)
    v_mfma_f32_16x16x32_bf16 v[148:151], v[240:243], v[20:23], v[148:151]
    v_mfma_f32_16x16x32_bf16 v[152:155], v[240:243], v[24:27], v[152:155]
    s_nop 7
    ds_read_b128 v[20:23], v6 offset:832
    ds_read_b128 v[24:27], v6 offset:15680
    ds_read_b128 v[216:219], v4 offset:64
    ds_read_b128 v[220:223], v4 offset:2368
    ds_read_b128 v[224:227], v4 offset:4672
    ds_read_b128 v[228:231], v4 offset:6976
    ds_read_b128 v[232:235], v4 offset:9280
    ds_read_b128 v[236:239], v4 offset:11584
    ds_read_b128 v[240:243], v4 offset:13888
    s_waitcnt lgkmcnt(6)
    v_mfma_f32_16x16x32_bf16 v[100:103], v[216:219], v[20:23], v[100:103]
    v_mfma_f32_16x16x32_bf16 v[104:107], v[216:219], v[24:27], v[104:107]
    s_waitcnt lgkmcnt(5)
    v_mfma_f32_16x16x32_bf16 v[108:111], v[220:223], v[20:23], v[108:111]
    v_mfma_f32_16x16x32_bf16 v[112:115], v[220:223], v[24:27], v[112:115]
    s_waitcnt lgkmcnt(4)
    v_mfma_f32_16x16x32_bf16 v[116:119], v[224:227], v[20:23], v[116:119]
    v_mfma_f32_16x16x32_bf16 v[120:123], v[224:227], v[24:27], v[120:123]
    s_waitcnt lgkmcnt(3)
    v_mfma_f32_16x16x32_bf16 v[124:127], v[228:231], v[20:23], v[124:127]
    v_mfma_f32_16x16x32_bf16 v[128:131], v[228:231], v[24:27], v[128:131]
    s_waitcnt lgkmcnt(2)
    v_mfma_f32_16x16x32_bf16 v[132:135], v[232:235], v[20:23], v[132:135]
    v_mfma_f32_16x16x32_bf16 v[136:139], v[232:235], v[24:27], v[136:139]
    s_waitcnt lgkmcnt(1)
    v_mfma_f32_16x16x32_bf16 v[140:143], v[236:239], v[20:23], v[140:143]
    v_mfma_f32_16x16x32_bf16 v[144:147], v[236:239], v[24:27], v[144:147]
    s_waitcnt lgkmcnt(0)
    v_mfma_f32_16x16x32_bf16 v[148:151], v[240:243], v[20:23], v[148:151]
    v_mfma_f32_16x16x32_bf16 v[152:155], v[240:243], v[24:27], v[152:155]
    s_nop 7
    s_barrier
    s_nop 15
    s_nop 7
    v_add_u32 v7, s42, v2
    v_mul_u32_u24 v7, 1792, v7
    v_lshlrev_b32 v8, 3, v3
    v_add_u32 v7, v7, v8
    s_lshl_b32 s43, s55, 1
    s_add_u32 s43, s43, 6094848
    v_mul_f32 v30, v100, v100
    v_fma_f32 v30, v30, s60, v31
    v_mul_f32 v30, v30, v100
    v_exp_f32 v30, v30
    s_nop 0
    v_add_f32 v30, 1.0, v30
    v_rcp_f32 v30, v30
    s_nop 0
    v_fma_f32 v100, -v100, v30, v100
    v_mul_f32 v30, v101, v101
    v_fma_f32 v30, v30, s60, v31
    v_mul_f32 v30, v30, v101
    v_exp_f32 v30, v30
    s_nop 0
    v_add_f32 v30, 1.0, v30
    v_rcp_f32 v30, v30
    s_nop 0
    v_fma_f32 v101, -v101, v30, v101
    v_mul_f32 v30, v102, v102
    v_fma_f32 v30, v30, s60, v31
    v_mul_f32 v30, v30, v102
    v_exp_f32 v30, v30
    s_nop 0
    v_add_f32 v30, 1.0, v30
    v_rcp_f32 v30, v30
    s_nop 0
    v_fma_f32 v102, -v102, v30, v102
    v_mul_f32 v30, v103, v103
    v_fma_f32 v30, v30, s60, v31
    v_mul_f32 v30, v30, v103
    v_exp_f32 v30, v30
    s_nop 0
    v_add_f32 v30, 1.0, v30
    v_rcp_f32 v30, v30
    s_nop 0
    v_fma_f32 v103, -v103, v30, v103
    v_cvt_pk_bf16_f32 v32, v100, v101
    v_cvt_pk_bf16_f32 v33, v102, v103
    buffer_store_dwordx2 v[32:33], v7, s[28:31], s43 offen offset:0
    v_mul_f32 v30, v104, v104
    v_fma_f32 v30, v30, s60, v31
    v_mul_f32 v30, v30, v104
    v_exp_f32 v30, v30
    s_nop 0
    v_add_f32 v30, 1.0, v30
    v_rcp_f32 v30, v30
    s_nop 0
    v_fma_f32 v104, -v104, v30, v104
    v_mul_f32 v30, v105, v105
    v_fma_f32 v30, v30, s60, v31
    v_mul_f32 v30, v30, v105
    v_exp_f32 v30, v30
    s_nop 0
    v_add_f32 v30, 1.0, v30
    v_rcp_f32 v30, v30
    s_nop 0
    v_fma_f32 v105, -v105, v30, v105
    v_mul_f32 v30, v106, v106
    v_fma_f32 v30, v30, s60, v31
    v_mul_f32 v30, v30, v106
    v_exp_f32 v30, v30
    s_nop 0
    v_add_f32 v30, 1.0, v30
    v_rcp_f32 v30, v30
    s_nop 0
    v_fma_f32 v106, -v106, v30, v106
    v_mul_f32 v30, v107, v107
    v_fma_f32 v30, v30, s60, v31
    v_mul_f32 v30, v30, v107
    v_exp_f32 v30, v30
    s_nop 0
    v_add_f32 v30, 1.0, v30
    v_rcp_f32 v30, v30
    s_nop 0
    v_fma_f32 v107, -v107, v30, v107
    v_cvt_pk_bf16_f32 v32, v104, v105
    v_cvt_pk_bf16_f32 v33, v106, v107
    v_add_u32 v8, 28672, v7
    buffer_store_dwordx2 v[32:33], v8, s[28:31], s43 offen offset:0
    v_mul_f32 v30, v108, v108
    v_fma_f32 v30, v30, s60, v31
    v_mul_f32 v30, v30, v108
    v_exp_f32 v30, v30
    s_nop 0
    v_add_f32 v30, 1.0, v30
    v_rcp_f32 v30, v30
    s_nop 0
    v_fma_f32 v108, -v108, v30, v108
    v_mul_f32 v30, v109, v109
    v_fma_f32 v30, v30, s60, v31
    v_mul_f32 v30, v30, v109
    v_exp_f32 v30, v30
    s_nop 0
    v_add_f32 v30, 1.0, v30
    v_rcp_f32 v30, v30
    s_nop 0
    v_fma_f32 v109, -v109, v30, v109
    v_mul_f32 v30, v110, v110
    v_fma_f32 v30, v30, s60, v31
    v_mul_f32 v30, v30, v110
    v_exp_f32 v30, v30
    s_nop 0
    v_add_f32 v30, 1.0, v30
    v_rcp_f32 v30, v30
    s_nop 0
    v_fma_f32 v110, -v110, v30, v110
    v_mul_f32 v30, v111, v111
    v_fma_f32 v30, v30, s60, v31
    v_mul_f32 v30, v30, v111
    v_exp_f32 v30, v30
    s_nop 0
    v_add_f32 v30, 1.0, v30
    v_rcp_f32 v30, v30
    s_nop 0
    v_fma_f32 v111, -v111, v30, v111
    v_cvt_pk_bf16_f32 v32, v108, v109
    v_cvt_pk_bf16_f32 v33, v110, v111
    buffer_store_dwordx2 v[32:33], v7, s[28:31], s43 offen offset:32
    v_mul_f32 v30, v112, v112
    v_fma_f32 v30, v30, s60, v31
    v_mul_f32 v30, v30, v112
    v_exp_f32 v30, v30
    s_nop 0
    v_add_f32 v30, 1.0, v30
    v_rcp_f32 v30, v30
    s_nop 0
    v_fma_f32 v112, -v112, v30, v112
    v_mul_f32 v30, v113, v113
    v_fma_f32 v30, v30, s60, v31
    v_mul_f32 v30, v30, v113
    v_exp_f32 v30, v30
    s_nop 0
    v_add_f32 v30, 1.0, v30
    v_rcp_f32 v30, v30
    s_nop 0
    v_fma_f32 v113, -v113, v30, v113
    v_mul_f32 v30, v114, v114
    v_fma_f32 v30, v30, s60, v31
    v_mul_f32 v30, v30, v114
    v_exp_f32 v30, v30
    s_nop 0
    v_add_f32 v30, 1.0, v30
    v_rcp_f32 v30, v30
    s_nop 0
    v_fma_f32 v114, -v114, v30, v114
    v_mul_f32 v30, v115, v115
    v_fma_f32 v30, v30, s60, v31
    v_mul_f32 v30, v30, v115
    v_exp_f32 v30, v30
    s_nop 0
    v_add_f32 v30, 1.0, v30
    v_rcp_f32 v30, v30
    s_nop 0
    v_fma_f32 v115, -v115, v30, v115
    v_cvt_pk_bf16_f32 v32, v112, v113
    v_cvt_pk_bf16_f32 v33, v114, v115
    v_add_u32 v8, 28672, v7
    buffer_store_dwordx2 v[32:33], v8, s[28:31], s43 offen offset:32
    v_mul_f32 v30, v116, v116
    v_fma_f32 v30, v30, s60, v31
    v_mul_f32 v30, v30, v116
    v_exp_f32 v30, v30
    s_nop 0
    v_add_f32 v30, 1.0, v30
    v_rcp_f32 v30, v30
    s_nop 0
    v_fma_f32 v116, -v116, v30, v116
    v_mul_f32 v30, v117, v117
    v_fma_f32 v30, v30, s60, v31
    v_mul_f32 v30, v30, v117
    v_exp_f32 v30, v30
    s_nop 0
    v_add_f32 v30, 1.0, v30
    v_rcp_f32 v30, v30
    s_nop 0
    v_fma_f32 v117, -v117, v30, v117
    v_mul_f32 v30, v118, v118
    v_fma_f32 v30, v30, s60, v31
    v_mul_f32 v30, v30, v118
    v_exp_f32 v30, v30
    s_nop 0
    v_add_f32 v30, 1.0, v30
    v_rcp_f32 v30, v30
    s_nop 0
    v_fma_f32 v118, -v118, v30, v118
    v_mul_f32 v30, v119, v119
    v_fma_f32 v30, v30, s60, v31
    v_mul_f32 v30, v30, v119
    v_exp_f32 v30, v30
    s_nop 0
    v_add_f32 v30, 1.0, v30
    v_rcp_f32 v30, v30
    s_nop 0
    v_fma_f32 v119, -v119, v30, v119
    v_cvt_pk_bf16_f32 v32, v116, v117
    v_cvt_pk_bf16_f32 v33, v118, v119
    buffer_store_dwordx2 v[32:33], v7, s[28:31], s43 offen offset:64
    v_mul_f32 v30, v120, v120
    v_fma_f32 v30, v30, s60, v31
    v_mul_f32 v30, v30, v120
    v_exp_f32 v30, v30
    s_nop 0
    v_add_f32 v30, 1.0, v30
    v_rcp_f32 v30, v30
    s_nop 0
    v_fma_f32 v120, -v120, v30, v120
    v_mul_f32 v30, v121, v121
    v_fma_f32 v30, v30, s60, v31
    v_mul_f32 v30, v30, v121
    v_exp_f32 v30, v30
    s_nop 0
    v_add_f32 v30, 1.0, v30
    v_rcp_f32 v30, v30
    s_nop 0
    v_fma_f32 v121, -v121, v30, v121
    v_mul_f32 v30, v122, v122
    v_fma_f32 v30, v30, s60, v31
    v_mul_f32 v30, v30, v122
    v_exp_f32 v30, v30
    s_nop 0
    v_add_f32 v30, 1.0, v30
    v_rcp_f32 v30, v30
    s_nop 0
    v_fma_f32 v122, -v122, v30, v122
    v_mul_f32 v30, v123, v123
    v_fma_f32 v30, v30, s60, v31
    v_mul_f32 v30, v30, v123
    v_exp_f32 v30, v30
    s_nop 0
    v_add_f32 v30, 1.0, v30
    v_rcp_f32 v30, v30
    s_nop 0
    v_fma_f32 v123, -v123, v30, v123
    v_cvt_pk_bf16_f32 v32, v120, v121
    v_cvt_pk_bf16_f32 v33, v122, v123
    v_add_u32 v8, 28672, v7
    buffer_store_dwordx2 v[32:33], v8, s[28:31], s43 offen offset:64
    v_mul_f32 v30, v124, v124
    v_fma_f32 v30, v30, s60, v31
    v_mul_f32 v30, v30, v124
    v_exp_f32 v30, v30
    s_nop 0
    v_add_f32 v30, 1.0, v30
    v_rcp_f32 v30, v30
    s_nop 0
    v_fma_f32 v124, -v124, v30, v124
    v_mul_f32 v30, v125, v125
    v_fma_f32 v30, v30, s60, v31
    v_mul_f32 v30, v30, v125
    v_exp_f32 v30, v30
    s_nop 0
    v_add_f32 v30, 1.0, v30
    v_rcp_f32 v30, v30
    s_nop 0
    v_fma_f32 v125, -v125, v30, v125
    v_mul_f32 v30, v126, v126
    v_fma_f32 v30, v30, s60, v31
    v_mul_f32 v30, v30, v126
    v_exp_f32 v30, v30
    s_nop 0
    v_add_f32 v30, 1.0, v30
    v_rcp_f32 v30, v30
    s_nop 0
    v_fma_f32 v126, -v126, v30, v126
    v_mul_f32 v30, v127, v127
    v_fma_f32 v30, v30, s60, v31
    v_mul_f32 v30, v30, v127
    v_exp_f32 v30, v30
    s_nop 0
    v_add_f32 v30, 1.0, v30
    v_rcp_f32 v30, v30
    s_nop 0
    v_fma_f32 v127, -v127, v30, v127
    v_cvt_pk_bf16_f32 v32, v124, v125
    v_cvt_pk_bf16_f32 v33, v126, v127
    buffer_store_dwordx2 v[32:33], v7, s[28:31], s43 offen offset:96
    v_mul_f32 v30, v128, v128
    v_fma_f32 v30, v30, s60, v31
    v_mul_f32 v30, v30, v128
    v_exp_f32 v30, v30
    s_nop 0
    v_add_f32 v30, 1.0, v30
    v_rcp_f32 v30, v30
    s_nop 0
    v_fma_f32 v128, -v128, v30, v128
    v_mul_f32 v30, v129, v129
    v_fma_f32 v30, v30, s60, v31
    v_mul_f32 v30, v30, v129
    v_exp_f32 v30, v30
    s_nop 0
    v_add_f32 v30, 1.0, v30
    v_rcp_f32 v30, v30
    s_nop 0
    v_fma_f32 v129, -v129, v30, v129
    v_mul_f32 v30, v130, v130
    v_fma_f32 v30, v30, s60, v31
    v_mul_f32 v30, v30, v130
    v_exp_f32 v30, v30
    s_nop 0
    v_add_f32 v30, 1.0, v30
    v_rcp_f32 v30, v30
    s_nop 0
    v_fma_f32 v130, -v130, v30, v130
    v_mul_f32 v30, v131, v131
    v_fma_f32 v30, v30, s60, v31
    v_mul_f32 v30, v30, v131
    v_exp_f32 v30, v30
    s_nop 0
    v_add_f32 v30, 1.0, v30
    v_rcp_f32 v30, v30
    s_nop 0
    v_fma_f32 v131, -v131, v30, v131
    v_cvt_pk_bf16_f32 v32, v128, v129
    v_cvt_pk_bf16_f32 v33, v130, v131
    v_add_u32 v8, 28672, v7
    buffer_store_dwordx2 v[32:33], v8, s[28:31], s43 offen offset:96
    v_mul_f32 v30, v132, v132
    v_fma_f32 v30, v30, s60, v31
    v_mul_f32 v30, v30, v132
    v_exp_f32 v30, v30
    s_nop 0
    v_add_f32 v30, 1.0, v30
    v_rcp_f32 v30, v30
    s_nop 0
    v_fma_f32 v132, -v132, v30, v132
    v_mul_f32 v30, v133, v133
    v_fma_f32 v30, v30, s60, v31
    v_mul_f32 v30, v30, v133
    v_exp_f32 v30, v30
    s_nop 0
    v_add_f32 v30, 1.0, v30
    v_rcp_f32 v30, v30
    s_nop 0
    v_fma_f32 v133, -v133, v30, v133
    v_mul_f32 v30, v134, v134
    v_fma_f32 v30, v30, s60, v31
    v_mul_f32 v30, v30, v134
    v_exp_f32 v30, v30
    s_nop 0
    v_add_f32 v30, 1.0, v30
    v_rcp_f32 v30, v30
    s_nop 0
    v_fma_f32 v134, -v134, v30, v134
    v_mul_f32 v30, v135, v135
    v_fma_f32 v30, v30, s60, v31
    v_mul_f32 v30, v30, v135
    v_exp_f32 v30, v30
    s_nop 0
    v_add_f32 v30, 1.0, v30
    v_rcp_f32 v30, v30
    s_nop 0
    v_fma_f32 v135, -v135, v30, v135
    v_cvt_pk_bf16_f32 v32, v132, v133
    v_cvt_pk_bf16_f32 v33, v134, v135
    buffer_store_dwordx2 v[32:33], v7, s[28:31], s43 offen offset:128
    v_mul_f32 v30, v136, v136
    v_fma_f32 v30, v30, s60, v31
    v_mul_f32 v30, v30, v136
    v_exp_f32 v30, v30
    s_nop 0
    v_add_f32 v30, 1.0, v30
    v_rcp_f32 v30, v30
    s_nop 0
    v_fma_f32 v136, -v136, v30, v136
    v_mul_f32 v30, v137, v137
    v_fma_f32 v30, v30, s60, v31
    v_mul_f32 v30, v30, v137
    v_exp_f32 v30, v30
    s_nop 0
    v_add_f32 v30, 1.0, v30
    v_rcp_f32 v30, v30
    s_nop 0
    v_fma_f32 v137, -v137, v30, v137
    v_mul_f32 v30, v138, v138
    v_fma_f32 v30, v30, s60, v31
    v_mul_f32 v30, v30, v138
    v_exp_f32 v30, v30
    s_nop 0
    v_add_f32 v30, 1.0, v30
    v_rcp_f32 v30, v30
    s_nop 0
    v_fma_f32 v138, -v138, v30, v138
    v_mul_f32 v30, v139, v139
    v_fma_f32 v30, v30, s60, v31
    v_mul_f32 v30, v30, v139
    v_exp_f32 v30, v30
    s_nop 0
    v_add_f32 v30, 1.0, v30
    v_rcp_f32 v30, v30
    s_nop 0
    v_fma_f32 v139, -v139, v30, v139
    v_cvt_pk_bf16_f32 v32, v136, v137
    v_cvt_pk_bf16_f32 v33, v138, v139
    v_add_u32 v8, 28672, v7
    buffer_store_dwordx2 v[32:33], v8, s[28:31], s43 offen offset:128
    v_mul_f32 v30, v140, v140
    v_fma_f32 v30, v30, s60, v31
    v_mul_f32 v30, v30, v140
    v_exp_f32 v30, v30
    s_nop 0
    v_add_f32 v30, 1.0, v30
    v_rcp_f32 v30, v30
    s_nop 0
    v_fma_f32 v140, -v140, v30, v140
    v_mul_f32 v30, v141, v141
    v_fma_f32 v30, v30, s60, v31
    v_mul_f32 v30, v30, v141
    v_exp_f32 v30, v30
    s_nop 0
    v_add_f32 v30, 1.0, v30
    v_rcp_f32 v30, v30
    s_nop 0
    v_fma_f32 v141, -v141, v30, v141
    v_mul_f32 v30, v142, v142
    v_fma_f32 v30, v30, s60, v31
    v_mul_f32 v30, v30, v142
    v_exp_f32 v30, v30
    s_nop 0
    v_add_f32 v30, 1.0, v30
    v_rcp_f32 v30, v30
    s_nop 0
    v_fma_f32 v142, -v142, v30, v142
    v_mul_f32 v30, v143, v143
    v_fma_f32 v30, v30, s60, v31
    v_mul_f32 v30, v30, v143
    v_exp_f32 v30, v30
    s_nop 0
    v_add_f32 v30, 1.0, v30
    v_rcp_f32 v30, v30
    s_nop 0
    v_fma_f32 v143, -v143, v30, v143
    v_cvt_pk_bf16_f32 v32, v140, v141
    v_cvt_pk_bf16_f32 v33, v142, v143
    buffer_store_dwordx2 v[32:33], v7, s[28:31], s43 offen offset:160
    v_mul_f32 v30, v144, v144
    v_fma_f32 v30, v30, s60, v31
    v_mul_f32 v30, v30, v144
    v_exp_f32 v30, v30
    s_nop 0
    v_add_f32 v30, 1.0, v30
    v_rcp_f32 v30, v30
    s_nop 0
    v_fma_f32 v144, -v144, v30, v144
    v_mul_f32 v30, v145, v145
    v_fma_f32 v30, v30, s60, v31
    v_mul_f32 v30, v30, v145
    v_exp_f32 v30, v30
    s_nop 0
    v_add_f32 v30, 1.0, v30
    v_rcp_f32 v30, v30
    s_nop 0
    v_fma_f32 v145, -v145, v30, v145
    v_mul_f32 v30, v146, v146
    v_fma_f32 v30, v30, s60, v31
    v_mul_f32 v30, v30, v146
    v_exp_f32 v30, v30
    s_nop 0
    v_add_f32 v30, 1.0, v30
    v_rcp_f32 v30, v30
    s_nop 0
    v_fma_f32 v146, -v146, v30, v146
    v_mul_f32 v30, v147, v147
    v_fma_f32 v30, v30, s60, v31
    v_mul_f32 v30, v30, v147
    v_exp_f32 v30, v30
    s_nop 0
    v_add_f32 v30, 1.0, v30
    v_rcp_f32 v30, v30
    s_nop 0
    v_fma_f32 v147, -v147, v30, v147
    v_cvt_pk_bf16_f32 v32, v144, v145
    v_cvt_pk_bf16_f32 v33, v146, v147
    v_add_u32 v8, 28672, v7
    buffer_store_dwordx2 v[32:33], v8, s[28:31], s43 offen offset:160
    v_mul_f32 v30, v148, v148
    v_fma_f32 v30, v30, s60, v31
    v_mul_f32 v30, v30, v148
    v_exp_f32 v30, v30
    s_nop 0
    v_add_f32 v30, 1.0, v30
    v_rcp_f32 v30, v30
    s_nop 0
    v_fma_f32 v148, -v148, v30, v148
    v_mul_f32 v30, v149, v149
    v_fma_f32 v30, v30, s60, v31
    v_mul_f32 v30, v30, v149
    v_exp_f32 v30, v30
    s_nop 0
    v_add_f32 v30, 1.0, v30
    v_rcp_f32 v30, v30
    s_nop 0
    v_fma_f32 v149, -v149, v30, v149
    v_mul_f32 v30, v150, v150
    v_fma_f32 v30, v30, s60, v31
    v_mul_f32 v30, v30, v150
    v_exp_f32 v30, v30
    s_nop 0
    v_add_f32 v30, 1.0, v30
    v_rcp_f32 v30, v30
    s_nop 0
    v_fma_f32 v150, -v150, v30, v150
    v_mul_f32 v30, v151, v151
    v_fma_f32 v30, v30, s60, v31
    v_mul_f32 v30, v30, v151
    v_exp_f32 v30, v30
    s_nop 0
    v_add_f32 v30, 1.0, v30
    v_rcp_f32 v30, v30
    s_nop 0
    v_fma_f32 v151, -v151, v30, v151
    v_cvt_pk_bf16_f32 v32, v148, v149
    v_cvt_pk_bf16_f32 v33, v150, v151
    buffer_store_dwordx2 v[32:33], v7, s[28:31], s43 offen offset:192
    v_mul_f32 v30, v152, v152
    v_fma_f32 v30, v30, s60, v31
    v_mul_f32 v30, v30, v152
    v_exp_f32 v30, v30
    s_nop 0
    v_add_f32 v30, 1.0, v30
    v_rcp_f32 v30, v30
    s_nop 0
    v_fma_f32 v152, -v152, v30, v152
    v_mul_f32 v30, v153, v153
    v_fma_f32 v30, v30, s60, v31
    v_mul_f32 v30, v30, v153
    v_exp_f32 v30, v30
    s_nop 0
    v_add_f32 v30, 1.0, v30
    v_rcp_f32 v30, v30
    s_nop 0
    v_fma_f32 v153, -v153, v30, v153
    v_mul_f32 v30, v154, v154
    v_fma_f32 v30, v30, s60, v31
    v_mul_f32 v30, v30, v154
    v_exp_f32 v30, v30
    s_nop 0
    v_add_f32 v30, 1.0, v30
    v_rcp_f32 v30, v30
    s_nop 0
    v_fma_f32 v154, -v154, v30, v154
    v_mul_f32 v30, v155, v155
    v_fma_f32 v30, v30, s60, v31
    v_mul_f32 v30, v30, v155
    v_exp_f32 v30, v30
    s_nop 0
    v_add_f32 v30, 1.0, v30
    v_rcp_f32 v30, v30
    s_nop 0
    v_fma_f32 v155, -v155, v30, v155
    v_cvt_pk_bf16_f32 v32, v152, v153
    v_cvt_pk_bf16_f32 v33, v154, v155
    v_add_u32 v8, 28672, v7
    buffer_store_dwordx2 v[32:33], v8, s[28:31], s43 offen offset:192
    s_waitcnt vmcnt(0)
    s_branch K2_END
K2_Z2:
    s_mov_b32 s43, 1851392
    v_add_u32 v8, 0, v7
    buffer_load_dwordx4 v[160:163], v8, s[28:31], s43 offen
    v_add_u32 v8, 28672, v7
    buffer_load_dwordx4 v[164:167], v8, s[28:31], s43 offen
    v_add_u32 v8, 57344, v7
    buffer_load_dwordx4 v[168:171], v8, s[28:31], s43 offen
    v_add_u32 v8, 86016, v7
    buffer_load_dwordx4 v[172:175], v8, s[28:31], s43 offen
    v_add_u32 v8, 114688, v7
    buffer_load_dwordx4 v[176:179], v8, s[28:31], s43 offen
    v_add_u32 v8, 143360, v7
    buffer_load_dwordx4 v[180:183], v8, s[28:31], s43 offen
    v_add_u32 v8, 172032, v7
    buffer_load_dwordx4 v[184:187], v8, s[28:31], s43 offen
    v_add_u32 v8, 200704, v7
    buffer_load_dwordx4 v[188:191], v8, s[28:31], s43 offen
    v_add_u32 v8, 229376, v7
    buffer_load_dwordx4 v[192:195], v8, s[28:31], s43 offen
    v_add_u32 v8, 258048, v7
    buffer_load_dwordx4 v[196:199], v8, s[28:31], s43 offen
    v_add_u32 v8, 286720, v7
    buffer_load_dwordx4 v[200:203], v8, s[28:31], s43 offen
    v_add_u32 v8, 315392, v7
    buffer_load_dwordx4 v[204:207], v8, s[28:31], s43 offen
    v_add_u32 v8, 344064, v7
    buffer_load_dwordx4 v[208:211], v8, s[28:31], s43 offen
    v_add_u32 v8, 372736, v7
    buffer_load_dwordx4 v[212:215], v8, s[28:31], s43 offen
    s_add_u32 s43, s43, 128
    s_waitcnt vmcnt(0)
    ds_write_b128 v9, v[160:163] offset:0
    ds_write_b128 v9, v[164:167] offset:4608
    ds_write_b128 v9, v[168:171] offset:9216
    ds_write_b128 v9, v[172:175] offset:13824
    ds_write_b128 v9, v[176:179] offset:18432
    ds_write_b128 v9, v[180:183] offset:23040
    ds_write_b128 v9, v[184:187] offset:27648
    ds_write_b128 v9, v[188:191] offset:32256
    ds_write_b128 v9, v[192:195] offset:36864
    ds_write_b128 v9, v[196:199] offset:41472
    ds_write_b128 v9, v[200:203] offset:46080
    ds_write_b128 v9, v[204:207] offset:50688
    ds_write_b128 v9, v[208:211] offset:55296
    ds_write_b128 v9, v[212:215] offset:59904
    s_waitcnt lgkmcnt(0)
    s_barrier
    v_add_u32 v8, 0, v7
    buffer_load_dwordx4 v[160:163], v8, s[28:31], s43 offen
    v_add_u32 v8, 28672, v7
    buffer_load_dwordx4 v[164:167], v8, s[28:31], s43 offen
    v_add_u32 v8, 57344, v7
    buffer_load_dwordx4 v[168:171], v8, s[28:31], s43 offen
    v_add_u32 v8, 86016, v7
    buffer_load_dwordx4 v[172:175], v8, s[28:31], s43 offen
    v_add_u32 v8, 114688, v7
    buffer_load_dwordx4 v[176:179], v8, s[28:31], s43 offen
    v_add_u32 v8, 143360, v7
    buffer_load_dwordx4 v[180:183], v8, s[28:31], s43 offen
    v_add_u32 v8, 172032, v7
    buffer_load_dwordx4 v[184:187], v8, s[28:31], s43 offen
    v_add_u32 v8, 200704, v7
    buffer_load_dwordx4 v[188:191], v8, s[28:31], s43 offen
    v_add_u32 v8, 229376, v7
    buffer_load_dwordx4 v[192:195], v8, s[28:31], s43 offen
    v_add_u32 v8, 258048, v7
    buffer_load_dwordx4 v[196:199], v8, s[28:31], s43 offen
    v_add_u32 v8, 286720, v7
    buffer_load_dwordx4 v[200:203], v8, s[28:31], s43 offen
    v_add_u32 v8, 315392, v7
    buffer_load_dwordx4 v[204:207], v8, s[28:31], s43 offen
    v_add_u32 v8, 344064, v7
    buffer_load_dwordx4 v[208:211], v8, s[28:31], s43 offen
    v_add_u32 v8, 372736, v7
    buffer_load_dwordx4 v[212:215], v8, s[28:31], s43 offen
    s_add_u32 s43, s43, 128
    ds_read_b128 v[20:23], v6 offset:0
    ds_read_b128 v[24:27], v6 offset:14848
    ds_read_b128 v[216:219], v4 offset:0
    ds_read_b128 v[220:223], v4 offset:2304
    ds_read_b128 v[224:227], v4 offset:4608
    ds_read_b128 v[228:231], v4 offset:6912
    ds_read_b128 v[232:235], v4 offset:9216
    ds_read_b128 v[236:239], v4 offset:11520
    ds_read_b128 v[240:243], v4 offset:13824
    s_waitcnt lgkmcnt(6)
    v_mfma_f32_16x16x32_bf16 v[100:103], v[20:23], v[216:219], v[100:103]
    v_mfma_f32_16x16x32_bf16 v[104:107], v[24:27], v[216:219], v[104:107]
    s_waitcnt lgkmcnt(5)
    v_mfma_f32_16x16x32_bf16 v[108:111], v[20:23], v[220:223], v[108:111]
    v_mfma_f32_16x16x32_bf16 v[112:115], v[24:27], v[220:223], v[112:115]
    s_waitcnt lgkmcnt(4)
    v_mfma_f32_16x16x32_bf16 v[116:119], v[20:23], v[224:227], v[116:119]
    v_mfma_f32_16x16x32_bf16 v[120:123], v[24:27], v[224:227], v[120:123]
    s_waitcnt lgkmcnt(3)
    v_mfma_f32_16x16x32_bf16 v[124:127], v[20:23], v[228:231], v[124:127]
    v_mfma_f32_16x16x32_bf16 v[128:131], v[24:27], v[228:231], v[128:131]
    s_waitcnt lgkmcnt(2)
    v_mfma_f32_16x16x32_bf16 v[132:135], v[20:23], v[232:235], v[132:135]
    v_mfma_f32_16x16x32_bf16 v[136:139], v[24:27], v[232:235], v[136:139]
    s_waitcnt lgkmcnt(1)
    v_mfma_f32_16x16x32_bf16 v[140:143], v[20:23], v[236:239], v[140:143]
    v_mfma_f32_16x16x32_bf16 v[144:147], v[24:27], v[236:239], v[144:147]
    s_waitcnt lgkmcnt(0)
    v_mfma_f32_16x16x32_bf16 v[148:151], v[20:23], v[240:243], v[148:151]
    v_mfma_f32_16x16x32_bf16 v[152:155], v[24:27], v[240:243], v[152:155]
    s_nop 7
    ds_read_b128 v[20:23], v6 offset:64
    ds_read_b128 v[24:27], v6 offset:14912
    ds_read_b128 v[216:219], v4 offset:64
    ds_read_b128 v[220:223], v4 offset:2368
    ds_read_b128 v[224:227], v4 offset:4672
    ds_read_b128 v[228:231], v4 offset:6976
    ds_read_b128 v[232:235], v4 offset:9280
    ds_read_b128 v[236:239], v4 offset:11584
    ds_read_b128 v[240:243], v4 offset:13888
    s_waitcnt lgkmcnt(6)
    v_mfma_f32_16x16x32_bf16 v[100:103], v[20:23], v[216:219], v[100:103]
    v_mfma_f32_16x16x32_bf16 v[104:107], v[24:27], v[216:219], v[104:107]
    s_waitcnt lgkmcnt(5)
    v_mfma_f32_16x16x32_bf16 v[108:111], v[20:23], v[220:223], v[108:111]
    v_mfma_f32_16x16x32_bf16 v[112:115], v[24:27], v[220:223], v[112:115]
    s_waitcnt lgkmcnt(4)
    v_mfma_f32_16x16x32_bf16 v[116:119], v[20:23], v[224:227], v[116:119]
    v_mfma_f32_16x16x32_bf16 v[120:123], v[24:27], v[224:227], v[120:123]
    s_waitcnt lgkmcnt(3)
    v_mfma_f32_16x16x32_bf16 v[124:127], v[20:23], v[228:231], v[124:127]
    v_mfma_f32_16x16x32_bf16 v[128:131], v[24:27], v[228:231], v[128:131]
    s_waitcnt lgkmcnt(2)
    v_mfma_f32_16x16x32_bf16 v[132:135], v[20:23], v[232:235], v[132:135]
    v_mfma_f32_16x16x32_bf16 v[136:139], v[24:27], v[232:235], v[136:139]
    s_waitcnt lgkmcnt(1)
    v_mfma_f32_16x16x32_bf16 v[140:143], v[20:23], v[236:239], v[140:143]
    v_mfma_f32_16x16x32_bf16 v[144:147], v[24:27], v[236:239], v[144:147]
    s_waitcnt lgkmcnt(0)
    v_mfma_f32_16x16x32_bf16 v[148:151], v[20:23], v[240:243], v[148:151]
    v_mfma_f32_16x16x32_bf16 v[152:155], v[24:27], v[240:243], v[152:155]
    s_nop 7
    s_barrier
    s_waitcnt vmcnt(0)
    ds_write_b128 v9, v[160:163] offset:0
    ds_write_b128 v9, v[164:167] offset:4608
    ds_write_b128 v9, v[168:171] offset:9216
    ds_write_b128 v9, v[172:175] offset:13824
    ds_write_b128 v9, v[176:179] offset:18432
    ds_write_b128 v9, v[180:183] offset:23040
    ds_write_b128 v9, v[184:187] offset:27648
    ds_write_b128 v9, v[188:191] offset:32256
    ds_write_b128 v9, v[192:195] offset:36864
    ds_write_b128 v9, v[196:199] offset:41472
    ds_write_b128 v9, v[200:203] offset:46080
    ds_write_b128 v9, v[204:207] offset:50688
    ds_write_b128 v9, v[208:211] offset:55296
    ds_write_b128 v9, v[212:215] offset:59904
    s_waitcnt lgkmcnt(0)
    s_barrier
    v_add_u32 v8, 0, v7
    buffer_load_dwordx4 v[160:163], v8, s[28:31], s43 offen
    v_add_u32 v8, 28672, v7
    buffer_load_dwordx4 v[164:167], v8, s[28:31], s43 offen
    v_add_u32 v8, 57344, v7
    buffer_load_dwordx4 v[168:171], v8, s[28:31], s43 offen
    v_add_u32 v8, 86016, v7
    buffer_load_dwordx4 v[172:175], v8, s[28:31], s43 offen
    v_add_u32 v8, 114688, v7
    buffer_load_dwordx4 v[176:179], v8, s[28:31], s43 offen
    v_add_u32 v8, 143360, v7
    buffer_load_dwordx4 v[180:183], v8, s[28:31], s43 offen
    v_add_u32 v8, 172032, v7
    buffer_load_dwordx4 v[184:187], v8, s[28:31], s43 offen
    v_add_u32 v8, 200704, v7
    buffer_load_dwordx4 v[188:191], v8, s[28:31], s43 offen
    v_add_u32 v8, 229376, v7
    buffer_load_dwordx4 v[192:195], v8, s[28:31], s43 offen
    v_add_u32 v8, 258048, v7
    buffer_load_dwordx4 v[196:199], v8, s[28:31], s43 offen
    v_add_u32 v8, 286720, v7
    buffer_load_dwordx4 v[200:203], v8, s[28:31], s43 offen
    v_add_u32 v8, 315392, v7
    buffer_load_dwordx4 v[204:207], v8, s[28:31], s43 offen
    v_add_u32 v8, 344064, v7
    buffer_load_dwordx4 v[208:211], v8, s[28:31], s43 offen
    v_add_u32 v8, 372736, v7
    buffer_load_dwordx4 v[212:215], v8, s[28:31], s43 offen
    s_add_u32 s43, s43, 128
    ds_read_b128 v[20:23], v6 offset:128
    ds_read_b128 v[24:27], v6 offset:14976
    ds_read_b128 v[216:219], v4 offset:0
    ds_read_b128 v[220:223], v4 offset:2304
    ds_read_b128 v[224:227], v4 offset:4608
    ds_read_b128 v[228:231], v4 offset:6912
    ds_read_b128 v[232:235], v4 offset:9216
    ds_read_b128 v[236:239], v4 offset:11520
    ds_read_b128 v[240:243], v4 offset:13824
    s_waitcnt lgkmcnt(6)
    v_mfma_f32_16x16x32_bf16 v[100:103], v[20:23], v[216:219], v[100:103]
    v_mfma_f32_16x16x32_bf16 v[104:107], v[24:27], v[216:219], v[104:107]
    s_waitcnt lgkmcnt(5)
    v_mfma_f32_16x16x32_bf16 v[108:111], v[20:23], v[220:223], v[108:111]
    v_mfma_f32_16x16x32_bf16 v[112:115], v[24:27], v[220:223], v[112:115]
    s_waitcnt lgkmcnt(4)
    v_mfma_f32_16x16x32_bf16 v[116:119], v[20:23], v[224:227], v[116:119]
    v_mfma_f32_16x16x32_bf16 v[120:123], v[24:27], v[224:227], v[120:123]
    s_waitcnt lgkmcnt(3)
    v_mfma_f32_16x16x32_bf16 v[124:127], v[20:23], v[228:231], v[124:127]
    v_mfma_f32_16x16x32_bf16 v[128:131], v[24:27], v[228:231], v[128:131]
    s_waitcnt lgkmcnt(2)
    v_mfma_f32_16x16x32_bf16 v[132:135], v[20:23], v[232:235], v[132:135]
    v_mfma_f32_16x16x32_bf16 v[136:139], v[24:27], v[232:235], v[136:139]
    s_waitcnt lgkmcnt(1)
    v_mfma_f32_16x16x32_bf16 v[140:143], v[20:23], v[236:239], v[140:143]
    v_mfma_f32_16x16x32_bf16 v[144:147], v[24:27], v[236:239], v[144:147]
    s_waitcnt lgkmcnt(0)
    v_mfma_f32_16x16x32_bf16 v[148:151], v[20:23], v[240:243], v[148:151]
    v_mfma_f32_16x16x32_bf16 v[152:155], v[24:27], v[240:243], v[152:155]
    s_nop 7
    ds_read_b128 v[20:23], v6 offset:192
    ds_read_b128 v[24:27], v6 offset:15040
    ds_read_b128 v[216:219], v4 offset:64
    ds_read_b128 v[220:223], v4 offset:2368
    ds_read_b128 v[224:227], v4 offset:4672
    ds_read_b128 v[228:231], v4 offset:6976
    ds_read_b128 v[232:235], v4 offset:9280
    ds_read_b128 v[236:239], v4 offset:11584
    ds_read_b128 v[240:243], v4 offset:13888
    s_waitcnt lgkmcnt(6)
    v_mfma_f32_16x16x32_bf16 v[100:103], v[20:23], v[216:219], v[100:103]
    v_mfma_f32_16x16x32_bf16 v[104:107], v[24:27], v[216:219], v[104:107]
    s_waitcnt lgkmcnt(5)
    v_mfma_f32_16x16x32_bf16 v[108:111], v[20:23], v[220:223], v[108:111]
    v_mfma_f32_16x16x32_bf16 v[112:115], v[24:27], v[220:223], v[112:115]
    s_waitcnt lgkmcnt(4)
    v_mfma_f32_16x16x32_bf16 v[116:119], v[20:23], v[224:227], v[116:119]
    v_mfma_f32_16x16x32_bf16 v[120:123], v[24:27], v[224:227], v[120:123]
    s_waitcnt lgkmcnt(3)
    v_mfma_f32_16x16x32_bf16 v[124:127], v[20:23], v[228:231], v[124:127]
    v_mfma_f32_16x16x32_bf16 v[128:131], v[24:27], v[228:231], v[128:131]
    s_waitcnt lgkmcnt(2)
    v_mfma_f32_16x16x32_bf16 v[132:135], v[20:23], v[232:235], v[132:135]
    v_mfma_f32_16x16x32_bf16 v[136:139], v[24:27], v[232:235], v[136:139]
    s_waitcnt lgkmcnt(1)
    v_mfma_f32_16x16x32_bf16 v[140:143], v[20:23], v[236:239], v[140:143]
    v_mfma_f32_16x16x32_bf16 v[144:147], v[24:27], v[236:239], v[144:147]
    s_waitcnt lgkmcnt(0)
    v_mfma_f32_16x16x32_bf16 v[148:151], v[20:23], v[240:243], v[148:151]
    v_mfma_f32_16x16x32_bf16 v[152:155], v[24:27], v[240:243], v[152:155]
    s_nop 7
    s_barrier
    s_waitcnt vmcnt(0)
    ds_write_b128 v9, v[160:163] offset:0
    ds_write_b128 v9, v[164:167] offset:4608
    ds_write_b128 v9, v[168:171] offset:9216
    ds_write_b128 v9, v[172:175] offset:13824
    ds_write_b128 v9, v[176:179] offset:18432
    ds_write_b128 v9, v[180:183] offset:23040
    ds_write_b128 v9, v[184:187] offset:27648
    ds_write_b128 v9, v[188:191] offset:32256
    ds_write_b128 v9, v[192:195] offset:36864
    ds_write_b128 v9, v[196:199] offset:41472
    ds_write_b128 v9, v[200:203] offset:46080
    ds_write_b128 v9, v[204:207] offset:50688
    ds_write_b128 v9, v[208:211] offset:55296
    ds_write_b128 v9, v[212:215] offset:59904
    s_waitcnt lgkmcnt(0)
    s_barrier
    v_add_u32 v8, 0, v7
    buffer_load_dwordx4 v[160:163], v8, s[28:31], s43 offen
    v_add_u32 v8, 28672, v7
    buffer_load_dwordx4 v[164:167], v8, s[28:31], s43 offen
    v_add_u32 v8, 57344, v7
    buffer_load_dwordx4 v[168:171], v8, s[28:31], s43 offen
    v_add_u32 v8, 86016, v7
    buffer_load_dwordx4 v[172:175], v8, s[28:31], s43 offen
    v_add_u32 v8, 114688, v7
    buffer_load_dwordx4 v[176:179], v8, s[28:31], s43 offen
    v_add_u32 v8, 143360, v7
    buffer_load_dwordx4 v[180:183], v8, s[28:31], s43 offen
    v_add_u32 v8, 172032, v7
    buffer_load_dwordx4 v[184:187], v8, s[28:31], s43 offen
    v_add_u32 v8, 200704, v7
    buffer_load_dwordx4 v[188:191], v8, s[28:31], s43 offen
    v_add_u32 v8, 229376, v7
    buffer_load_dwordx4 v[192:195], v8, s[28:31], s43 offen
    v_add_u32 v8, 258048, v7
    buffer_load_dwordx4 v[196:199], v8, s[28:31], s43 offen
    v_add_u32 v8, 286720, v7
    buffer_load_dwordx4 v[200:203], v8, s[28:31], s43 offen
    v_add_u32 v8, 315392, v7
    buffer_load_dwordx4 v[204:207], v8, s[28:31], s43 offen
    v_add_u32 v8, 344064, v7
    buffer_load_dwordx4 v[208:211], v8, s[28:31], s43 offen
    v_add_u32 v8, 372736, v7
    buffer_load_dwordx4 v[212:215], v8, s[28:31], s43 offen
    s_add_u32 s43, s43, 128
    ds_read_b128 v[20:23], v6 offset:256
    ds_read_b128 v[24:27], v6 offset:15104
    ds_read_b128 v[216:219], v4 offset:0
    ds_read_b128 v[220:223], v4 offset:2304
    ds_read_b128 v[224:227], v4 offset:4608
    ds_read_b128 v[228:231], v4 offset:6912
    ds_read_b128 v[232:235], v4 offset:9216
    ds_read_b128 v[236:239], v4 offset:11520
    ds_read_b128 v[240:243], v4 offset:13824
    s_waitcnt lgkmcnt(6)
    v_mfma_f32_16x16x32_bf16 v[100:103], v[20:23], v[216:219], v[100:103]
    v_mfma_f32_16x16x32_bf16 v[104:107], v[24:27], v[216:219], v[104:107]
    s_waitcnt lgkmcnt(5)
    v_mfma_f32_16x16x32_bf16 v[108:111], v[20:23], v[220:223], v[108:111]
    v_mfma_f32_16x16x32_bf16 v[112:115], v[24:27], v[220:223], v[112:115]
    s_waitcnt lgkmcnt(4)
    v_mfma_f32_16x16x32_bf16 v[116:119], v[20:23], v[224:227], v[116:119]
    v_mfma_f32_16x16x32_bf16 v[120:123], v[24:27], v[224:227], v[120:123]
    s_waitcnt lgkmcnt(3)
    v_mfma_f32_16x16x32_bf16 v[124:127], v[20:23], v[228:231], v[124:127]
    v_mfma_f32_16x16x32_bf16 v[128:131], v[24:27], v[228:231], v[128:131]
    s_waitcnt lgkmcnt(2)
    v_mfma_f32_16x16x32_bf16 v[132:135], v[20:23], v[232:235], v[132:135]
    v_mfma_f32_16x16x32_bf16 v[136:139], v[24:27], v[232:235], v[136:139]
    s_waitcnt lgkmcnt(1)
    v_mfma_f32_16x16x32_bf16 v[140:143], v[20:23], v[236:239], v[140:143]
    v_mfma_f32_16x16x32_bf16 v[144:147], v[24:27], v[236:239], v[144:147]
    s_waitcnt lgkmcnt(0)
    v_mfma_f32_16x16x32_bf16 v[148:151], v[20:23], v[240:243], v[148:151]
    v_mfma_f32_16x16x32_bf16 v[152:155], v[24:27], v[240:243], v[152:155]
    s_nop 7
    ds_read_b128 v[20:23], v6 offset:320
    ds_read_b128 v[24:27], v6 offset:15168
    ds_read_b128 v[216:219], v4 offset:64
    ds_read_b128 v[220:223], v4 offset:2368
    ds_read_b128 v[224:227], v4 offset:4672
    ds_read_b128 v[228:231], v4 offset:6976
    ds_read_b128 v[232:235], v4 offset:9280
    ds_read_b128 v[236:239], v4 offset:11584
    ds_read_b128 v[240:243], v4 offset:13888
    s_waitcnt lgkmcnt(6)
    v_mfma_f32_16x16x32_bf16 v[100:103], v[20:23], v[216:219], v[100:103]
    v_mfma_f32_16x16x32_bf16 v[104:107], v[24:27], v[216:219], v[104:107]
    s_waitcnt lgkmcnt(5)
    v_mfma_f32_16x16x32_bf16 v[108:111], v[20:23], v[220:223], v[108:111]
    v_mfma_f32_16x16x32_bf16 v[112:115], v[24:27], v[220:223], v[112:115]
    s_waitcnt lgkmcnt(4)
    v_mfma_f32_16x16x32_bf16 v[116:119], v[20:23], v[224:227], v[116:119]
    v_mfma_f32_16x16x32_bf16 v[120:123], v[24:27], v[224:227], v[120:123]
    s_waitcnt lgkmcnt(3)
    v_mfma_f32_16x16x32_bf16 v[124:127], v[20:23], v[228:231], v[124:127]
    v_mfma_f32_16x16x32_bf16 v[128:131], v[24:27], v[228:231], v[128:131]
    s_waitcnt lgkmcnt(2)
    v_mfma_f32_16x16x32_bf16 v[132:135], v[20:23], v[232:235], v[132:135]
    v_mfma_f32_16x16x32_bf16 v[136:139], v[24:27], v[232:235], v[136:139]
    s_waitcnt lgkmcnt(1)
    v_mfma_f32_16x16x32_bf16 v[140:143], v[20:23], v[236:239], v[140:143]
    v_mfma_f32_16x16x32_bf16 v[144:147], v[24:27], v[236:239], v[144:147]
    s_waitcnt lgkmcnt(0)
    v_mfma_f32_16x16x32_bf16 v[148:151], v[20:23], v[240:243], v[148:151]
    v_mfma_f32_16x16x32_bf16 v[152:155], v[24:27], v[240:243], v[152:155]
    s_nop 7
    s_barrier
    s_waitcnt vmcnt(0)
    ds_write_b128 v9, v[160:163] offset:0
    ds_write_b128 v9, v[164:167] offset:4608
    ds_write_b128 v9, v[168:171] offset:9216
    ds_write_b128 v9, v[172:175] offset:13824
    ds_write_b128 v9, v[176:179] offset:18432
    ds_write_b128 v9, v[180:183] offset:23040
    ds_write_b128 v9, v[184:187] offset:27648
    ds_write_b128 v9, v[188:191] offset:32256
    ds_write_b128 v9, v[192:195] offset:36864
    ds_write_b128 v9, v[196:199] offset:41472
    ds_write_b128 v9, v[200:203] offset:46080
    ds_write_b128 v9, v[204:207] offset:50688
    ds_write_b128 v9, v[208:211] offset:55296
    ds_write_b128 v9, v[212:215] offset:59904
    s_waitcnt lgkmcnt(0)
    s_barrier
    v_add_u32 v8, 0, v7
    buffer_load_dwordx4 v[160:163], v8, s[28:31], s43 offen
    v_add_u32 v8, 28672, v7
    buffer_load_dwordx4 v[164:167], v8, s[28:31], s43 offen
    v_add_u32 v8, 57344, v7
    buffer_load_dwordx4 v[168:171], v8, s[28:31], s43 offen
    v_add_u32 v8, 86016, v7
    buffer_load_dwordx4 v[172:175], v8, s[28:31], s43 offen
    v_add_u32 v8, 114688, v7
    buffer_load_dwordx4 v[176:179], v8, s[28:31], s43 offen
    v_add_u32 v8, 143360, v7
    buffer_load_dwordx4 v[180:183], v8, s[28:31], s43 offen
    v_add_u32 v8, 172032, v7
    buffer_load_dwordx4 v[184:187], v8, s[28:31], s43 offen
    v_add_u32 v8, 200704, v7
    buffer_load_dwordx4 v[188:191], v8, s[28:31], s43 offen
    v_add_u32 v8, 229376, v7
    buffer_load_dwordx4 v[192:195], v8, s[28:31], s43 offen
    v_add_u32 v8, 258048, v7
    buffer_load_dwordx4 v[196:199], v8, s[28:31], s43 offen
    v_add_u32 v8, 286720, v7
    buffer_load_dwordx4 v[200:203], v8, s[28:31], s43 offen
    v_add_u32 v8, 315392, v7
    buffer_load_dwordx4 v[204:207], v8, s[28:31], s43 offen
    v_add_u32 v8, 344064, v7
    buffer_load_dwordx4 v[208:211], v8, s[28:31], s43 offen
    v_add_u32 v8, 372736, v7
    buffer_load_dwordx4 v[212:215], v8, s[28:31], s43 offen
    s_add_u32 s43, s43, 128
    ds_read_b128 v[20:23], v6 offset:384
    ds_read_b128 v[24:27], v6 offset:15232
    ds_read_b128 v[216:219], v4 offset:0
    ds_read_b128 v[220:223], v4 offset:2304
    ds_read_b128 v[224:227], v4 offset:4608
    ds_read_b128 v[228:231], v4 offset:6912
    ds_read_b128 v[232:235], v4 offset:9216
    ds_read_b128 v[236:239], v4 offset:11520
    ds_read_b128 v[240:243], v4 offset:13824
    s_waitcnt lgkmcnt(6)
    v_mfma_f32_16x16x32_bf16 v[100:103], v[20:23], v[216:219], v[100:103]
    v_mfma_f32_16x16x32_bf16 v[104:107], v[24:27], v[216:219], v[104:107]
    s_waitcnt lgkmcnt(5)
    v_mfma_f32_16x16x32_bf16 v[108:111], v[20:23], v[220:223], v[108:111]
    v_mfma_f32_16x16x32_bf16 v[112:115], v[24:27], v[220:223], v[112:115]
    s_waitcnt lgkmcnt(4)
    v_mfma_f32_16x16x32_bf16 v[116:119], v[20:23], v[224:227], v[116:119]
    v_mfma_f32_16x16x32_bf16 v[120:123], v[24:27], v[224:227], v[120:123]
    s_waitcnt lgkmcnt(3)
    v_mfma_f32_16x16x32_bf16 v[124:127], v[20:23], v[228:231], v[124:127]
    v_mfma_f32_16x16x32_bf16 v[128:131], v[24:27], v[228:231], v[128:131]
    s_waitcnt lgkmcnt(2)
    v_mfma_f32_16x16x32_bf16 v[132:135], v[20:23], v[232:235], v[132:135]
    v_mfma_f32_16x16x32_bf16 v[136:139], v[24:27], v[232:235], v[136:139]
    s_waitcnt lgkmcnt(1)
    v_mfma_f32_16x16x32_bf16 v[140:143], v[20:23], v[236:239], v[140:143]
    v_mfma_f32_16x16x32_bf16 v[144:147], v[24:27], v[236:239], v[144:147]
    s_waitcnt lgkmcnt(0)
    v_mfma_f32_16x16x32_bf16 v[148:151], v[20:23], v[240:243], v[148:151]
    v_mfma_f32_16x16x32_bf16 v[152:155], v[24:27], v[240:243], v[152:155]
    s_nop 7
    ds_read_b128 v[20:23], v6 offset:448
    ds_read_b128 v[24:27], v6 offset:15296
    ds_read_b128 v[216:219], v4 offset:64
    ds_read_b128 v[220:223], v4 offset:2368
    ds_read_b128 v[224:227], v4 offset:4672
    ds_read_b128 v[228:231], v4 offset:6976
    ds_read_b128 v[232:235], v4 offset:9280
    ds_read_b128 v[236:239], v4 offset:11584
    ds_read_b128 v[240:243], v4 offset:13888
    s_waitcnt lgkmcnt(6)
    v_mfma_f32_16x16x32_bf16 v[100:103], v[20:23], v[216:219], v[100:103]
    v_mfma_f32_16x16x32_bf16 v[104:107], v[24:27], v[216:219], v[104:107]
    s_waitcnt lgkmcnt(5)
    v_mfma_f32_16x16x32_bf16 v[108:111], v[20:23], v[220:223], v[108:111]
    v_mfma_f32_16x16x32_bf16 v[112:115], v[24:27], v[220:223], v[112:115]
    s_waitcnt lgkmcnt(4)
    v_mfma_f32_16x16x32_bf16 v[116:119], v[20:23], v[224:227], v[116:119]
    v_mfma_f32_16x16x32_bf16 v[120:123], v[24:27], v[224:227], v[120:123]
    s_waitcnt lgkmcnt(3)
    v_mfma_f32_16x16x32_bf16 v[124:127], v[20:23], v[228:231], v[124:127]
    v_mfma_f32_16x16x32_bf16 v[128:131], v[24:27], v[228:231], v[128:131]
    s_waitcnt lgkmcnt(2)
    v_mfma_f32_16x16x32_bf16 v[132:135], v[20:23], v[232:235], v[132:135]
    v_mfma_f32_16x16x32_bf16 v[136:139], v[24:27], v[232:235], v[136:139]
    s_waitcnt lgkmcnt(1)
    v_mfma_f32_16x16x32_bf16 v[140:143], v[20:23], v[236:239], v[140:143]
    v_mfma_f32_16x16x32_bf16 v[144:147], v[24:27], v[236:239], v[144:147]
    s_waitcnt lgkmcnt(0)
    v_mfma_f32_16x16x32_bf16 v[148:151], v[20:23], v[240:243], v[148:151]
    v_mfma_f32_16x16x32_bf16 v[152:155], v[24:27], v[240:243], v[152:155]
    s_nop 7
    s_barrier
    s_waitcnt vmcnt(0)
    ds_write_b128 v9, v[160:163] offset:0
    ds_write_b128 v9, v[164:167] offset:4608
    ds_write_b128 v9, v[168:171] offset:9216
    ds_write_b128 v9, v[172:175] offset:13824
    ds_write_b128 v9, v[176:179] offset:18432
    ds_write_b128 v9, v[180:183] offset:23040
    ds_write_b128 v9, v[184:187] offset:27648
    ds_write_b128 v9, v[188:191] offset:32256
    ds_write_b128 v9, v[192:195] offset:36864
    ds_write_b128 v9, v[196:199] offset:41472
    ds_write_b128 v9, v[200:203] offset:46080
    ds_write_b128 v9, v[204:207] offset:50688
    ds_write_b128 v9, v[208:211] offset:55296
    ds_write_b128 v9, v[212:215] offset:59904
    s_waitcnt lgkmcnt(0)
    s_barrier
    v_add_u32 v8, 0, v7
    buffer_load_dwordx4 v[160:163], v8, s[28:31], s43 offen
    v_add_u32 v8, 28672, v7
    buffer_load_dwordx4 v[164:167], v8, s[28:31], s43 offen
    v_add_u32 v8, 57344, v7
    buffer_load_dwordx4 v[168:171], v8, s[28:31], s43 offen
    v_add_u32 v8, 86016, v7
    buffer_load_dwordx4 v[172:175], v8, s[28:31], s43 offen
    v_add_u32 v8, 114688, v7
    buffer_load_dwordx4 v[176:179], v8, s[28:31], s43 offen
    v_add_u32 v8, 143360, v7
    buffer_load_dwordx4 v[180:183], v8, s[28:31], s43 offen
    v_add_u32 v8, 172032, v7
    buffer_load_dwordx4 v[184:187], v8, s[28:31], s43 offen
    v_add_u32 v8, 200704, v7
    buffer_load_dwordx4 v[188:191], v8, s[28:31], s43 offen
    v_add_u32 v8, 229376, v7
    buffer_load_dwordx4 v[192:195], v8, s[28:31], s43 offen
    v_add_u32 v8, 258048, v7
    buffer_load_dwordx4 v[196:199], v8, s[28:31], s43 offen
    v_add_u32 v8, 286720, v7
    buffer_load_dwordx4 v[200:203], v8, s[28:31], s43 offen
    v_add_u32 v8, 315392, v7
    buffer_load_dwordx4 v[204:207], v8, s[28:31], s43 offen
    v_add_u32 v8, 344064, v7
    buffer_load_dwordx4 v[208:211], v8, s[28:31], s43 offen
    v_add_u32 v8, 372736, v7
    buffer_load_dwordx4 v[212:215], v8, s[28:31], s43 offen
    s_add_u32 s43, s43, 128
    ds_read_b128 v[20:23], v6 offset:512
    ds_read_b128 v[24:27], v6 offset:15360
    ds_read_b128 v[216:219], v4 offset:0
    ds_read_b128 v[220:223], v4 offset:2304
    ds_read_b128 v[224:227], v4 offset:4608
    ds_read_b128 v[228:231], v4 offset:6912
    ds_read_b128 v[232:235], v4 offset:9216
    ds_read_b128 v[236:239], v4 offset:11520
    ds_read_b128 v[240:243], v4 offset:13824
    s_waitcnt lgkmcnt(6)
    v_mfma_f32_16x16x32_bf16 v[100:103], v[20:23], v[216:219], v[100:103]
    v_mfma_f32_16x16x32_bf16 v[104:107], v[24:27], v[216:219], v[104:107]
    s_waitcnt lgkmcnt(5)
    v_mfma_f32_16x16x32_bf16 v[108:111], v[20:23], v[220:223], v[108:111]
    v_mfma_f32_16x16x32_bf16 v[112:115], v[24:27], v[220:223], v[112:115]
    s_waitcnt lgkmcnt(4)
    v_mfma_f32_16x16x32_bf16 v[116:119], v[20:23], v[224:227], v[116:119]
    v_mfma_f32_16x16x32_bf16 v[120:123], v[24:27], v[224:227], v[120:123]
    s_waitcnt lgkmcnt(3)
    v_mfma_f32_16x16x32_bf16 v[124:127], v[20:23], v[228:231], v[124:127]
    v_mfma_f32_16x16x32_bf16 v[128:131], v[24:27], v[228:231], v[128:131]
    s_waitcnt lgkmcnt(2)
    v_mfma_f32_16x16x32_bf16 v[132:135], v[20:23], v[232:235], v[132:135]
    v_mfma_f32_16x16x32_bf16 v[136:139], v[24:27], v[232:235], v[136:139]
    s_waitcnt lgkmcnt(1)
    v_mfma_f32_16x16x32_bf16 v[140:143], v[20:23], v[236:239], v[140:143]
    v_mfma_f32_16x16x32_bf16 v[144:147], v[24:27], v[236:239], v[144:147]
    s_waitcnt lgkmcnt(0)
    v_mfma_f32_16x16x32_bf16 v[148:151], v[20:23], v[240:243], v[148:151]
    v_mfma_f32_16x16x32_bf16 v[152:155], v[24:27], v[240:243], v[152:155]
    s_nop 7
    ds_read_b128 v[20:23], v6 offset:576
    ds_read_b128 v[24:27], v6 offset:15424
    ds_read_b128 v[216:219], v4 offset:64
    ds_read_b128 v[220:223], v4 offset:2368
    ds_read_b128 v[224:227], v4 offset:4672
    ds_read_b128 v[228:231], v4 offset:6976
    ds_read_b128 v[232:235], v4 offset:9280
    ds_read_b128 v[236:239], v4 offset:11584
    ds_read_b128 v[240:243], v4 offset:13888
    s_waitcnt lgkmcnt(6)
    v_mfma_f32_16x16x32_bf16 v[100:103], v[20:23], v[216:219], v[100:103]
    v_mfma_f32_16x16x32_bf16 v[104:107], v[24:27], v[216:219], v[104:107]
    s_waitcnt lgkmcnt(5)
    v_mfma_f32_16x16x32_bf16 v[108:111], v[20:23], v[220:223], v[108:111]
    v_mfma_f32_16x16x32_bf16 v[112:115], v[24:27], v[220:223], v[112:115]
    s_waitcnt lgkmcnt(4)
    v_mfma_f32_16x16x32_bf16 v[116:119], v[20:23], v[224:227], v[116:119]
    v_mfma_f32_16x16x32_bf16 v[120:123], v[24:27], v[224:227], v[120:123]
    s_waitcnt lgkmcnt(3)
    v_mfma_f32_16x16x32_bf16 v[124:127], v[20:23], v[228:231], v[124:127]
    v_mfma_f32_16x16x32_bf16 v[128:131], v[24:27], v[228:231], v[128:131]
    s_waitcnt lgkmcnt(2)
    v_mfma_f32_16x16x32_bf16 v[132:135], v[20:23], v[232:235], v[132:135]
    v_mfma_f32_16x16x32_bf16 v[136:139], v[24:27], v[232:235], v[136:139]
    s_waitcnt lgkmcnt(1)
    v_mfma_f32_16x16x32_bf16 v[140:143], v[20:23], v[236:239], v[140:143]
    v_mfma_f32_16x16x32_bf16 v[144:147], v[24:27], v[236:239], v[144:147]
    s_waitcnt lgkmcnt(0)
    v_mfma_f32_16x16x32_bf16 v[148:151], v[20:23], v[240:243], v[148:151]
    v_mfma_f32_16x16x32_bf16 v[152:155], v[24:27], v[240:243], v[152:155]
    s_nop 7
    s_barrier
    s_waitcnt vmcnt(0)
    ds_write_b128 v9, v[160:163] offset:0
    ds_write_b128 v9, v[164:167] offset:4608
    ds_write_b128 v9, v[168:171] offset:9216
    ds_write_b128 v9, v[172:175] offset:13824
    ds_write_b128 v9, v[176:179] offset:18432
    ds_write_b128 v9, v[180:183] offset:23040
    ds_write_b128 v9, v[184:187] offset:27648
    ds_write_b128 v9, v[188:191] offset:32256
    ds_write_b128 v9, v[192:195] offset:36864
    ds_write_b128 v9, v[196:199] offset:41472
    ds_write_b128 v9, v[200:203] offset:46080
    ds_write_b128 v9, v[204:207] offset:50688
    ds_write_b128 v9, v[208:211] offset:55296
    ds_write_b128 v9, v[212:215] offset:59904
    s_waitcnt lgkmcnt(0)
    s_barrier
    v_add_u32 v8, 0, v7
    buffer_load_dwordx4 v[160:163], v8, s[28:31], s43 offen
    v_add_u32 v8, 28672, v7
    buffer_load_dwordx4 v[164:167], v8, s[28:31], s43 offen
    v_add_u32 v8, 57344, v7
    buffer_load_dwordx4 v[168:171], v8, s[28:31], s43 offen
    v_add_u32 v8, 86016, v7
    buffer_load_dwordx4 v[172:175], v8, s[28:31], s43 offen
    v_add_u32 v8, 114688, v7
    buffer_load_dwordx4 v[176:179], v8, s[28:31], s43 offen
    v_add_u32 v8, 143360, v7
    buffer_load_dwordx4 v[180:183], v8, s[28:31], s43 offen
    v_add_u32 v8, 172032, v7
    buffer_load_dwordx4 v[184:187], v8, s[28:31], s43 offen
    v_add_u32 v8, 200704, v7
    buffer_load_dwordx4 v[188:191], v8, s[28:31], s43 offen
    v_add_u32 v8, 229376, v7
    buffer_load_dwordx4 v[192:195], v8, s[28:31], s43 offen
    v_add_u32 v8, 258048, v7
    buffer_load_dwordx4 v[196:199], v8, s[28:31], s43 offen
    v_add_u32 v8, 286720, v7
    buffer_load_dwordx4 v[200:203], v8, s[28:31], s43 offen
    v_add_u32 v8, 315392, v7
    buffer_load_dwordx4 v[204:207], v8, s[28:31], s43 offen
    v_add_u32 v8, 344064, v7
    buffer_load_dwordx4 v[208:211], v8, s[28:31], s43 offen
    v_add_u32 v8, 372736, v7
    buffer_load_dwordx4 v[212:215], v8, s[28:31], s43 offen
    s_add_u32 s43, s43, 128
    ds_read_b128 v[20:23], v6 offset:640
    ds_read_b128 v[24:27], v6 offset:15488
    ds_read_b128 v[216:219], v4 offset:0
    ds_read_b128 v[220:223], v4 offset:2304
    ds_read_b128 v[224:227], v4 offset:4608
    ds_read_b128 v[228:231], v4 offset:6912
    ds_read_b128 v[232:235], v4 offset:9216
    ds_read_b128 v[236:239], v4 offset:11520
    ds_read_b128 v[240:243], v4 offset:13824
    s_waitcnt lgkmcnt(6)
    v_mfma_f32_16x16x32_bf16 v[100:103], v[20:23], v[216:219], v[100:103]
    v_mfma_f32_16x16x32_bf16 v[104:107], v[24:27], v[216:219], v[104:107]
    s_waitcnt lgkmcnt(5)
    v_mfma_f32_16x16x32_bf16 v[108:111], v[20:23], v[220:223], v[108:111]
    v_mfma_f32_16x16x32_bf16 v[112:115], v[24:27], v[220:223], v[112:115]
    s_waitcnt lgkmcnt(4)
    v_mfma_f32_16x16x32_bf16 v[116:119], v[20:23], v[224:227], v[116:119]
    v_mfma_f32_16x16x32_bf16 v[120:123], v[24:27], v[224:227], v[120:123]
    s_waitcnt lgkmcnt(3)
    v_mfma_f32_16x16x32_bf16 v[124:127], v[20:23], v[228:231], v[124:127]
    v_mfma_f32_16x16x32_bf16 v[128:131], v[24:27], v[228:231], v[128:131]
    s_waitcnt lgkmcnt(2)
    v_mfma_f32_16x16x32_bf16 v[132:135], v[20:23], v[232:235], v[132:135]
    v_mfma_f32_16x16x32_bf16 v[136:139], v[24:27], v[232:235], v[136:139]
    s_waitcnt lgkmcnt(1)
    v_mfma_f32_16x16x32_bf16 v[140:143], v[20:23], v[236:239], v[140:143]
    v_mfma_f32_16x16x32_bf16 v[144:147], v[24:27], v[236:239], v[144:147]
    s_waitcnt lgkmcnt(0)
    v_mfma_f32_16x16x32_bf16 v[148:151], v[20:23], v[240:243], v[148:151]
    v_mfma_f32_16x16x32_bf16 v[152:155], v[24:27], v[240:243], v[152:155]
    s_nop 7
    ds_read_b128 v[20:23], v6 offset:704
    ds_read_b128 v[24:27], v6 offset:15552
    ds_read_b128 v[216:219], v4 offset:64
    ds_read_b128 v[220:223], v4 offset:2368
    ds_read_b128 v[224:227], v4 offset:4672
    ds_read_b128 v[228:231], v4 offset:6976
    ds_read_b128 v[232:235], v4 offset:9280
    ds_read_b128 v[236:239], v4 offset:11584
    ds_read_b128 v[240:243], v4 offset:13888
    s_waitcnt lgkmcnt(6)
    v_mfma_f32_16x16x32_bf16 v[100:103], v[20:23], v[216:219], v[100:103]
    v_mfma_f32_16x16x32_bf16 v[104:107], v[24:27], v[216:219], v[104:107]
    s_waitcnt lgkmcnt(5)
    v_mfma_f32_16x16x32_bf16 v[108:111], v[20:23], v[220:223], v[108:111]
    v_mfma_f32_16x16x32_bf16 v[112:115], v[24:27], v[220:223], v[112:115]
    s_waitcnt lgkmcnt(4)
    v_mfma_f32_16x16x32_bf16 v[116:119], v[20:23], v[224:227], v[116:119]
    v_mfma_f32_16x16x32_bf16 v[120:123], v[24:27], v[224:227], v[120:123]
    s_waitcnt lgkmcnt(3)
    v_mfma_f32_16x16x32_bf16 v[124:127], v[20:23], v[228:231], v[124:127]
    v_mfma_f32_16x16x32_bf16 v[128:131], v[24:27], v[228:231], v[128:131]
    s_waitcnt lgkmcnt(2)
    v_mfma_f32_16x16x32_bf16 v[132:135], v[20:23], v[232:235], v[132:135]
    v_mfma_f32_16x16x32_bf16 v[136:139], v[24:27], v[232:235], v[136:139]
    s_waitcnt lgkmcnt(1)
    v_mfma_f32_16x16x32_bf16 v[140:143], v[20:23], v[236:239], v[140:143]
    v_mfma_f32_16x16x32_bf16 v[144:147], v[24:27], v[236:239], v[144:147]
    s_waitcnt lgkmcnt(0)
    v_mfma_f32_16x16x32_bf16 v[148:151], v[20:23], v[240:243], v[148:151]
    v_mfma_f32_16x16x32_bf16 v[152:155], v[24:27], v[240:243], v[152:155]
    s_nop 7
    s_barrier
    s_waitcnt vmcnt(0)
    ds_write_b128 v9, v[160:163] offset:0
    ds_write_b128 v9, v[164:167] offset:4608
    ds_write_b128 v9, v[168:171] offset:9216
    ds_write_b128 v9, v[172:175] offset:13824
    ds_write_b128 v9, v[176:179] offset:18432
    ds_write_b128 v9, v[180:183] offset:23040
    ds_write_b128 v9, v[184:187] offset:27648
    ds_write_b128 v9, v[188:191] offset:32256
    ds_write_b128 v9, v[192:195] offset:36864
    ds_write_b128 v9, v[196:199] offset:41472
    ds_write_b128 v9, v[200:203] offset:46080
    ds_write_b128 v9, v[204:207] offset:50688
    ds_write_b128 v9, v[208:211] offset:55296
    ds_write_b128 v9, v[212:215] offset:59904
    s_waitcnt lgkmcnt(0)
    s_barrier
    ds_read_b128 v[20:23], v6 offset:768
    ds_read_b128 v[24:27], v6 offset:15616
    ds_read_b128 v[216:219], v4 offset:0
    ds_read_b128 v[220:223], v4 offset:2304
    ds_read_b128 v[224:227], v4 offset:4608
    ds_read_b128 v[228:231], v4 offset:6912
    ds_read_b128 v[232:235], v4 offset:9216
    ds_read_b128 v[236:239], v4 offset:11520
    ds_read_b128 v[240:243], v4 offset:13824
    s_waitcnt lgkmcnt(6)
    v_mfma_f32_16x16x32_bf16 v[100:103], v[20:23], v[216:219], v[100:103]
    v_mfma_f32_16x16x32_bf16 v[104:107], v[24:27], v[216:219], v[104:107]
    s_waitcnt lgkmcnt(5)
    v_mfma_f32_16x16x32_bf16 v[108:111], v[20:23], v[220:223], v[108:111]
    v_mfma_f32_16x16x32_bf16 v[112:115], v[24:27], v[220:223], v[112:115]
    s_waitcnt lgkmcnt(4)
    v_mfma_f32_16x16x32_bf16 v[116:119], v[20:23], v[224:227], v[116:119]
    v_mfma_f32_16x16x32_bf16 v[120:123], v[24:27], v[224:227], v[120:123]
    s_waitcnt lgkmcnt(3)
    v_mfma_f32_16x16x32_bf16 v[124:127], v[20:23], v[228:231], v[124:127]
    v_mfma_f32_16x16x32_bf16 v[128:131], v[24:27], v[228:231], v[128:131]
    s_waitcnt lgkmcnt(2)
    v_mfma_f32_16x16x32_bf16 v[132:135], v[20:23], v[232:235], v[132:135]
    v_mfma_f32_16x16x32_bf16 v[136:139], v[24:27], v[232:235], v[136:139]
    s_waitcnt lgkmcnt(1)
    v_mfma_f32_16x16x32_bf16 v[140:143], v[20:23], v[236:239], v[140:143]
    v_mfma_f32_16x16x32_bf16 v[144:147], v[24:27], v[236:239], v[144:147]
    s_waitcnt lgkmcnt(0)
    v_mfma_f32_16x16x32_bf16 v[148:151], v[20:23], v[240:243], v[148:151]
    v_mfma_f32_16x16x32_bf16 v[152:155], v[24:27], v[240:243], v[152:155]
    s_nop 7
    ds_read_b128 v[20:23], v6 offset:832
    ds_read_b128 v[24:27], v6 offset:15680
    ds_read_b128 v[216:219], v4 offset:64
    ds_read_b128 v[220:223], v4 offset:2368
    ds_read_b128 v[224:227], v4 offset:4672
    ds_read_b128 v[228:231], v4 offset:6976
    ds_read_b128 v[232:235], v4 offset:9280
    ds_read_b128 v[236:239], v4 offset:11584
    ds_read_b128 v[240:243], v4 offset:13888
    s_waitcnt lgkmcnt(6)
    v_mfma_f32_16x16x32_bf16 v[100:103], v[20:23], v[216:219], v[100:103]
    v_mfma_f32_16x16x32_bf16 v[104:107], v[24:27], v[216:219], v[104:107]
    s_waitcnt lgkmcnt(5)
    v_mfma_f32_16x16x32_bf16 v[108:111], v[20:23], v[220:223], v[108:111]
    v_mfma_f32_16x16x32_bf16 v[112:115], v[24:27], v[220:223], v[112:115]
    s_waitcnt lgkmcnt(4)
    v_mfma_f32_16x16x32_bf16 v[116:119], v[20:23], v[224:227], v[116:119]
    v_mfma_f32_16x16x32_bf16 v[120:123], v[24:27], v[224:227], v[120:123]
    s_waitcnt lgkmcnt(3)
    v_mfma_f32_16x16x32_bf16 v[124:127], v[20:23], v[228:231], v[124:127]
    v_mfma_f32_16x16x32_bf16 v[128:131], v[24:27], v[228:231], v[128:131]
    s_waitcnt lgkmcnt(2)
    v_mfma_f32_16x16x32_bf16 v[132:135], v[20:23], v[232:235], v[132:135]
    v_mfma_f32_16x16x32_bf16 v[136:139], v[24:27], v[232:235], v[136:139]
    s_waitcnt lgkmcnt(1)
    v_mfma_f32_16x16x32_bf16 v[140:143], v[20:23], v[236:239], v[140:143]
    v_mfma_f32_16x16x32_bf16 v[144:147], v[24:27], v[236:239], v[144:147]
    s_waitcnt lgkmcnt(0)
    v_mfma_f32_16x16x32_bf16 v[148:151], v[20:23], v[240:243], v[148:151]
    v_mfma_f32_16x16x32_bf16 v[152:155], v[24:27], v[240:243], v[152:155]
    s_nop 7
    s_barrier
    s_nop 15
    s_nop 7
    s_sub_u32 s56, s55, 896
    v_add_u32 v7, s56, v2
    v_lshlrev_b32 v7, 12, v7
    v_lshlrev_b32 v8, 3, v3
    v_add_u32 v7, v7, v8
    s_lshl_b32 s43, s42, 1
    s_add_u32 s43, s43, 9764864
    v_mov_b32 v40, 0
    v_mov_b32 v41, 0
    v_mov_b32 v42, 0
    v_mov_b32 v43, 0
    v_mov_b32 v44, 0
    v_mov_b32 v45, 0
    v_mov_b32 v46, 0
    v_mov_b32 v47, 0
    v_mov_b32 v48, 0
    v_mov_b32 v49, 0
    v_mov_b32 v50, 0
    v_mov_b32 v51, 0
    v_mov_b32 v52, 0
    v_mov_b32 v53, 0
    v_mov_b32 v54, 0
    v_mov_b32 v55, 0
    v_mul_f32 v30, v100, v100
    v_fma_f32 v30, v30, s60, v31
    v_mul_f32 v30, v30, v100
    v_exp_f32 v30, v30
    s_nop 0
    v_add_f32 v30, 1.0, v30
    v_rcp_f32 v30, v30
    s_nop 0
    v_fma_f32 v100, -v100, v30, v100
    v_mul_f32 v30, v101, v101
    v_fma_f32 v30, v30, s60, v31
    v_mul_f32 v30, v30, v101
    v_exp_f32 v30, v30
    s_nop 0
    v_add_f32 v30, 1.0, v30
    v_rcp_f32 v30, v30
    s_nop 0
    v_fma_f32 v101, -v101, v30, v101
    v_mul_f32 v30, v102, v102
    v_fma_f32 v30, v30, s60, v31
    v_mul_f32 v30, v30, v102
    v_exp_f32 v30, v30
    s_nop 0
    v_add_f32 v30, 1.0, v30
    v_rcp_f32 v30, v30
    s_nop 0
    v_fma_f32 v102, -v102, v30, v102
    v_mul_f32 v30, v103, v103
    v_fma_f32 v30, v30, s60, v31
    v_mul_f32 v30, v30, v103
    v_exp_f32 v30, v30
    s_nop 0
    v_add_f32 v30, 1.0, v30
    v_rcp_f32 v30, v30
    s_nop 0
    v_fma_f32 v103, -v103, v30, v103
    v_cvt_pk_bf16_f32 v32, v100, v101
    v_cvt_pk_bf16_f32 v33, v102, v103
    v_add_u32 v8, 0, v7
    buffer_store_dwordx2 v[32:33], v8, s[28:31], s43 offen offset:0
    v_lshlrev_b32 v34, 16, v32
    v_and_b32 v35, 0xffff0000, v32
    v_lshlrev_b32 v36, 16, v33
    v_and_b32 v37, 0xffff0000, v33
    v_add_f32 v40, v40, v34
    v_fmac_f32 v48, v34, v34
    v_add_f32 v41, v41, v35
    v_fmac_f32 v49, v35, v35
    v_add_f32 v42, v42, v36
    v_fmac_f32 v50, v36, v36
    v_add_f32 v43, v43, v37
    v_fmac_f32 v51, v37, v37
    v_mul_f32 v30, v104, v104
    v_fma_f32 v30, v30, s60, v31
    v_mul_f32 v30, v30, v104
    v_exp_f32 v30, v30
    s_nop 0
    v_add_f32 v30, 1.0, v30
    v_rcp_f32 v30, v30
    s_nop 0
    v_fma_f32 v104, -v104, v30, v104
    v_mul_f32 v30, v105, v105
    v_fma_f32 v30, v30, s60, v31
    v_mul_f32 v30, v30, v105
    v_exp_f32 v30, v30
    s_nop 0
    v_add_f32 v30, 1.0, v30
    v_rcp_f32 v30, v30
    s_nop 0
    v_fma_f32 v105, -v105, v30, v105
    v_mul_f32 v30, v106, v106
    v_fma_f32 v30, v30, s60, v31
    v_mul_f32 v30, v30, v106
    v_exp_f32 v30, v30
    s_nop 0
    v_add_f32 v30, 1.0, v30
    v_rcp_f32 v30, v30
    s_nop 0
    v_fma_f32 v106, -v106, v30, v106
    v_mul_f32 v30, v107, v107
    v_fma_f32 v30, v30, s60, v31
    v_mul_f32 v30, v30, v107
    v_exp_f32 v30, v30
    s_nop 0
    v_add_f32 v30, 1.0, v30
    v_rcp_f32 v30, v30
    s_nop 0
    v_fma_f32 v107, -v107, v30, v107
    v_cvt_pk_bf16_f32 v32, v104, v105
    v_cvt_pk_bf16_f32 v33, v106, v107
    v_add_u32 v8, 0, v7
    buffer_store_dwordx2 v[32:33], v8, s[28:31], s43 offen offset:32
    v_lshlrev_b32 v34, 16, v32
    v_and_b32 v35, 0xffff0000, v32
    v_lshlrev_b32 v36, 16, v33
    v_and_b32 v37, 0xffff0000, v33
    v_add_f32 v44, v44, v34
    v_fmac_f32 v52, v34, v34
    v_add_f32 v45, v45, v35
    v_fmac_f32 v53, v35, v35
    v_add_f32 v46, v46, v36
    v_fmac_f32 v54, v36, v36
    v_add_f32 v47, v47, v37
    v_fmac_f32 v55, v37, v37
    v_mul_f32 v30, v108, v108
    v_fma_f32 v30, v30, s60, v31
    v_mul_f32 v30, v30, v108
    v_exp_f32 v30, v30
    s_nop 0
    v_add_f32 v30, 1.0, v30
    v_rcp_f32 v30, v30
    s_nop 0
    v_fma_f32 v108, -v108, v30, v108
    v_mul_f32 v30, v109, v109
    v_fma_f32 v30, v30, s60, v31
    v_mul_f32 v30, v30, v109
    v_exp_f32 v30, v30
    s_nop 0
    v_add_f32 v30, 1.0, v30
    v_rcp_f32 v30, v30
    s_nop 0
    v_fma_f32 v109, -v109, v30, v109
    v_mul_f32 v30, v110, v110
    v_fma_f32 v30, v30, s60, v31
    v_mul_f32 v30, v30, v110
    v_exp_f32 v30, v30
    s_nop 0
    v_add_f32 v30, 1.0, v30
    v_rcp_f32 v30, v30
    s_nop 0
    v_fma_f32 v110, -v110, v30, v110
    v_mul_f32 v30, v111, v111
    v_fma_f32 v30, v30, s60, v31
    v_mul_f32 v30, v30, v111
    v_exp_f32 v30, v30
    s_nop 0
    v_add_f32 v30, 1.0, v30
    v_rcp_f32 v30, v30
    s_nop 0
    v_fma_f32 v111, -v111, v30, v111
    v_cvt_pk_bf16_f32 v32, v108, v109
    v_cvt_pk_bf16_f32 v33, v110, v111
    v_add_u32 v8, 65536, v7
    buffer_store_dwordx2 v[32:33], v8, s[28:31], s43 offen offset:0
    v_lshlrev_b32 v34, 16, v32
    v_and_b32 v35, 0xffff0000, v32
    v_lshlrev_b32 v36, 16, v33
    v_and_b32 v37, 0xffff0000, v33
    v_add_f32 v40, v40, v34
    v_fmac_f32 v48, v34, v34
    v_add_f32 v41, v41, v35
    v_fmac_f32 v49, v35, v35
    v_add_f32 v42, v42, v36
    v_fmac_f32 v50, v36, v36
    v_add_f32 v43, v43, v37
    v_fmac_f32 v51, v37, v37
    v_mul_f32 v30, v112, v112
    v_fma_f32 v30, v30, s60, v31
    v_mul_f32 v30, v30, v112
    v_exp_f32 v30, v30
    s_nop 0
    v_add_f32 v30, 1.0, v30
    v_rcp_f32 v30, v30
    s_nop 0
    v_fma_f32 v112, -v112, v30, v112
    v_mul_f32 v30, v113, v113
    v_fma_f32 v30, v30, s60, v31
    v_mul_f32 v30, v30, v113
    v_exp_f32 v30, v30
    s_nop 0
    v_add_f32 v30, 1.0, v30
    v_rcp_f32 v30, v30
    s_nop 0
    v_fma_f32 v113, -v113, v30, v113
    v_mul_f32 v30, v114, v114
    v_fma_f32 v30, v30, s60, v31
    v_mul_f32 v30, v30, v114
    v_exp_f32 v30, v30
    s_nop 0
    v_add_f32 v30, 1.0, v30
    v_rcp_f32 v30, v30
    s_nop 0
    v_fma_f32 v114, -v114, v30, v114
    v_mul_f32 v30, v115, v115
    v_fma_f32 v30, v30, s60, v31
    v_mul_f32 v30, v30, v115
    v_exp_f32 v30, v30
    s_nop 0
    v_add_f32 v30, 1.0, v30
    v_rcp_f32 v30, v30
    s_nop 0
    v_fma_f32 v115, -v115, v30, v115
    v_cvt_pk_bf16_f32 v32, v112, v113
    v_cvt_pk_bf16_f32 v33, v114, v115
    v_add_u32 v8, 65536, v7
    buffer_store_dwordx2 v[32:33], v8, s[28:31], s43 offen offset:32
    v_lshlrev_b32 v34, 16, v32
    v_and_b32 v35, 0xffff0000, v32
    v_lshlrev_b32 v36, 16, v33
    v_and_b32 v37, 0xffff0000, v33
    v_add_f32 v44, v44, v34
    v_fmac_f32 v52, v34, v34
    v_add_f32 v45, v45, v35
    v_fmac_f32 v53, v35, v35
    v_add_f32 v46, v46, v36
    v_fmac_f32 v54, v36, v36
    v_add_f32 v47, v47, v37
    v_fmac_f32 v55, v37, v37
    v_mul_f32 v30, v116, v116
    v_fma_f32 v30, v30, s60, v31
    v_mul_f32 v30, v30, v116
    v_exp_f32 v30, v30
    s_nop 0
    v_add_f32 v30, 1.0, v30
    v_rcp_f32 v30, v30
    s_nop 0
    v_fma_f32 v116, -v116, v30, v116
    v_mul_f32 v30, v117, v117
    v_fma_f32 v30, v30, s60, v31
    v_mul_f32 v30, v30, v117
    v_exp_f32 v30, v30
    s_nop 0
    v_add_f32 v30, 1.0, v30
    v_rcp_f32 v30, v30
    s_nop 0
    v_fma_f32 v117, -v117, v30, v117
    v_mul_f32 v30, v118, v118
    v_fma_f32 v30, v30, s60, v31
    v_mul_f32 v30, v30, v118
    v_exp_f32 v30, v30
    s_nop 0
    v_add_f32 v30, 1.0, v30
    v_rcp_f32 v30, v30
    s_nop 0
    v_fma_f32 v118, -v118, v30, v118
    v_mul_f32 v30, v119, v119
    v_fma_f32 v30, v30, s60, v31
    v_mul_f32 v30, v30, v119
    v_exp_f32 v30, v30
    s_nop 0
    v_add_f32 v30, 1.0, v30
    v_rcp_f32 v30, v30
    s_nop 0
    v_fma_f32 v119, -v119, v30, v119
    v_cvt_pk_bf16_f32 v32, v116, v117
    v_cvt_pk_bf16_f32 v33, v118, v119
    v_add_u32 v8, 131072, v7
    buffer_store_dwordx2 v[32:33], v8, s[28:31], s43 offen offset:0
    v_lshlrev_b32 v34, 16, v32
    v_and_b32 v35, 0xffff0000, v32
    v_lshlrev_b32 v36, 16, v33
    v_and_b32 v37, 0xffff0000, v33
    v_add_f32 v40, v40, v34
    v_fmac_f32 v48, v34, v34
    v_add_f32 v41, v41, v35
    v_fmac_f32 v49, v35, v35
    v_add_f32 v42, v42, v36
    v_fmac_f32 v50, v36, v36
    v_add_f32 v43, v43, v37
    v_fmac_f32 v51, v37, v37
    v_mul_f32 v30, v120, v120
    v_fma_f32 v30, v30, s60, v31
    v_mul_f32 v30, v30, v120
    v_exp_f32 v30, v30
    s_nop 0
    v_add_f32 v30, 1.0, v30
    v_rcp_f32 v30, v30
    s_nop 0
    v_fma_f32 v120, -v120, v30, v120
    v_mul_f32 v30, v121, v121
    v_fma_f32 v30, v30, s60, v31
    v_mul_f32 v30, v30, v121
    v_exp_f32 v30, v30
    s_nop 0
    v_add_f32 v30, 1.0, v30
    v_rcp_f32 v30, v30
    s_nop 0
    v_fma_f32 v121, -v121, v30, v121
    v_mul_f32 v30, v122, v122
    v_fma_f32 v30, v30, s60, v31
    v_mul_f32 v30, v30, v122
    v_exp_f32 v30, v30
    s_nop 0
    v_add_f32 v30, 1.0, v30
    v_rcp_f32 v30, v30
    s_nop 0
    v_fma_f32 v122, -v122, v30, v122
    v_mul_f32 v30, v123, v123
    v_fma_f32 v30, v30, s60, v31
    v_mul_f32 v30, v30, v123
    v_exp_f32 v30, v30
    s_nop 0
    v_add_f32 v30, 1.0, v30
    v_rcp_f32 v30, v30
    s_nop 0
    v_fma_f32 v123, -v123, v30, v123
    v_cvt_pk_bf16_f32 v32, v120, v121
    v_cvt_pk_bf16_f32 v33, v122, v123
    v_add_u32 v8, 131072, v7
    buffer_store_dwordx2 v[32:33], v8, s[28:31], s43 offen offset:32
    v_lshlrev_b32 v34, 16, v32
    v_and_b32 v35, 0xffff0000, v32
    v_lshlrev_b32 v36, 16, v33
    v_and_b32 v37, 0xffff0000, v33
    v_add_f32 v44, v44, v34
    v_fmac_f32 v52, v34, v34
    v_add_f32 v45, v45, v35
    v_fmac_f32 v53, v35, v35
    v_add_f32 v46, v46, v36
    v_fmac_f32 v54, v36, v36
    v_add_f32 v47, v47, v37
    v_fmac_f32 v55, v37, v37
    v_mul_f32 v30, v124, v124
    v_fma_f32 v30, v30, s60, v31
    v_mul_f32 v30, v30, v124
    v_exp_f32 v30, v30
    s_nop 0
    v_add_f32 v30, 1.0, v30
    v_rcp_f32 v30, v30
    s_nop 0
    v_fma_f32 v124, -v124, v30, v124
    v_mul_f32 v30, v125, v125
    v_fma_f32 v30, v30, s60, v31
    v_mul_f32 v30, v30, v125
    v_exp_f32 v30, v30
    s_nop 0
    v_add_f32 v30, 1.0, v30
    v_rcp_f32 v30, v30
    s_nop 0
    v_fma_f32 v125, -v125, v30, v125
    v_mul_f32 v30, v126, v126
    v_fma_f32 v30, v30, s60, v31
    v_mul_f32 v30, v30, v126
    v_exp_f32 v30, v30
    s_nop 0
    v_add_f32 v30, 1.0, v30
    v_rcp_f32 v30, v30
    s_nop 0
    v_fma_f32 v126, -v126, v30, v126
    v_mul_f32 v30, v127, v127
    v_fma_f32 v30, v30, s60, v31
    v_mul_f32 v30, v30, v127
    v_exp_f32 v30, v30
    s_nop 0
    v_add_f32 v30, 1.0, v30
    v_rcp_f32 v30, v30
    s_nop 0
    v_fma_f32 v127, -v127, v30, v127
    v_cvt_pk_bf16_f32 v32, v124, v125
    v_cvt_pk_bf16_f32 v33, v126, v127
    v_add_u32 v8, 196608, v7
    buffer_store_dwordx2 v[32:33], v8, s[28:31], s43 offen offset:0
    v_lshlrev_b32 v34, 16, v32
    v_and_b32 v35, 0xffff0000, v32
    v_lshlrev_b32 v36, 16, v33
    v_and_b32 v37, 0xffff0000, v33
    v_add_f32 v40, v40, v34
    v_fmac_f32 v48, v34, v34
    v_add_f32 v41, v41, v35
    v_fmac_f32 v49, v35, v35
    v_add_f32 v42, v42, v36
    v_fmac_f32 v50, v36, v36
    v_add_f32 v43, v43, v37
    v_fmac_f32 v51, v37, v37
    v_mul_f32 v30, v128, v128
    v_fma_f32 v30, v30, s60, v31
    v_mul_f32 v30, v30, v128
    v_exp_f32 v30, v30
    s_nop 0
    v_add_f32 v30, 1.0, v30
    v_rcp_f32 v30, v30
    s_nop 0
    v_fma_f32 v128, -v128, v30, v128
    v_mul_f32 v30, v129, v129
    v_fma_f32 v30, v30, s60, v31
    v_mul_f32 v30, v30, v129
    v_exp_f32 v30, v30
    s_nop 0
    v_add_f32 v30, 1.0, v30
    v_rcp_f32 v30, v30
    s_nop 0
    v_fma_f32 v129, -v129, v30, v129
    v_mul_f32 v30, v130, v130
    v_fma_f32 v30, v30, s60, v31
    v_mul_f32 v30, v30, v130
    v_exp_f32 v30, v30
    s_nop 0
    v_add_f32 v30, 1.0, v30
    v_rcp_f32 v30, v30
    s_nop 0
    v_fma_f32 v130, -v130, v30, v130
    v_mul_f32 v30, v131, v131
    v_fma_f32 v30, v30, s60, v31
    v_mul_f32 v30, v30, v131
    v_exp_f32 v30, v30
    s_nop 0
    v_add_f32 v30, 1.0, v30
    v_rcp_f32 v30, v30
    s_nop 0
    v_fma_f32 v131, -v131, v30, v131
    v_cvt_pk_bf16_f32 v32, v128, v129
    v_cvt_pk_bf16_f32 v33, v130, v131
    v_add_u32 v8, 196608, v7
    buffer_store_dwordx2 v[32:33], v8, s[28:31], s43 offen offset:32
    v_lshlrev_b32 v34, 16, v32
    v_and_b32 v35, 0xffff0000, v32
    v_lshlrev_b32 v36, 16, v33
    v_and_b32 v37, 0xffff0000, v33
    v_add_f32 v44, v44, v34
    v_fmac_f32 v52, v34, v34
    v_add_f32 v45, v45, v35
    v_fmac_f32 v53, v35, v35
    v_add_f32 v46, v46, v36
    v_fmac_f32 v54, v36, v36
    v_add_f32 v47, v47, v37
    v_fmac_f32 v55, v37, v37
    v_mul_f32 v30, v132, v132
    v_fma_f32 v30, v30, s60, v31
    v_mul_f32 v30, v30, v132
    v_exp_f32 v30, v30
    s_nop 0
    v_add_f32 v30, 1.0, v30
    v_rcp_f32 v30, v30
    s_nop 0
    v_fma_f32 v132, -v132, v30, v132
    v_mul_f32 v30, v133, v133
    v_fma_f32 v30, v30, s60, v31
    v_mul_f32 v30, v30, v133
    v_exp_f32 v30, v30
    s_nop 0
    v_add_f32 v30, 1.0, v30
    v_rcp_f32 v30, v30
    s_nop 0
    v_fma_f32 v133, -v133, v30, v133
    v_mul_f32 v30, v134, v134
    v_fma_f32 v30, v30, s60, v31
    v_mul_f32 v30, v30, v134
    v_exp_f32 v30, v30
    s_nop 0
    v_add_f32 v30, 1.0, v30
    v_rcp_f32 v30, v30
    s_nop 0
    v_fma_f32 v134, -v134, v30, v134
    v_mul_f32 v30, v135, v135
    v_fma_f32 v30, v30, s60, v31
    v_mul_f32 v30, v30, v135
    v_exp_f32 v30, v30
    s_nop 0
    v_add_f32 v30, 1.0, v30
    v_rcp_f32 v30, v30
    s_nop 0
    v_fma_f32 v135, -v135, v30, v135
    v_cvt_pk_bf16_f32 v32, v132, v133
    v_cvt_pk_bf16_f32 v33, v134, v135
    v_add_u32 v8, 262144, v7
    buffer_store_dwordx2 v[32:33], v8, s[28:31], s43 offen offset:0
    v_lshlrev_b32 v34, 16, v32
    v_and_b32 v35, 0xffff0000, v32
    v_lshlrev_b32 v36, 16, v33
    v_and_b32 v37, 0xffff0000, v33
    v_add_f32 v40, v40, v34
    v_fmac_f32 v48, v34, v34
    v_add_f32 v41, v41, v35
    v_fmac_f32 v49, v35, v35
    v_add_f32 v42, v42, v36
    v_fmac_f32 v50, v36, v36
    v_add_f32 v43, v43, v37
    v_fmac_f32 v51, v37, v37
    v_mul_f32 v30, v136, v136
    v_fma_f32 v30, v30, s60, v31
    v_mul_f32 v30, v30, v136
    v_exp_f32 v30, v30
    s_nop 0
    v_add_f32 v30, 1.0, v30
    v_rcp_f32 v30, v30
    s_nop 0
    v_fma_f32 v136, -v136, v30, v136
    v_mul_f32 v30, v137, v137
    v_fma_f32 v30, v30, s60, v31
    v_mul_f32 v30, v30, v137
    v_exp_f32 v30, v30
    s_nop 0
    v_add_f32 v30, 1.0, v30
    v_rcp_f32 v30, v30
    s_nop 0
    v_fma_f32 v137, -v137, v30, v137
    v_mul_f32 v30, v138, v138
    v_fma_f32 v30, v30, s60, v31
    v_mul_f32 v30, v30, v138
    v_exp_f32 v30, v30
    s_nop 0
    v_add_f32 v30, 1.0, v30
    v_rcp_f32 v30, v30
    s_nop 0
    v_fma_f32 v138, -v138, v30, v138
    v_mul_f32 v30, v139, v139
    v_fma_f32 v30, v30, s60, v31
    v_mul_f32 v30, v30, v139
    v_exp_f32 v30, v30
    s_nop 0
    v_add_f32 v30, 1.0, v30
    v_rcp_f32 v30, v30
    s_nop 0
    v_fma_f32 v139, -v139, v30, v139
    v_cvt_pk_bf16_f32 v32, v136, v137
    v_cvt_pk_bf16_f32 v33, v138, v139
    v_add_u32 v8, 262144, v7
    buffer_store_dwordx2 v[32:33], v8, s[28:31], s43 offen offset:32
    v_lshlrev_b32 v34, 16, v32
    v_and_b32 v35, 0xffff0000, v32
    v_lshlrev_b32 v36, 16, v33
    v_and_b32 v37, 0xffff0000, v33
    v_add_f32 v44, v44, v34
    v_fmac_f32 v52, v34, v34
    v_add_f32 v45, v45, v35
    v_fmac_f32 v53, v35, v35
    v_add_f32 v46, v46, v36
    v_fmac_f32 v54, v36, v36
    v_add_f32 v47, v47, v37
    v_fmac_f32 v55, v37, v37
    v_mul_f32 v30, v140, v140
    v_fma_f32 v30, v30, s60, v31
    v_mul_f32 v30, v30, v140
    v_exp_f32 v30, v30
    s_nop 0
    v_add_f32 v30, 1.0, v30
    v_rcp_f32 v30, v30
    s_nop 0
    v_fma_f32 v140, -v140, v30, v140
    v_mul_f32 v30, v141, v141
    v_fma_f32 v30, v30, s60, v31
    v_mul_f32 v30, v30, v141
    v_exp_f32 v30, v30
    s_nop 0
    v_add_f32 v30, 1.0, v30
    v_rcp_f32 v30, v30
    s_nop 0
    v_fma_f32 v141, -v141, v30, v141
    v_mul_f32 v30, v142, v142
    v_fma_f32 v30, v30, s60, v31
    v_mul_f32 v30, v30, v142
    v_exp_f32 v30, v30
    s_nop 0
    v_add_f32 v30, 1.0, v30
    v_rcp_f32 v30, v30
    s_nop 0
    v_fma_f32 v142, -v142, v30, v142
    v_mul_f32 v30, v143, v143
    v_fma_f32 v30, v30, s60, v31
    v_mul_f32 v30, v30, v143
    v_exp_f32 v30, v30
    s_nop 0
    v_add_f32 v30, 1.0, v30
    v_rcp_f32 v30, v30
    s_nop 0
    v_fma_f32 v143, -v143, v30, v143
    v_cvt_pk_bf16_f32 v32, v140, v141
    v_cvt_pk_bf16_f32 v33, v142, v143
    v_add_u32 v8, 327680, v7
    buffer_store_dwordx2 v[32:33], v8, s[28:31], s43 offen offset:0
    v_lshlrev_b32 v34, 16, v32
    v_and_b32 v35, 0xffff0000, v32
    v_lshlrev_b32 v36, 16, v33
    v_and_b32 v37, 0xffff0000, v33
    v_add_f32 v40, v40, v34
    v_fmac_f32 v48, v34, v34
    v_add_f32 v41, v41, v35
    v_fmac_f32 v49, v35, v35
    v_add_f32 v42, v42, v36
    v_fmac_f32 v50, v36, v36
    v_add_f32 v43, v43, v37
    v_fmac_f32 v51, v37, v37
    v_mul_f32 v30, v144, v144
    v_fma_f32 v30, v30, s60, v31
    v_mul_f32 v30, v30, v144
    v_exp_f32 v30, v30
    s_nop 0
    v_add_f32 v30, 1.0, v30
    v_rcp_f32 v30, v30
    s_nop 0
    v_fma_f32 v144, -v144, v30, v144
    v_mul_f32 v30, v145, v145
    v_fma_f32 v30, v30, s60, v31
    v_mul_f32 v30, v30, v145
    v_exp_f32 v30, v30
    s_nop 0
    v_add_f32 v30, 1.0, v30
    v_rcp_f32 v30, v30
    s_nop 0
    v_fma_f32 v145, -v145, v30, v145
    v_mul_f32 v30, v146, v146
    v_fma_f32 v30, v30, s60, v31
    v_mul_f32 v30, v30, v146
    v_exp_f32 v30, v30
    s_nop 0
    v_add_f32 v30, 1.0, v30
    v_rcp_f32 v30, v30
    s_nop 0
    v_fma_f32 v146, -v146, v30, v146
    v_mul_f32 v30, v147, v147
    v_fma_f32 v30, v30, s60, v31
    v_mul_f32 v30, v30, v147
    v_exp_f32 v30, v30
    s_nop 0
    v_add_f32 v30, 1.0, v30
    v_rcp_f32 v30, v30
    s_nop 0
    v_fma_f32 v147, -v147, v30, v147
    v_cvt_pk_bf16_f32 v32, v144, v145
    v_cvt_pk_bf16_f32 v33, v146, v147
    v_add_u32 v8, 327680, v7
    buffer_store_dwordx2 v[32:33], v8, s[28:31], s43 offen offset:32
    v_lshlrev_b32 v34, 16, v32
    v_and_b32 v35, 0xffff0000, v32
    v_lshlrev_b32 v36, 16, v33
    v_and_b32 v37, 0xffff0000, v33
    v_add_f32 v44, v44, v34
    v_fmac_f32 v52, v34, v34
    v_add_f32 v45, v45, v35
    v_fmac_f32 v53, v35, v35
    v_add_f32 v46, v46, v36
    v_fmac_f32 v54, v36, v36
    v_add_f32 v47, v47, v37
    v_fmac_f32 v55, v37, v37
    v_mul_f32 v30, v148, v148
    v_fma_f32 v30, v30, s60, v31
    v_mul_f32 v30, v30, v148
    v_exp_f32 v30, v30
    s_nop 0
    v_add_f32 v30, 1.0, v30
    v_rcp_f32 v30, v30
    s_nop 0
    v_fma_f32 v148, -v148, v30, v148
    v_mul_f32 v30, v149, v149
    v_fma_f32 v30, v30, s60, v31
    v_mul_f32 v30, v30, v149
    v_exp_f32 v30, v30
    s_nop 0
    v_add_f32 v30, 1.0, v30
    v_rcp_f32 v30, v30
    s_nop 0
    v_fma_f32 v149, -v149, v30, v149
    v_mul_f32 v30, v150, v150
    v_fma_f32 v30, v30, s60, v31
    v_mul_f32 v30, v30, v150
    v_exp_f32 v30, v30
    s_nop 0
    v_add_f32 v30, 1.0, v30
    v_rcp_f32 v30, v30
    s_nop 0
    v_fma_f32 v150, -v150, v30, v150
    v_mul_f32 v30, v151, v151
    v_fma_f32 v30, v30, s60, v31
    v_mul_f32 v30, v30, v151
    v_exp_f32 v30, v30
    s_nop 0
    v_add_f32 v30, 1.0, v30
    v_rcp_f32 v30, v30
    s_nop 0
    v_fma_f32 v151, -v151, v30, v151
    v_cvt_pk_bf16_f32 v32, v148, v149
    v_cvt_pk_bf16_f32 v33, v150, v151
    v_add_u32 v8, 393216, v7
    buffer_store_dwordx2 v[32:33], v8, s[28:31], s43 offen offset:0
    v_lshlrev_b32 v34, 16, v32
    v_and_b32 v35, 0xffff0000, v32
    v_lshlrev_b32 v36, 16, v33
    v_and_b32 v37, 0xffff0000, v33
    v_add_f32 v40, v40, v34
    v_fmac_f32 v48, v34, v34
    v_add_f32 v41, v41, v35
    v_fmac_f32 v49, v35, v35
    v_add_f32 v42, v42, v36
    v_fmac_f32 v50, v36, v36
    v_add_f32 v43, v43, v37
    v_fmac_f32 v51, v37, v37
    v_mul_f32 v30, v152, v152
    v_fma_f32 v30, v30, s60, v31
    v_mul_f32 v30, v30, v152
    v_exp_f32 v30, v30
    s_nop 0
    v_add_f32 v30, 1.0, v30
    v_rcp_f32 v30, v30
    s_nop 0
    v_fma_f32 v152, -v152, v30, v152
    v_mul_f32 v30, v153, v153
    v_fma_f32 v30, v30, s60, v31
    v_mul_f32 v30, v30, v153
    v_exp_f32 v30, v30
    s_nop 0
    v_add_f32 v30, 1.0, v30
    v_rcp_f32 v30, v30
    s_nop 0
    v_fma_f32 v153, -v153, v30, v153
    v_mul_f32 v30, v154, v154
    v_fma_f32 v30, v30, s60, v31
    v_mul_f32 v30, v30, v154
    v_exp_f32 v30, v30
    s_nop 0
    v_add_f32 v30, 1.0, v30
    v_rcp_f32 v30, v30
    s_nop 0
    v_fma_f32 v154, -v154, v30, v154
    v_mul_f32 v30, v155, v155
    v_fma_f32 v30, v30, s60, v31
    v_mul_f32 v30, v30, v155
    v_exp_f32 v30, v30
    s_nop 0
    v_add_f32 v30, 1.0, v30
    v_rcp_f32 v30, v30
    s_nop 0
    v_fma_f32 v155, -v155, v30, v155
    v_cvt_pk_bf16_f32 v32, v152, v153
    v_cvt_pk_bf16_f32 v33, v154, v155
    v_add_u32 v8, 393216, v7
    buffer_store_dwordx2 v[32:33], v8, s[28:31], s43 offen offset:32
    v_lshlrev_b32 v34, 16, v32
    v_and_b32 v35, 0xffff0000, v32
    v_lshlrev_b32 v36, 16, v33
    v_and_b32 v37, 0xffff0000, v33
    v_add_f32 v44, v44, v34
    v_fmac_f32 v52, v34, v34
    v_add_f32 v45, v45, v35
    v_fmac_f32 v53, v35, v35
    v_add_f32 v46, v46, v36
    v_fmac_f32 v54, v36, v36
    v_add_f32 v47, v47, v37
    v_fmac_f32 v55, v37, v37
    s_nop 1
    v_add_f32_dpp v40, v40, v40 row_ror:8 row_mask:0xf bank_mask:0xf
    s_nop 1
    v_add_f32_dpp v40, v40, v40 row_ror:4 row_mask:0xf bank_mask:0xf
    s_nop 1
    v_add_f32_dpp v40, v40, v40 row_ror:2 row_mask:0xf bank_mask:0xf
    s_nop 1
    v_add_f32_dpp v40, v40, v40 row_ror:1 row_mask:0xf bank_mask:0xf
    s_nop 1
    v_add_f32_dpp v41, v41, v41 row_ror:8 row_mask:0xf bank_mask:0xf
    s_nop 1
    v_add_f32_dpp v41, v41, v41 row_ror:4 row_mask:0xf bank_mask:0xf
    s_nop 1
    v_add_f32_dpp v41, v41, v41 row_ror:2 row_mask:0xf bank_mask:0xf
    s_nop 1
    v_add_f32_dpp v41, v41, v41 row_ror:1 row_mask:0xf bank_mask:0xf
    s_nop 1
    v_add_f32_dpp v42, v42, v42 row_ror:8 row_mask:0xf bank_mask:0xf
    s_nop 1
    v_add_f32_dpp v42, v42, v42 row_ror:4 row_mask:0xf bank_mask:0xf
    s_nop 1
    v_add_f32_dpp v42, v42, v42 row_ror:2 row_mask:0xf bank_mask:0xf
    s_nop 1
    v_add_f32_dpp v42, v42, v42 row_ror:1 row_mask:0xf bank_mask:0xf
    s_nop 1
    v_add_f32_dpp v43, v43, v43 row_ror:8 row_mask:0xf bank_mask:0xf
    s_nop 1
    v_add_f32_dpp v43, v43, v43 row_ror:4 row_mask:0xf bank_mask:0xf
    s_nop 1
    v_add_f32_dpp v43, v43, v43 row_ror:2 row_mask:0xf bank_mask:0xf
    s_nop 1
    v_add_f32_dpp v43, v43, v43 row_ror:1 row_mask:0xf bank_mask:0xf
    s_nop 1
    v_add_f32_dpp v44, v44, v44 row_ror:8 row_mask:0xf bank_mask:0xf
    s_nop 1
    v_add_f32_dpp v44, v44, v44 row_ror:4 row_mask:0xf bank_mask:0xf
    s_nop 1
    v_add_f32_dpp v44, v44, v44 row_ror:2 row_mask:0xf bank_mask:0xf
    s_nop 1
    v_add_f32_dpp v44, v44, v44 row_ror:1 row_mask:0xf bank_mask:0xf
    s_nop 1
    v_add_f32_dpp v45, v45, v45 row_ror:8 row_mask:0xf bank_mask:0xf
    s_nop 1
    v_add_f32_dpp v45, v45, v45 row_ror:4 row_mask:0xf bank_mask:0xf
    s_nop 1
    v_add_f32_dpp v45, v45, v45 row_ror:2 row_mask:0xf bank_mask:0xf
    s_nop 1
    v_add_f32_dpp v45, v45, v45 row_ror:1 row_mask:0xf bank_mask:0xf
    s_nop 1
    v_add_f32_dpp v46, v46, v46 row_ror:8 row_mask:0xf bank_mask:0xf
    s_nop 1
    v_add_f32_dpp v46, v46, v46 row_ror:4 row_mask:0xf bank_mask:0xf
    s_nop 1
    v_add_f32_dpp v46, v46, v46 row_ror:2 row_mask:0xf bank_mask:0xf
    s_nop 1
    v_add_f32_dpp v46, v46, v46 row_ror:1 row_mask:0xf bank_mask:0xf
    s_nop 1
    v_add_f32_dpp v47, v47, v47 row_ror:8 row_mask:0xf bank_mask:0xf
    s_nop 1
    v_add_f32_dpp v47, v47, v47 row_ror:4 row_mask:0xf bank_mask:0xf
    s_nop 1
    v_add_f32_dpp v47, v47, v47 row_ror:2 row_mask:0xf bank_mask:0xf
    s_nop 1
    v_add_f32_dpp v47, v47, v47 row_ror:1 row_mask:0xf bank_mask:0xf
    s_nop 1
    v_add_f32_dpp v48, v48, v48 row_ror:8 row_mask:0xf bank_mask:0xf
    s_nop 1
    v_add_f32_dpp v48, v48, v48 row_ror:4 row_mask:0xf bank_mask:0xf
    s_nop 1
    v_add_f32_dpp v48, v48, v48 row_ror:2 row_mask:0xf bank_mask:0xf
    s_nop 1
    v_add_f32_dpp v48, v48, v48 row_ror:1 row_mask:0xf bank_mask:0xf
    s_nop 1
    v_add_f32_dpp v49, v49, v49 row_ror:8 row_mask:0xf bank_mask:0xf
    s_nop 1
    v_add_f32_dpp v49, v49, v49 row_ror:4 row_mask:0xf bank_mask:0xf
    s_nop 1
    v_add_f32_dpp v49, v49, v49 row_ror:2 row_mask:0xf bank_mask:0xf
    s_nop 1
    v_add_f32_dpp v49, v49, v49 row_ror:1 row_mask:0xf bank_mask:0xf
    s_nop 1
    v_add_f32_dpp v50, v50, v50 row_ror:8 row_mask:0xf bank_mask:0xf
    s_nop 1
    v_add_f32_dpp v50, v50, v50 row_ror:4 row_mask:0xf bank_mask:0xf
    s_nop 1
    v_add_f32_dpp v50, v50, v50 row_ror:2 row_mask:0xf bank_mask:0xf
    s_nop 1
    v_add_f32_dpp v50, v50, v50 row_ror:1 row_mask:0xf bank_mask:0xf
    s_nop 1
    v_add_f32_dpp v51, v51, v51 row_ror:8 row_mask:0xf bank_mask:0xf
    s_nop 1
    v_add_f32_dpp v51, v51, v51 row_ror:4 row_mask:0xf bank_mask:0xf
    s_nop 1
    v_add_f32_dpp v51, v51, v51 row_ror:2 row_mask:0xf bank_mask:0xf
    s_nop 1
    v_add_f32_dpp v51, v51, v51 row_ror:1 row_mask:0xf bank_mask:0xf
    s_nop 1
    v_add_f32_dpp v52, v52, v52 row_ror:8 row_mask:0xf bank_mask:0xf
    s_nop 1
    v_add_f32_dpp v52, v52, v52 row_ror:4 row_mask:0xf bank_mask:0xf
    s_nop 1
    v_add_f32_dpp v52, v52, v52 row_ror:2 row_mask:0xf bank_mask:0xf
    s_nop 1
    v_add_f32_dpp v52, v52, v52 row_ror:1 row_mask:0xf bank_mask:0xf
    s_nop 1
    v_add_f32_dpp v53, v53, v53 row_ror:8 row_mask:0xf bank_mask:0xf
    s_nop 1
    v_add_f32_dpp v53, v53, v53 row_ror:4 row_mask:0xf bank_mask:0xf
    s_nop 1
    v_add_f32_dpp v53, v53, v53 row_ror:2 row_mask:0xf bank_mask:0xf
    s_nop 1
    v_add_f32_dpp v53, v53, v53 row_ror:1 row_mask:0xf bank_mask:0xf
    s_nop 1
    v_add_f32_dpp v54, v54, v54 row_ror:8 row_mask:0xf bank_mask:0xf
    s_nop 1
    v_add_f32_dpp v54, v54, v54 row_ror:4 row_mask:0xf bank_mask:0xf
    s_nop 1
    v_add_f32_dpp v54, v54, v54 row_ror:2 row_mask:0xf bank_mask:0xf
    s_nop 1
    v_add_f32_dpp v54, v54, v54 row_ror:1 row_mask:0xf bank_mask:0xf
    s_nop 1
    v_add_f32_dpp v55, v55, v55 row_ror:8 row_mask:0xf bank_mask:0xf
    s_nop 1
    v_add_f32_dpp v55, v55, v55 row_ror:4 row_mask:0xf bank_mask:0xf
    s_nop 1
    v_add_f32_dpp v55, v55, v55 row_ror:2 row_mask:0xf bank_mask:0xf
    s_nop 1
    v_add_f32_dpp v55, v55, v55 row_ror:1 row_mask:0xf bank_mask:0xf
    s_nop 1
    v_cmp_eq_u32 vcc, 0, v2
    s_and_saveexec_b64 s[44:45], vcc
    s_lshl_b32 s56, s54, 8
    s_add_u32 s56, s56, 40448
    v_lshlrev_b32 v8, 5, v3
    v_add_u32 v8, s56, v8
    v_mov_b32 v34, v40
    v_mov_b32 v35, v48
    ds_write_b64 v8, v[34:35] offset:0
    v_mov_b32 v34, v41
    v_mov_b32 v35, v49
    ds_write_b64 v8, v[34:35] offset:8
    v_mov_b32 v34, v42
    v_mov_b32 v35, v50
    ds_write_b64 v8, v[34:35] offset:16
    v_mov_b32 v34, v43
    v_mov_b32 v35, v51
    ds_write_b64 v8, v[34:35] offset:24
    v_mov_b32 v34, v44
    v_mov_b32 v35, v52
    ds_write_b64 v8, v[34:35] offset:128
    v_mov_b32 v34, v45
    v_mov_b32 v35, v53
    ds_write_b64 v8, v[34:35] offset:136
    v_mov_b32 v34, v46
    v_mov_b32 v35, v54
    ds_write_b64 v8, v[34:35] offset:144
    v_mov_b32 v34, v47
    v_mov_b32 v35, v55
    ds_write_b64 v8, v[34:35] offset:152
    s_mov_b64 exec, s[44:45]
    s_waitcnt lgkmcnt(0)
    s_barrier
    v_cmp_gt_u32 vcc, 32, v0
    s_and_saveexec_b64 s[44:45], vcc
    s_cbranch_execz K2_END
    v_lshlrev_b32 v8, 3, v0
    v_add_u32 v8, 40448, v8
    ds_read_b64 v[34:35], v8 offset:0
    ds_read_b64 v[36:37], v8 offset:256
    ds_read_b64 v[38:39], v8 offset:512
    ds_read_b64 v[40:41], v8 offset:768
    s_waitcnt lgkmcnt(0)
    v_add_f32 v34, v34, v36
    v_add_f32 v34, v34, v38
    v_add_f32 v34, v34, v40
    v_add_f32 v35, v35, v37
    v_add_f32 v35, v35, v39
    v_add_f32 v35, v35, v41
    s_sub_u32 s56, s40, 2
    s_lshl_b32 s56, s56, 14
    s_lshl_b32 s57, s42, 3
    s_add_u32 s56, s56, s57
    s_add_u32 s56, s56, 13434880
    v_lshlrev_b32 v8, 3, v0
    buffer_store_dwordx2 v[34:35], v8, s[28:31], s56 offen
K2_END:
    s_endpgm
.globl k3_gemm2_kernel
.p2align 8
.type k3_gemm2_kernel,@function
k3_gemm2_kernel:
    s_cmp_ge_u32 s2, 224
    s_cbranch_scc1 K3_END
    s_load_dwordx2 s[14:15], s[0:1], 120
    s_load_dwordx4 s[4:7], s[0:1], 64
    s_and_b32 s40, s2, 3
    s_lshl_b32 s40, s40, 2
    s_lshr_b32 s41, s2, 3
    s_and_b32 s42, s41, 3
    s_add_u32 s40, s40, s42
    s_lshr_b32 s41, s41, 2
    s_bfe_u32 s42, s2, 0x10002
    s_mul_i32 s42, s42, 7
    s_add_u32 s41, s41, s42
    s_lshl_b32 s42, s40, 7
    s_lshl_b32 s43, s41, 6
    s_waitcnt lgkmcnt(0)
    s_mov_b32 s28, s14
    s_and_b32 s29, s15, 0xffff
    s_mov_b32 s30, 268435456
    s_mov_b32 s31, 0x00020000
    s_mov_b32 s16, s4
    s_and_b32 s17, s5, 0xffff
    s_mov_b32 s18, 8388608
    s_mov_b32 s19, 0x00020000
    v_lshrrev_b32 v1, 3, v0
    v_and_b32 v2, 7, v0
    v_lshlrev_b32 v2, 4, v2
    v_add_u32 v3, s43, v1
    v_mul_u32_u24 v3, 4096, v3
    v_add_u32 v3, v3, v2
    v_add_u32 v4, 131072, v3
    v_add_u32 v5, s42, v1
    v_mul_u32_u24 v5, 4096, v5
    v_add_u32 v5, v5, v2
    v_add_u32 v6, 131072, v5
    v_add_u32 v7, 262144, v5
    v_add_u32 v8, 393216, v5
    s_mov_b32 s44, 9764864
    s_mov_b32 s45, 0
    v_mul_u32_u24 v9, 144, v1
    v_add_u32 v9, v9, v2
    v_add_u32 v64, 0x8000, v9
    v_lshrrev_b32 v11, 6, v0
    s_nop 0
    v_readfirstlane_b32 s54, v11
    s_and_b32 s55, s54, 1
    s_lshr_b32 s56, s54, 1
    v_and_b32 v11, 63, v0
    v_and_b32 v12, 15, v11
    v_lshrrev_b32 v13, 4, v11
    s_mul_i32 s57, s55, 64
    s_add_u32 s57, s57, s42
    v_add_u32 v14, s57, v12
    s_lshl_b32 s57, s56, 5
    s_add_u32 s57, s57, s43
    v_lshlrev_b32 v15, 2, v13
    v_add_u32 v15, s57, v15
    v_lshlrev_b32 v10, 6, v0
    s_mov_b32 s46, 13434880
    s_mov_b32 s47, 13451264
    buffer_load_dwordx4 v[16:19], v10, s[28:31], s46 offen offset:0
    buffer_load_dwordx4 v[20:23], v10, s[28:31], s46 offen offset:16
    buffer_load_dwordx4 v[24:27], v10, s[28:31], s46 offen offset:32
    buffer_load_dwordx4 v[28:31], v10, s[28:31], s46 offen offset:48
    buffer_load_dwordx4 v[32:35], v10, s[28:31], s47 offen offset:0
    buffer_load_dwordx4 v[36:39], v10, s[28:31], s47 offen offset:16
    buffer_load_dwordx4 v[40:43], v10, s[28:31], s47 offen offset:32
    buffer_load_dwordx4 v[44:47], v10, s[28:31], s47 offen offset:48
    buffer_load_dwordx4 v[96:99], v3, s[28:31], s44 offen
    buffer_load_dwordx4 v[100:103], v4, s[28:31], s44 offen
    buffer_load_dwordx4 v[104:107], v5, s[16:19], s45 offen
    buffer_load_dwordx4 v[108:111], v6, s[16:19], s45 offen
    buffer_load_dwordx4 v[112:115], v7, s[16:19], s45 offen
    buffer_load_dwordx4 v[116:119], v8, s[16:19], s45 offen
    s_add_u32 s44, s44, 128
    s_add_u32 s45, s45, 128
    buffer_load_dwordx4 v[120:123], v3, s[28:31], s44 offen
    buffer_load_dwordx4 v[124:127], v4, s[28:31], s44 offen
    buffer_load_dwordx4 v[128:131], v5, s[16:19], s45 offen
    buffer_load_dwordx4 v[132:135], v6, s[16:19], s45 offen
    buffer_load_dwordx4 v[136:139], v7, s[16:19], s45 offen
    buffer_load_dwordx4 v[140:143], v8, s[16:19], s45 offen
    s_add_u32 s44, s44, 128
    s_add_u32 s45, s45, 128
    buffer_load_dwordx4 v[144:147], v3, s[28:31], s44 offen
    buffer_load_dwordx4 v[148:151], v4, s[28:31], s44 offen
    buffer_load_dwordx4 v[152:155], v5, s[16:19], s45 offen
    buffer_load_dwordx4 v[156:159], v6, s[16:19], s45 offen
    buffer_load_dwordx4 v[160:163], v7, s[16:19], s45 offen
    buffer_load_dwordx4 v[164:167], v8, s[16:19], s45 offen
    s_add_u32 s44, s44, 128
    s_add_u32 s45, s45, 128
    buffer_load_dwordx4 v[168:171], v3, s[28:31], s44 offen
    buffer_load_dwordx4 v[172:175], v4, s[28:31], s44 offen
    buffer_load_dwordx4 v[176:179], v5, s[16:19], s45 offen
    buffer_load_dwordx4 v[180:183], v6, s[16:19], s45 offen
    buffer_load_dwordx4 v[184:187], v7, s[16:19], s45 offen
    buffer_load_dwordx4 v[188:191], v8, s[16:19], s45 offen
    s_add_u32 s44, s44, 128
    s_add_u32 s45, s45, 128
    s_mov_b32 s20, s6
    s_and_b32 s21, s7, 0xffff
    s_mov_b32 s22, 4096
    s_mov_b32 s23, 0x00020000
    v_lshlrev_b32 v65, 1, v14
    buffer_load_ushort v82, v65, s[20:23], 0 offen offset:0
    buffer_load_ushort v83, v65, s[20:23], 0 offen offset:32
    buffer_load_ushort v84, v65, s[20:23], 0 offen offset:64
    buffer_load_ushort v85, v65, s[20:23], 0 offen offset:96
    v_mul_u32_u24 v65, 1792, v14
    v_lshlrev_b32 v15, 1, v15
    v_add_u32 v65, v65, v15
    s_mov_b32 s58, 6094848
    v_add_u32 v15, 0, v65
    buffer_load_dwordx2 v[66:67], v15, s[28:31], s58 offen offset:0
    buffer_load_dwordx2 v[68:69], v15, s[28:31], s58 offen offset:32
    v_add_u32 v15, 28672, v65
    buffer_load_dwordx2 v[70:71], v15, s[28:31], s58 offen offset:0
    buffer_load_dwordx2 v[72:73], v15, s[28:31], s58 offen offset:32
    v_add_u32 v15, 57344, v65
    buffer_load_dwordx2 v[74:75], v15, s[28:31], s58 offen offset:0
    buffer_load_dwordx2 v[76:77], v15, s[28:31], s58 offen offset:32
    v_add_u32 v15, 86016, v65
    buffer_load_dwordx2 v[78:79], v15, s[28:31], s58 offen offset:0
    buffer_load_dwordx2 v[80:81], v15, s[28:31], s58 offen offset:32
    s_waitcnt vmcnt(36)
    v_add_f32 v11, v16, v32
    v_add_f32 v15, v17, v33
    v_mul_f32 v11, 0x3a924925, v11
    v_mul_f32 v15, 0x3a924925, v15
    v_fma_f32 v15, -v11, v11, v15
    v_add_f32 v15, 0x3727c5ac, v15
    v_rsq_f32 v15, v15
    s_nop 0
    v_mov_b32 v48, v15
    v_mul_f32 v56, v11, v15
    v_sub_f32 v56, 0, v56
    v_add_f32 v11, v18, v34
    v_add_f32 v15, v19, v35
    v_mul_f32 v11, 0x3a924925, v11
    v_mul_f32 v15, 0x3a924925, v15
    v_fma_f32 v15, -v11, v11, v15
    v_add_f32 v15, 0x3727c5ac, v15
    v_rsq_f32 v15, v15
    s_nop 0
    v_mov_b32 v49, v15
    v_mul_f32 v57, v11, v15
    v_sub_f32 v57, 0, v57
    v_add_f32 v11, v20, v36
    v_add_f32 v15, v21, v37
    v_mul_f32 v11, 0x3a924925, v11
    v_mul_f32 v15, 0x3a924925, v15
    v_fma_f32 v15, -v11, v11, v15
    v_add_f32 v15, 0x3727c5ac, v15
    v_rsq_f32 v15, v15
    s_nop 0
    v_mov_b32 v50, v15
    v_mul_f32 v58, v11, v15
    v_sub_f32 v58, 0, v58
    v_add_f32 v11, v22, v38
    v_add_f32 v15, v23, v39
    v_mul_f32 v11, 0x3a924925, v11
    v_mul_f32 v15, 0x3a924925, v15
    v_fma_f32 v15, -v11, v11, v15
    v_add_f32 v15, 0x3727c5ac, v15
    v_rsq_f32 v15, v15
    s_nop 0
    v_mov_b32 v51, v15
    v_mul_f32 v59, v11, v15
    v_sub_f32 v59, 0, v59
    v_add_f32 v11, v24, v40
    v_add_f32 v15, v25, v41
    v_mul_f32 v11, 0x3a924925, v11
    v_mul_f32 v15, 0x3a924925, v15
    v_fma_f32 v15, -v11, v11, v15
    v_add_f32 v15, 0x3727c5ac, v15
    v_rsq_f32 v15, v15
    s_nop 0
    v_mov_b32 v52, v15
    v_mul_f32 v60, v11, v15
    v_sub_f32 v60, 0, v60
    v_add_f32 v11, v26, v42
    v_add_f32 v15, v27, v43
    v_mul_f32 v11, 0x3a924925, v11
    v_mul_f32 v15, 0x3a924925, v15
    v_fma_f32 v15, -v11, v11, v15
    v_add_f32 v15, 0x3727c5ac, v15
    v_rsq_f32 v15, v15
    s_nop 0
    v_mov_b32 v53, v15
    v_mul_f32 v61, v11, v15
    v_sub_f32 v61, 0, v61
    v_add_f32 v11, v28, v44
    v_add_f32 v15, v29, v45
    v_mul_f32 v11, 0x3a924925, v11
    v_mul_f32 v15, 0x3a924925, v15
    v_fma_f32 v15, -v11, v11, v15
    v_add_f32 v15, 0x3727c5ac, v15
    v_rsq_f32 v15, v15
    s_nop 0
    v_mov_b32 v54, v15
    v_mul_f32 v62, v11, v15
    v_sub_f32 v62, 0, v62
    v_add_f32 v11, v30, v46
    v_add_f32 v15, v31, v47
    v_mul_f32 v11, 0x3a924925, v11
    v_mul_f32 v15, 0x3a924925, v15
    v_fma_f32 v15, -v11, v11, v15
    v_add_f32 v15, 0x3727c5ac, v15
    v_rsq_f32 v15, v15
    s_nop 0
    v_mov_b32 v55, v15
    v_mul_f32 v63, v11, v15
    v_sub_f32 v63, 0, v63
    v_lshlrev_b32 v10, 5, v0
    ds_write_b128 v10, v[48:51] offset:0
    ds_write_b128 v10, v[52:55] offset:16
    ds_write_b128 v10, v[56:59] offset:8192
    ds_write_b128 v10, v[60:63] offset:8208
    v_lshlrev_b32 v10, 5, v0
    v_and_b32 v10, 0xe0, v10
    s_waitcnt lgkmcnt(0)
    s_barrier
    s_waitcnt vmcnt(30)
    ds_read_b128 v[16:19], v10 offset:0
    ds_read_b128 v[20:23], v10 offset:16
    ds_read_b128 v[24:27], v10 offset:8192
    ds_read_b128 v[28:31], v10 offset:8208
    s_waitcnt lgkmcnt(0)
    v_lshlrev_b32 v11, 16, v96
    v_and_b32 v15, 0xffff0000, v96
    v_fma_f32 v11, v11, v16, v24
    v_fma_f32 v15, v15, v17, v25
    v_cvt_pk_bf16_f32 v96, v11, v15
    v_lshlrev_b32 v11, 16, v97
    v_and_b32 v15, 0xffff0000, v97
    v_fma_f32 v11, v11, v18, v26
    v_fma_f32 v15, v15, v19, v27
    v_cvt_pk_bf16_f32 v97, v11, v15
    v_lshlrev_b32 v11, 16, v98
    v_and_b32 v15, 0xffff0000, v98
    v_fma_f32 v11, v11, v20, v28
    v_fma_f32 v15, v15, v21, v29
    v_cvt_pk_bf16_f32 v98, v11, v15
    v_lshlrev_b32 v11, 16, v99
    v_and_b32 v15, 0xffff0000, v99
    v_fma_f32 v11, v11, v22, v30
    v_fma_f32 v15, v15, v23, v31
    v_cvt_pk_bf16_f32 v99, v11, v15
    v_lshlrev_b32 v11, 16, v100
    v_and_b32 v15, 0xffff0000, v100
    v_fma_f32 v11, v11, v16, v24
    v_fma_f32 v15, v15, v17, v25
    v_cvt_pk_bf16_f32 v100, v11, v15
    v_lshlrev_b32 v11, 16, v101
    v_and_b32 v15, 0xffff0000, v101
    v_fma_f32 v11, v11, v18, v26
    v_fma_f32 v15, v15, v19, v27
    v_cvt_pk_bf16_f32 v101, v11, v15
    v_lshlrev_b32 v11, 16, v102
    v_and_b32 v15, 0xffff0000, v102
    v_fma_f32 v11, v11, v20, v28
    v_fma_f32 v15, v15, v21, v29
    v_cvt_pk_bf16_f32 v102, v11, v15
    v_lshlrev_b32 v11, 16, v103
    v_and_b32 v15, 0xffff0000, v103
    v_fma_f32 v11, v11, v22, v30
    v_fma_f32 v15, v15, v23, v31
    v_cvt_pk_bf16_f32 v103, v11, v15
    ds_write_b128 v9, v[96:99] offset:16384
    ds_write_b128 v9, v[100:103] offset:20992
    ds_write_b128 v9, v[104:107] offset:25600
    ds_write_b128 v9, v[108:111] offset:30208
    ds_write_b128 v9, v[112:115] offset:34816
    ds_write_b128 v9, v[116:119] offset:39424
    v_mul_u32_u24 v14, 144, v12
    v_lshlrev_b32 v15, 4, v13
    v_add_u32 v14, v14, v15
    s_mul_i32 s57, s56, 4608
    v_add_u32 v15, s57, v14
    s_mul_i32 s57, s55, 9216
    s_add_u32 s57, s57, 9216
    v_add_u32 v14, s57, v14
    v_mov_b32 v12, v15
    v_mov_b32 v32, 0
    v_mov_b32 v33, 0
    v_mov_b32 v34, 0
    v_mov_b32 v35, 0
    v_mov_b32 v36, 0
    v_mov_b32 v37, 0
    v_mov_b32 v38, 0
    v_mov_b32 v39, 0
    v_mov_b32 v40, 0
    v_mov_b32 v41, 0
    v_mov_b32 v42, 0
    v_mov_b32 v43, 0
    v_mov_b32 v44, 0
    v_mov_b32 v45, 0
    v_mov_b32 v46, 0
    v_mov_b32 v47, 0
    v_mov_b32 v48, 0
    v_mov_b32 v49, 0
    v_mov_b32 v50, 0
    v_mov_b32 v51, 0
    v_mov_b32 v52, 0
    v_mov_b32 v53, 0
    v_mov_b32 v54, 0
    v_mov_b32 v55, 0
    v_mov_b32 v56, 0
    v_mov_b32 v57, 0
    v_mov_b32 v58, 0
    v_mov_b32 v59, 0
    v_mov_b32 v60, 0
    v_mov_b32 v61, 0
    v_mov_b32 v62, 0
    v_mov_b32 v63, 0
    s_waitcnt lgkmcnt(0)
    s_barrier
    ds_read_b128 v[200:203], v12 offset:16384
    ds_read_b128 v[204:207], v12 offset:18688
    ds_read_b128 v[208:211], v14 offset:16384
    ds_read_b128 v[212:215], v14 offset:18688
    ds_read_b128 v[216:219], v14 offset:20992
    ds_read_b128 v[220:223], v14 offset:23296
    ds_read_b128 v[16:19], v10 offset:256
    ds_read_b128 v[20:23], v10 offset:272
    ds_read_b128 v[24:27], v10 offset:8448
    ds_read_b128 v[28:31], v10 offset:8464
    buffer_load_dwordx4 v[96:99], v3, s[28:31], s44 offen
    buffer_load_dwordx4 v[100:103], v4, s[28:31], s44 offen
    buffer_load_dwordx4 v[104:107], v5, s[16:19], s45 offen
    buffer_load_dwordx4 v[108:111], v6, s[16:19], s45 offen
    buffer_load_dwordx4 v[112:115], v7, s[16:19], s45 offen
    buffer_load_dwordx4 v[116:119], v8, s[16:19], s45 offen
    s_add_u32 s44, s44, 128
    s_add_u32 s45, s45, 128
    s_waitcnt vmcnt(18) lgkmcnt(0)
    v_lshlrev_b32 v11, 16, v120
    v_and_b32 v15, 0xffff0000, v120
    v_fma_f32 v11, v11, v16, v24
    v_fma_f32 v15, v15, v17, v25
    v_cvt_pk_bf16_f32 v120, v11, v15
    v_lshlrev_b32 v11, 16, v121
    v_and_b32 v15, 0xffff0000, v121
    v_fma_f32 v11, v11, v18, v26
    v_fma_f32 v15, v15, v19, v27
    v_cvt_pk_bf16_f32 v121, v11, v15
    v_lshlrev_b32 v11, 16, v122
    v_and_b32 v15, 0xffff0000, v122
    v_fma_f32 v11, v11, v20, v28
    v_fma_f32 v15, v15, v21, v29
    v_cvt_pk_bf16_f32 v122, v11, v15
    v_lshlrev_b32 v11, 16, v123
    v_and_b32 v15, 0xffff0000, v123
    v_fma_f32 v11, v11, v22, v30
    v_fma_f32 v15, v15, v23, v31
    v_cvt_pk_bf16_f32 v123, v11, v15
    v_lshlrev_b32 v11, 16, v124
    v_and_b32 v15, 0xffff0000, v124
    v_fma_f32 v11, v11, v16, v24
    v_fma_f32 v15, v15, v17, v25
    v_cvt_pk_bf16_f32 v124, v11, v15
    v_lshlrev_b32 v11, 16, v125
    v_and_b32 v15, 0xffff0000, v125
    v_fma_f32 v11, v11, v18, v26
    v_fma_f32 v15, v15, v19, v27
    v_cvt_pk_bf16_f32 v125, v11, v15
    v_lshlrev_b32 v11, 16, v126
    v_and_b32 v15, 0xffff0000, v126
    v_fma_f32 v11, v11, v20, v28
    v_fma_f32 v15, v15, v21, v29
    v_cvt_pk_bf16_f32 v126, v11, v15
    v_lshlrev_b32 v11, 16, v127
    v_and_b32 v15, 0xffff0000, v127
    v_fma_f32 v11, v11, v22, v30
    v_fma_f32 v15, v15, v23, v31
    v_cvt_pk_bf16_f32 v127, v11, v15
    ds_write_b128 v9, v[120:123] offset:44032
    ds_write_b128 v9, v[124:127] offset:48640
    ds_write_b128 v9, v[128:131] offset:53248
    ds_write_b128 v9, v[132:135] offset:57856
    ds_write_b128 v9, v[136:139] offset:62464
    ds_write_b128 v64, v[140:143] offset:34304
    ds_read_b128 v[224:227], v12 offset:16448
    ds_read_b128 v[228:231], v12 offset:18752
    ds_read_b128 v[232:235], v14 offset:16448
    ds_read_b128 v[236:239], v14 offset:18752
    ds_read_b128 v[240:243], v14 offset:21056
    ds_read_b128 v[244:247], v14 offset:23360
    s_waitcnt lgkmcnt(12)
    v_mfma_f32_16x16x32_bf16 v[32:35], v[200:203], v[208:211], v[32:35]
    v_mfma_f32_16x16x32_bf16 v[36:39], v[204:207], v[208:211], v[36:39]
    v_mfma_f32_16x16x32_bf16 v[40:43], v[200:203], v[212:215], v[40:43]
    v_mfma_f32_16x16x32_bf16 v[44:47], v[204:207], v[212:215], v[44:47]
    v_mfma_f32_16x16x32_bf16 v[48:51], v[200:203], v[216:219], v[48:51]
    v_mfma_f32_16x16x32_bf16 v[52:55], v[204:207], v[216:219], v[52:55]
    v_mfma_f32_16x16x32_bf16 v[56:59], v[200:203], v[220:223], v[56:59]
    v_mfma_f32_16x16x32_bf16 v[60:63], v[204:207], v[220:223], v[60:63]
    s_waitcnt lgkmcnt(0)
    s_barrier
    ds_read_b128 v[200:203], v12 offset:44032
    ds_read_b128 v[204:207], v12 offset:46336
    ds_read_b128 v[208:211], v14 offset:44032
    ds_read_b128 v[212:215], v14 offset:46336
    ds_read_b128 v[216:219], v14 offset:48640
    ds_read_b128 v[220:223], v14 offset:50944
    ds_read_b128 v[16:19], v10 offset:512
    ds_read_b128 v[20:23], v10 offset:528
    ds_read_b128 v[24:27], v10 offset:8704
    ds_read_b128 v[28:31], v10 offset:8720
    buffer_load_dwordx4 v[120:123], v3, s[28:31], s44 offen
    buffer_load_dwordx4 v[124:127], v4, s[28:31], s44 offen
    buffer_load_dwordx4 v[128:131], v5, s[16:19], s45 offen
    buffer_load_dwordx4 v[132:135], v6, s[16:19], s45 offen
    buffer_load_dwordx4 v[136:139], v7, s[16:19], s45 offen
    buffer_load_dwordx4 v[140:143], v8, s[16:19], s45 offen
    s_add_u32 s44, s44, 128
    s_add_u32 s45, s45, 128
    v_mfma_f32_16x16x32_bf16 v[32:35], v[224:227], v[232:235], v[32:35]
    v_mfma_f32_16x16x32_bf16 v[36:39], v[228:231], v[232:235], v[36:39]
    s_waitcnt vmcnt(18) lgkmcnt(0)
    v_mfma_f32_16x16x32_bf16 v[40:43], v[224:227], v[236:239], v[40:43]
    v_lshlrev_b32 v11, 16, v144
    v_and_b32 v15, 0xffff0000, v144
    v_fma_f32 v11, v11, v16, v24
    v_fma_f32 v15, v15, v17, v25
    v_cvt_pk_bf16_f32 v144, v11, v15
    v_lshlrev_b32 v11, 16, v145
    v_and_b32 v15, 0xffff0000, v145
    v_mfma_f32_16x16x32_bf16 v[44:47], v[228:231], v[236:239], v[44:47]
    v_fma_f32 v11, v11, v18, v26
    v_fma_f32 v15, v15, v19, v27
    v_cvt_pk_bf16_f32 v145, v11, v15
    v_lshlrev_b32 v11, 16, v146
    v_and_b32 v15, 0xffff0000, v146
    v_fma_f32 v11, v11, v20, v28
    v_fma_f32 v15, v15, v21, v29
    v_mfma_f32_16x16x32_bf16 v[48:51], v[224:227], v[240:243], v[48:51]
    v_cvt_pk_bf16_f32 v146, v11, v15
    v_lshlrev_b32 v11, 16, v147
    v_and_b32 v15, 0xffff0000, v147
    v_fma_f32 v11, v11, v22, v30
    v_fma_f32 v15, v15, v23, v31
    v_cvt_pk_bf16_f32 v147, v11, v15
    v_lshlrev_b32 v11, 16, v148
    v_mfma_f32_16x16x32_bf16 v[52:55], v[228:231], v[240:243], v[52:55]
    v_and_b32 v15, 0xffff0000, v148
    v_fma_f32 v11, v11, v16, v24
    v_fma_f32 v15, v15, v17, v25
    v_cvt_pk_bf16_f32 v148, v11, v15
    v_lshlrev_b32 v11, 16, v149
    v_and_b32 v15, 0xffff0000, v149
    v_fma_f32 v11, v11, v18, v26
    v_mfma_f32_16x16x32_bf16 v[56:59], v[224:227], v[244:247], v[56:59]
    v_fma_f32 v15, v15, v19, v27
    v_cvt_pk_bf16_f32 v149, v11, v15
    v_lshlrev_b32 v11, 16, v150
    v_and_b32 v15, 0xffff0000, v150
    v_fma_f32 v11, v11, v20, v28
    v_fma_f32 v15, v15, v21, v29
    v_cvt_pk_bf16_f32 v150, v11, v15
    v_mfma_f32_16x16x32_bf16 v[60:63], v[228:231], v[244:247], v[60:63]
    v_lshlrev_b32 v11, 16, v151
    v_and_b32 v15, 0xffff0000, v151
    v_fma_f32 v11, v11, v22, v30
    v_fma_f32 v15, v15, v23, v31
    v_cvt_pk_bf16_f32 v151, v11, v15
    ds_write_b128 v9, v[144:147] offset:16384
    ds_write_b128 v9, v[148:151] offset:20992
    ds_write_b128 v9, v[152:155] offset:25600
    ds_write_b128 v9, v[156:159] offset:30208
    ds_write_b128 v9, v[160:163] offset:34816
    ds_write_b128 v9, v[164:167] offset:39424
    ds_read_b128 v[224:227], v12 offset:44096
    ds_read_b128 v[228:231], v12 offset:46400
    ds_read_b128 v[232:235], v14 offset:44096
    ds_read_b128 v[236:239], v14 offset:46400
    ds_read_b128 v[240:243], v14 offset:48704
    ds_read_b128 v[244:247], v14 offset:51008
    s_waitcnt lgkmcnt(12)
    v_mfma_f32_16x16x32_bf16 v[32:35], v[200:203], v[208:211], v[32:35]
    v_mfma_f32_16x16x32_bf16 v[36:39], v[204:207], v[208:211], v[36:39]
    v_mfma_f32_16x16x32_bf16 v[40:43], v[200:203], v[212:215], v[40:43]
    v_mfma_f32_16x16x32_bf16 v[44:47], v[204:207], v[212:215], v[44:47]
    v_mfma_f32_16x16x32_bf16 v[48:51], v[200:203], v[216:219], v[48:51]
    v_mfma_f32_16x16x32_bf16 v[52:55], v[204:207], v[216:219], v[52:55]
    v_mfma_f32_16x16x32_bf16 v[56:59], v[200:203], v[220:223], v[56:59]
    v_mfma_f32_16x16x32_bf16 v[60:63], v[204:207], v[220:223], v[60:63]
    s_waitcnt lgkmcnt(0)
    s_barrier
    ds_read_b128 v[200:203], v12 offset:16384
    ds_read_b128 v[204:207], v12 offset:18688
    ds_read_b128 v[208:211], v14 offset:16384
    ds_read_b128 v[212:215], v14 offset:18688
    ds_read_b128 v[216:219], v14 offset:20992
    ds_read_b128 v[220:223], v14 offset:23296
    ds_read_b128 v[16:19], v10 offset:768
    ds_read_b128 v[20:23], v10 offset:784
    ds_read_b128 v[24:27], v10 offset:8960
    ds_read_b128 v[28:31], v10 offset:8976
    buffer_load_dwordx4 v[144:147], v3, s[28:31], s44 offen
    buffer_load_dwordx4 v[148:151], v4, s[28:31], s44 offen
    buffer_load_dwordx4 v[152:155], v5, s[16:19], s45 offen
    buffer_load_dwordx4 v[156:159], v6, s[16:19], s45 offen
    buffer_load_dwordx4 v[160:163], v7, s[16:19], s45 offen
    buffer_load_dwordx4 v[164:167], v8, s[16:19], s45 offen
    s_add_u32 s44, s44, 128
    s_add_u32 s45, s45, 128
    v_mfma_f32_16x16x32_bf16 v[32:35], v[224:227], v[232:235], v[32:35]
    v_mfma_f32_16x16x32_bf16 v[36:39], v[228:231], v[232:235], v[36:39]
    s_waitcnt vmcnt(18) lgkmcnt(0)
    v_mfma_f32_16x16x32_bf16 v[40:43], v[224:227], v[236:239], v[40:43]
    v_lshlrev_b32 v11, 16, v168
    v_and_b32 v15, 0xffff0000, v168
    v_fma_f32 v11, v11, v16, v24
    v_fma_f32 v15, v15, v17, v25
    v_cvt_pk_bf16_f32 v168, v11, v15
    v_lshlrev_b32 v11, 16, v169
    v_and_b32 v15, 0xffff0000, v169
    v_mfma_f32_16x16x32_bf16 v[44:47], v[228:231], v[236:239], v[44:47]
    v_fma_f32 v11, v11, v18, v26
    v_fma_f32 v15, v15, v19, v27
    v_cvt_pk_bf16_f32 v169, v11, v15
    v_lshlrev_b32 v11, 16, v170
    v_and_b32 v15, 0xffff0000, v170
    v_fma_f32 v11, v11, v20, v28
    v_fma_f32 v15, v15, v21, v29
    v_mfma_f32_16x16x32_bf16 v[48:51], v[224:227], v[240:243], v[48:51]
    v_cvt_pk_bf16_f32 v170, v11, v15
    v_lshlrev_b32 v11, 16, v171
    v_and_b32 v15, 0xffff0000, v171
    v_fma_f32 v11, v11, v22, v30
    v_fma_f32 v15, v15, v23, v31
    v_cvt_pk_bf16_f32 v171, v11, v15
    v_lshlrev_b32 v11, 16, v172
    v_mfma_f32_16x16x32_bf16 v[52:55], v[228:231], v[240:243], v[52:55]
    v_and_b32 v15, 0xffff0000, v172
    v_fma_f32 v11, v11, v16, v24
    v_fma_f32 v15, v15, v17, v25
    v_cvt_pk_bf16_f32 v172, v11, v15
    v_lshlrev_b32 v11, 16, v173
    v_and_b32 v15, 0xffff0000, v173
    v_fma_f32 v11, v11, v18, v26
    v_mfma_f32_16x16x32_bf16 v[56:59], v[224:227], v[244:247], v[56:59]
    v_fma_f32 v15, v15, v19, v27
    v_cvt_pk_bf16_f32 v173, v11, v15
    v_lshlrev_b32 v11, 16, v174
    v_and_b32 v15, 0xffff0000, v174
    v_fma_f32 v11, v11, v20, v28
    v_fma_f32 v15, v15, v21, v29
    v_cvt_pk_bf16_f32 v174, v11, v15
    v_mfma_f32_16x16x32_bf16 v[60:63], v[228:231], v[244:247], v[60:63]
    v_lshlrev_b32 v11, 16, v175
    v_and_b32 v15, 0xffff0000, v175
    v_fma_f32 v11, v11, v22, v30
    v_fma_f32 v15, v15, v23, v31
    v_cvt_pk_bf16_f32 v175, v11, v15
    ds_write_b128 v9, v[168:171] offset:44032
    ds_write_b128 v9, v[172:175] offset:48640
    ds_write_b128 v9, v[176:179] offset:53248
    ds_write_b128 v9, v[180:183] offset:57856
    ds_write_b128 v9, v[184:187] offset:62464
    ds_write_b128 v64, v[188:191] offset:34304
    ds_read_b128 v[224:227], v12 offset:16448
    ds_read_b128 v[228:231], v12 offset:18752
    ds_read_b128 v[232:235], v14 offset:16448
    ds_read_b128 v[236:239], v14 offset:18752
    ds_read_b128 v[240:243], v14 offset:21056
    ds_read_b128 v[244:247], v14 offset:23360
    s_waitcnt lgkmcnt(12)
    v_mfma_f32_16x16x32_bf16 v[32:35], v[200:203], v[208:211], v[32:35]
    v_mfma_f32_16x16x32_bf16 v[36:39], v[204:207], v[208:211], v[36:39]
    v_mfma_f32_16x16x32_bf16 v[40:43], v[200:203], v[212:215], v[40:43]
    v_mfma_f32_16x16x32_bf16 v[44:47], v[204:207], v[212:215], v[44:47]
    v_mfma_f32_16x16x32_bf16 v[48:51], v[200:203], v[216:219], v[48:51]
    v_mfma_f32_16x16x32_bf16 v[52:55], v[204:207], v[216:219], v[52:55]
    v_mfma_f32_16x16x32_bf16 v[56:59], v[200:203], v[220:223], v[56:59]
    v_mfma_f32_16x16x32_bf16 v[60:63], v[204:207], v[220:223], v[60:63]
    s_waitcnt lgkmcnt(0)
    s_barrier
    ds_read_b128 v[200:203], v12 offset:44032
    ds_read_b128 v[204:207], v12 offset:46336
    ds_read_b128 v[208:211], v14 offset:44032
    ds_read_b128 v[212:215], v14 offset:46336
    ds_read_b128 v[216:219], v14 offset:48640
    ds_read_b128 v[220:223], v14 offset:50944
    ds_read_b128 v[16:19], v10 offset:1024
    ds_read_b128 v[20:23], v10 offset:1040
    ds_read_b128 v[24:27], v10 offset:9216
    ds_read_b128 v[28:31], v10 offset:9232
    buffer_load_dwordx4 v[168:171], v3, s[28:31], s44 offen
    buffer_load_dwordx4 v[172:175], v4, s[28:31], s44 offen
    buffer_load_dwordx4 v[176:179], v5, s[16:19], s45 offen
    buffer_load_dwordx4 v[180:183], v6, s[16:19], s45 offen
    buffer_load_dwordx4 v[184:187], v7, s[16:19], s45 offen
    buffer_load_dwordx4 v[188:191], v8, s[16:19], s45 offen
    s_add_u32 s44, s44, 128
    s_add_u32 s45, s45, 128
    v_mfma_f32_16x16x32_bf16 v[32:35], v[224:227], v[232:235], v[32:35]
    v_mfma_f32_16x16x32_bf16 v[36:39], v[228:231], v[232:235], v[36:39]
    s_waitcnt vmcnt(18) lgkmcnt(0)
    v_mfma_f32_16x16x32_bf16 v[40:43], v[224:227], v[236:239], v[40:43]
    v_lshlrev_b32 v11, 16, v96
    v_and_b32 v15, 0xffff0000, v96
    v_fma_f32 v11, v11, v16, v24
    v_fma_f32 v15, v15, v17, v25
    v_cvt_pk_bf16_f32 v96, v11, v15
    v_lshlrev_b32 v11, 16, v97
    v_and_b32 v15, 0xffff0000, v97
    v_mfma_f32_16x16x32_bf16 v[44:47], v[228:231], v[236:239], v[44:47]
    v_fma_f32 v11, v11, v18, v26
    v_fma_f32 v15, v15, v19, v27
    v_cvt_pk_bf16_f32 v97, v11, v15
    v_lshlrev_b32 v11, 16, v98
    v_and_b32 v15, 0xffff0000, v98
    v_fma_f32 v11, v11, v20, v28
    v_fma_f32 v15, v15, v21, v29
    v_mfma_f32_16x16x32_bf16 v[48:51], v[224:227], v[240:243], v[48:51]
    v_cvt_pk_bf16_f32 v98, v11, v15
    v_lshlrev_b32 v11, 16, v99
    v_and_b32 v15, 0xffff0000, v99
    v_fma_f32 v11, v11, v22, v30
    v_fma_f32 v15, v15, v23, v31
    v_cvt_pk_bf16_f32 v99, v11, v15
    v_lshlrev_b32 v11, 16, v100
    v_mfma_f32_16x16x32_bf16 v[52:55], v[228:231], v[240:243], v[52:55]
    v_and_b32 v15, 0xffff0000, v100
    v_fma_f32 v11, v11, v16, v24
    v_fma_f32 v15, v15, v17, v25
    v_cvt_pk_bf16_f32 v100, v11, v15
    v_lshlrev_b32 v11, 16, v101
    v_and_b32 v15, 0xffff0000, v101
    v_fma_f32 v11, v11, v18, v26
    v_mfma_f32_16x16x32_bf16 v[56:59], v[224:227], v[244:247], v[56:59]
    v_fma_f32 v15, v15, v19, v27
    v_cvt_pk_bf16_f32 v101, v11, v15
    v_lshlrev_b32 v11, 16, v102
    v_and_b32 v15, 0xffff0000, v102
    v_fma_f32 v11, v11, v20, v28
    v_fma_f32 v15, v15, v21, v29
    v_cvt_pk_bf16_f32 v102, v11, v15
    v_mfma_f32_16x16x32_bf16 v[60:63], v[228:231], v[244:247], v[60:63]
    v_lshlrev_b32 v11, 16, v103
    v_and_b32 v15, 0xffff0000, v103
    v_fma_f32 v11, v11, v22, v30
    v_fma_f32 v15, v15, v23, v31
    v_cvt_pk_bf16_f32 v103, v11, v15
    ds_write_b128 v9, v[96:99] offset:16384
    ds_write_b128 v9, v[100:103] offset:20992
    ds_write_b128 v9, v[104:107] offset:25600
    ds_write_b128 v9, v[108:111] offset:30208
    ds_write_b128 v9, v[112:115] offset:34816
    ds_write_b128 v9, v[116:119] offset:39424
    ds_read_b128 v[224:227], v12 offset:44096
    ds_read_b128 v[228:231], v12 offset:46400
    ds_read_b128 v[232:235], v14 offset:44096
    ds_read_b128 v[236:239], v14 offset:46400
    ds_read_b128 v[240:243], v14 offset:48704
    ds_read_b128 v[244:247], v14 offset:51008
    s_waitcnt lgkmcnt(12)
    v_mfma_f32_16x16x32_bf16 v[32:35], v[200:203], v[208:211], v[32:35]
    v_mfma_f32_16x16x32_bf16 v[36:39], v[204:207], v[208:211], v[36:39]
    v_mfma_f32_16x16x32_bf16 v[40:43], v[200:203], v[212:215], v[40:43]
    v_mfma_f32_16x16x32_bf16 v[44:47], v[204:207], v[212:215], v[44:47]
    v_mfma_f32_16x16x32_bf16 v[48:51], v[200:203], v[216:219], v[48:51]
    v_mfma_f32_16x16x32_bf16 v[52:55], v[204:207], v[216:219], v[52:55]
    v_mfma_f32_16x16x32_bf16 v[56:59], v[200:203], v[220:223], v[56:59]
    v_mfma_f32_16x16x32_bf16 v[60:63], v[204:207], v[220:223], v[60:63]
    s_waitcnt lgkmcnt(0)
    s_barrier
    ds_read_b128 v[200:203], v12 offset:16384
    ds_read_b128 v[204:207], v12 offset:18688
    ds_read_b128 v[208:211], v14 offset:16384
    ds_read_b128 v[212:215], v14 offset:18688
    ds_read_b128 v[216:219], v14 offset:20992
    ds_read_b128 v[220:223], v14 offset:23296
    ds_read_b128 v[16:19], v10 offset:1280
    ds_read_b128 v[20:23], v10 offset:1296
    ds_read_b128 v[24:27], v10 offset:9472
    ds_read_b128 v[28:31], v10 offset:9488
    buffer_load_dwordx4 v[96:99], v3, s[28:31], s44 offen
    buffer_load_dwordx4 v[100:103], v4, s[28:31], s44 offen
    buffer_load_dwordx4 v[104:107], v5, s[16:19], s45 offen
    buffer_load_dwordx4 v[108:111], v6, s[16:19], s45 offen
    buffer_load_dwordx4 v[112:115], v7, s[16:19], s45 offen
    buffer_load_dwordx4 v[116:119], v8, s[16:19], s45 offen
    s_add_u32 s44, s44, 128
    s_add_u32 s45, s45, 128
    v_mfma_f32_16x16x32_bf16 v[32:35], v[224:227], v[232:235], v[32:35]
    v_mfma_f32_16x16x32_bf16 v[36:39], v[228:231], v[232:235], v[36:39]
    s_waitcnt vmcnt(18) lgkmcnt(0)
    v_mfma_f32_16x16x32_bf16 v[40:43], v[224:227], v[236:239], v[40:43]
    v_lshlrev_b32 v11, 16, v120
    v_and_b32 v15, 0xffff0000, v120
    v_fma_f32 v11, v11, v16, v24
    v_fma_f32 v15, v15, v17, v25
    v_cvt_pk_bf16_f32 v120, v11, v15
    v_lshlrev_b32 v11, 16, v121
    v_and_b32 v15, 0xffff0000, v121
    v_mfma_f32_16x16x32_bf16 v[44:47], v[228:231], v[236:239], v[44:47]
    v_fma_f32 v11, v11, v18, v26
    v_fma_f32 v15, v15, v19, v27
    v_cvt_pk_bf16_f32 v121, v11, v15
    v_lshlrev_b32 v11, 16, v122
    v_and_b32 v15, 0xffff0000, v122
    v_fma_f32 v11, v11, v20, v28
    v_fma_f32 v15, v15, v21, v29
    v_mfma_f32_16x16x32_bf16 v[48:51], v[224:227], v[240:243], v[48:51]
    v_cvt_pk_bf16_f32 v122, v11, v15
    v_lshlrev_b32 v11, 16, v123
    v_and_b32 v15, 0xffff0000, v123
    v_fma_f32 v11, v11, v22, v30
    v_fma_f32 v15, v15, v23, v31
    v_cvt_pk_bf16_f32 v123, v11, v15
    v_lshlrev_b32 v11, 16, v124
    v_mfma_f32_16x16x32_bf16 v[52:55], v[228:231], v[240:243], v[52:55]
    v_and_b32 v15, 0xffff0000, v124
    v_fma_f32 v11, v11, v16, v24
    v_fma_f32 v15, v15, v17, v25
    v_cvt_pk_bf16_f32 v124, v11, v15
    v_lshlrev_b32 v11, 16, v125
    v_and_b32 v15, 0xffff0000, v125
    v_fma_f32 v11, v11, v18, v26
    v_mfma_f32_16x16x32_bf16 v[56:59], v[224:227], v[244:247], v[56:59]
    v_fma_f32 v15, v15, v19, v27
    v_cvt_pk_bf16_f32 v125, v11, v15
    v_lshlrev_b32 v11, 16, v126
    v_and_b32 v15, 0xffff0000, v126
    v_fma_f32 v11, v11, v20, v28
    v_fma_f32 v15, v15, v21, v29
    v_cvt_pk_bf16_f32 v126, v11, v15
    v_mfma_f32_16x16x32_bf16 v[60:63], v[228:231], v[244:247], v[60:63]
    v_lshlrev_b32 v11, 16, v127
    v_and_b32 v15, 0xffff0000, v127
    v_fma_f32 v11, v11, v22, v30
    v_fma_f32 v15, v15, v23, v31
    v_cvt_pk_bf16_f32 v127, v11, v15
    ds_write_b128 v9, v[120:123] offset:44032
    ds_write_b128 v9, v[124:127] offset:48640
    ds_write_b128 v9, v[128:131] offset:53248
    ds_write_b128 v9, v[132:135] offset:57856
    ds_write_b128 v9, v[136:139] offset:62464
    ds_write_b128 v64, v[140:143] offset:34304
    ds_read_b128 v[224:227], v12 offset:16448
    ds_read_b128 v[228:231], v12 offset:18752
    ds_read_b128 v[232:235], v14 offset:16448
    ds_read_b128 v[236:239], v14 offset:18752
    ds_read_b128 v[240:243], v14 offset:21056
    ds_read_b128 v[244:247], v14 offset:23360
    s_waitcnt lgkmcnt(12)
    v_mfma_f32_16x16x32_bf16 v[32:35], v[200:203], v[208:211], v[32:35]
    v_mfma_f32_16x16x32_bf16 v[36:39], v[204:207], v[208:211], v[36:39]
    v_mfma_f32_16x16x32_bf16 v[40:43], v[200:203], v[212:215], v[40:43]
    v_mfma_f32_16x16x32_bf16 v[44:47], v[204:207], v[212:215], v[44:47]
    v_mfma_f32_16x16x32_bf16 v[48:51], v[200:203], v[216:219], v[48:51]
    v_mfma_f32_16x16x32_bf16 v[52:55], v[204:207], v[216:219], v[52:55]
    v_mfma_f32_16x16x32_bf16 v[56:59], v[200:203], v[220:223], v[56:59]
    v_mfma_f32_16x16x32_bf16 v[60:63], v[204:207], v[220:223], v[60:63]
    s_waitcnt lgkmcnt(0)
    s_barrier
    ds_read_b128 v[200:203], v12 offset:44032
    ds_read_b128 v[204:207], v12 offset:46336
    ds_read_b128 v[208:211], v14 offset:44032
    ds_read_b128 v[212:215], v14 offset:46336
    ds_read_b128 v[216:219], v14 offset:48640
    ds_read_b128 v[220:223], v14 offset:50944
    ds_read_b128 v[16:19], v10 offset:1536
    ds_read_b128 v[20:23], v10 offset:1552
    ds_read_b128 v[24:27], v10 offset:9728
    ds_read_b128 v[28:31], v10 offset:9744
    buffer_load_dwordx4 v[120:123], v3, s[28:31], s44 offen
    buffer_load_dwordx4 v[124:127], v4, s[28:31], s44 offen
    buffer_load_dwordx4 v[128:131], v5, s[16:19], s45 offen
    buffer_load_dwordx4 v[132:135], v6, s[16:19], s45 offen
    buffer_load_dwordx4 v[136:139], v7, s[16:19], s45 offen
    buffer_load_dwordx4 v[140:143], v8, s[16:19], s45 offen
    s_add_u32 s44, s44, 128
    s_add_u32 s45, s45, 128
    v_mfma_f32_16x16x32_bf16 v[32:35], v[224:227], v[232:235], v[32:35]
    v_mfma_f32_16x16x32_bf16 v[36:39], v[228:231], v[232:235], v[36:39]
    s_waitcnt vmcnt(18) lgkmcnt(0)
    v_mfma_f32_16x16x32_bf16 v[40:43], v[224:227], v[236:239], v[40:43]
    v_lshlrev_b32 v11, 16, v144
    v_and_b32 v15, 0xffff0000, v144
    v_fma_f32 v11, v11, v16, v24
    v_fma_f32 v15, v15, v17, v25
    v_cvt_pk_bf16_f32 v144, v11, v15
    v_lshlrev_b32 v11, 16, v145
    v_and_b32 v15, 0xffff0000, v145
    v_mfma_f32_16x16x32_bf16 v[44:47], v[228:231], v[236:239], v[44:47]
    v_fma_f32 v11, v11, v18, v26
    v_fma_f32 v15, v15, v19, v27
    v_cvt_pk_bf16_f32 v145, v11, v15
    v_lshlrev_b32 v11, 16, v146
    v_and_b32 v15, 0xffff0000, v146
    v_fma_f32 v11, v11, v20, v28
    v_fma_f32 v15, v15, v21, v29
    v_mfma_f32_16x16x32_bf16 v[48:51], v[224:227], v[240:243], v[48:51]
    v_cvt_pk_bf16_f32 v146, v11, v15
    v_lshlrev_b32 v11, 16, v147
    v_and_b32 v15, 0xffff0000, v147
    v_fma_f32 v11, v11, v22, v30
    v_fma_f32 v15, v15, v23, v31
    v_cvt_pk_bf16_f32 v147, v11, v15
    v_lshlrev_b32 v11, 16, v148
    v_mfma_f32_16x16x32_bf16 v[52:55], v[228:231], v[240:243], v[52:55]
    v_and_b32 v15, 0xffff0000, v148
    v_fma_f32 v11, v11, v16, v24
    v_fma_f32 v15, v15, v17, v25
    v_cvt_pk_bf16_f32 v148, v11, v15
    v_lshlrev_b32 v11, 16, v149
    v_and_b32 v15, 0xffff0000, v149
    v_fma_f32 v11, v11, v18, v26
    v_mfma_f32_16x16x32_bf16 v[56:59], v[224:227], v[244:247], v[56:59]
    v_fma_f32 v15, v15, v19, v27
    v_cvt_pk_bf16_f32 v149, v11, v15
    v_lshlrev_b32 v11, 16, v150
    v_and_b32 v15, 0xffff0000, v150
    v_fma_f32 v11, v11, v20, v28
    v_fma_f32 v15, v15, v21, v29
    v_cvt_pk_bf16_f32 v150, v11, v15
    v_mfma_f32_16x16x32_bf16 v[60:63], v[228:231], v[244:247], v[60:63]
    v_lshlrev_b32 v11, 16, v151
    v_and_b32 v15, 0xffff0000, v151
    v_fma_f32 v11, v11, v22, v30
    v_fma_f32 v15, v15, v23, v31
    v_cvt_pk_bf16_f32 v151, v11, v15
    ds_write_b128 v9, v[144:147] offset:16384
    ds_write_b128 v9, v[148:151] offset:20992
    ds_write_b128 v9, v[152:155] offset:25600
    ds_write_b128 v9, v[156:159] offset:30208
    ds_write_b128 v9, v[160:163] offset:34816
    ds_write_b128 v9, v[164:167] offset:39424
    ds_read_b128 v[224:227], v12 offset:44096
    ds_read_b128 v[228:231], v12 offset:46400
    ds_read_b128 v[232:235], v14 offset:44096
    ds_read_b128 v[236:239], v14 offset:46400
    ds_read_b128 v[240:243], v14 offset:48704
    ds_read_b128 v[244:247], v14 offset:51008
    s_waitcnt lgkmcnt(12)
    v_mfma_f32_16x16x32_bf16 v[32:35], v[200:203], v[208:211], v[32:35]
    v_mfma_f32_16x16x32_bf16 v[36:39], v[204:207], v[208:211], v[36:39]
    v_mfma_f32_16x16x32_bf16 v[40:43], v[200:203], v[212:215], v[40:43]
    v_mfma_f32_16x16x32_bf16 v[44:47], v[204:207], v[212:215], v[44:47]
    v_mfma_f32_16x16x32_bf16 v[48:51], v[200:203], v[216:219], v[48:51]
    v_mfma_f32_16x16x32_bf16 v[52:55], v[204:207], v[216:219], v[52:55]
    v_mfma_f32_16x16x32_bf16 v[56:59], v[200:203], v[220:223], v[56:59]
    v_mfma_f32_16x16x32_bf16 v[60:63], v[204:207], v[220:223], v[60:63]
    s_waitcnt lgkmcnt(0)
    s_barrier
    ds_read_b128 v[200:203], v12 offset:16384
    ds_read_b128 v[204:207], v12 offset:18688
    ds_read_b128 v[208:211], v14 offset:16384
    ds_read_b128 v[212:215], v14 offset:18688
    ds_read_b128 v[216:219], v14 offset:20992
    ds_read_b128 v[220:223], v14 offset:23296
    ds_read_b128 v[16:19], v10 offset:1792
    ds_read_b128 v[20:23], v10 offset:1808
    ds_read_b128 v[24:27], v10 offset:9984
    ds_read_b128 v[28:31], v10 offset:10000
    buffer_load_dwordx4 v[144:147], v3, s[28:31], s44 offen
    buffer_load_dwordx4 v[148:151], v4, s[28:31], s44 offen
    buffer_load_dwordx4 v[152:155], v5, s[16:19], s45 offen
    buffer_load_dwordx4 v[156:159], v6, s[16:19], s45 offen
    buffer_load_dwordx4 v[160:163], v7, s[16:19], s45 offen
    buffer_load_dwordx4 v[164:167], v8, s[16:19], s45 offen
    s_add_u32 s44, s44, 128
    s_add_u32 s45, s45, 128
    v_mfma_f32_16x16x32_bf16 v[32:35], v[224:227], v[232:235], v[32:35]
    v_mfma_f32_16x16x32_bf16 v[36:39], v[228:231], v[232:235], v[36:39]
    s_waitcnt vmcnt(18) lgkmcnt(0)
    v_mfma_f32_16x16x32_bf16 v[40:43], v[224:227], v[236:239], v[40:43]
    v_lshlrev_b32 v11, 16, v168
    v_and_b32 v15, 0xffff0000, v168
    v_fma_f32 v11, v11, v16, v24
    v_fma_f32 v15, v15, v17, v25
    v_cvt_pk_bf16_f32 v168, v11, v15
    v_lshlrev_b32 v11, 16, v169
    v_and_b32 v15, 0xffff0000, v169
    v_mfma_f32_16x16x32_bf16 v[44:47], v[228:231], v[236:239], v[44:47]
    v_fma_f32 v11, v11, v18, v26
    v_fma_f32 v15, v15, v19, v27
    v_cvt_pk_bf16_f32 v169, v11, v15
    v_lshlrev_b32 v11, 16, v170
    v_and_b32 v15, 0xffff0000, v170
    v_fma_f32 v11, v11, v20, v28
    v_fma_f32 v15, v15, v21, v29
    v_mfma_f32_16x16x32_bf16 v[48:51], v[224:227], v[240:243], v[48:51]
    v_cvt_pk_bf16_f32 v170, v11, v15
    v_lshlrev_b32 v11, 16, v171
    v_and_b32 v15, 0xffff0000, v171
    v_fma_f32 v11, v11, v22, v30
    v_fma_f32 v15, v15, v23, v31
    v_cvt_pk_bf16_f32 v171, v11, v15
    v_lshlrev_b32 v11, 16, v172
    v_mfma_f32_16x16x32_bf16 v[52:55], v[228:231], v[240:243], v[52:55]
    v_and_b32 v15, 0xffff0000, v172
    v_fma_f32 v11, v11, v16, v24
    v_fma_f32 v15, v15, v17, v25
    v_cvt_pk_bf16_f32 v172, v11, v15
    v_lshlrev_b32 v11, 16, v173
    v_and_b32 v15, 0xffff0000, v173
    v_fma_f32 v11, v11, v18, v26
    v_mfma_f32_16x16x32_bf16 v[56:59], v[224:227], v[244:247], v[56:59]
    v_fma_f32 v15, v15, v19, v27
    v_cvt_pk_bf16_f32 v173, v11, v15
    v_lshlrev_b32 v11, 16, v174
    v_and_b32 v15, 0xffff0000, v174
    v_fma_f32 v11, v11, v20, v28
    v_fma_f32 v15, v15, v21, v29
    v_cvt_pk_bf16_f32 v174, v11, v15
    v_mfma_f32_16x16x32_bf16 v[60:63], v[228:231], v[244:247], v[60:63]
    v_lshlrev_b32 v11, 16, v175
    v_and_b32 v15, 0xffff0000, v175
    v_fma_f32 v11, v11, v22, v30
    v_fma_f32 v15, v15, v23, v31
    v_cvt_pk_bf16_f32 v175, v11, v15
    ds_write_b128 v9, v[168:171] offset:44032
    ds_write_b128 v9, v[172:175] offset:48640
    ds_write_b128 v9, v[176:179] offset:53248
    ds_write_b128 v9, v[180:183] offset:57856
    ds_write_b128 v9, v[184:187] offset:62464
    ds_write_b128 v64, v[188:191] offset:34304
    ds_read_b128 v[224:227], v12 offset:16448
    ds_read_b128 v[228:231], v12 offset:18752
    ds_read_b128 v[232:235], v14 offset:16448
    ds_read_b128 v[236:239], v14 offset:18752
    ds_read_b128 v[240:243], v14 offset:21056
    ds_read_b128 v[244:247], v14 offset:23360
    s_waitcnt lgkmcnt(12)
    v_mfma_f32_16x16x32_bf16 v[32:35], v[200:203], v[208:211], v[32:35]
    v_mfma_f32_16x16x32_bf16 v[36:39], v[204:207], v[208:211], v[36:39]
    v_mfma_f32_16x16x32_bf16 v[40:43], v[200:203], v[212:215], v[40:43]
    v_mfma_f32_16x16x32_bf16 v[44:47], v[204:207], v[212:215], v[44:47]
    v_mfma_f32_16x16x32_bf16 v[48:51], v[200:203], v[216:219], v[48:51]
    v_mfma_f32_16x16x32_bf16 v[52:55], v[204:207], v[216:219], v[52:55]
    v_mfma_f32_16x16x32_bf16 v[56:59], v[200:203], v[220:223], v[56:59]
    v_mfma_f32_16x16x32_bf16 v[60:63], v[204:207], v[220:223], v[60:63]
    s_waitcnt lgkmcnt(0)
    s_barrier
    ds_read_b128 v[200:203], v12 offset:44032
    ds_read_b128 v[204:207], v12 offset:46336
    ds_read_b128 v[208:211], v14 offset:44032
    ds_read_b128 v[212:215], v14 offset:46336
    ds_read_b128 v[216:219], v14 offset:48640
    ds_read_b128 v[220:223], v14 offset:50944
    ds_read_b128 v[16:19], v10 offset:2048
    ds_read_b128 v[20:23], v10 offset:2064
    ds_read_b128 v[24:27], v10 offset:10240
    ds_read_b128 v[28:31], v10 offset:10256
    buffer_load_dwordx4 v[168:171], v3, s[28:31], s44 offen
    buffer_load_dwordx4 v[172:175], v4, s[28:31], s44 offen
    buffer_load_dwordx4 v[176:179], v5, s[16:19], s45 offen
    buffer_load_dwordx4 v[180:183], v6, s[16:19], s45 offen
    buffer_load_dwordx4 v[184:187], v7, s[16:19], s45 offen
    buffer_load_dwordx4 v[188:191], v8, s[16:19], s45 offen
    s_add_u32 s44, s44, 128
    s_add_u32 s45, s45, 128
    v_mfma_f32_16x16x32_bf16 v[32:35], v[224:227], v[232:235], v[32:35]
    v_mfma_f32_16x16x32_bf16 v[36:39], v[228:231], v[232:235], v[36:39]
    s_waitcnt vmcnt(18) lgkmcnt(0)
    v_mfma_f32_16x16x32_bf16 v[40:43], v[224:227], v[236:239], v[40:43]
    v_lshlrev_b32 v11, 16, v96
    v_and_b32 v15, 0xffff0000, v96
    v_fma_f32 v11, v11, v16, v24
    v_fma_f32 v15, v15, v17, v25
    v_cvt_pk_bf16_f32 v96, v11, v15
    v_lshlrev_b32 v11, 16, v97
    v_and_b32 v15, 0xffff0000, v97
    v_mfma_f32_16x16x32_bf16 v[44:47], v[228:231], v[236:239], v[44:47]
    v_fma_f32 v11, v11, v18, v26
    v_fma_f32 v15, v15, v19, v27
    v_cvt_pk_bf16_f32 v97, v11, v15
    v_lshlrev_b32 v11, 16, v98
    v_and_b32 v15, 0xffff0000, v98
    v_fma_f32 v11, v11, v20, v28
    v_fma_f32 v15, v15, v21, v29
    v_mfma_f32_16x16x32_bf16 v[48:51], v[224:227], v[240:243], v[48:51]
    v_cvt_pk_bf16_f32 v98, v11, v15
    v_lshlrev_b32 v11, 16, v99
    v_and_b32 v15, 0xffff0000, v99
    v_fma_f32 v11, v11, v22, v30
    v_fma_f32 v15, v15, v23, v31
    v_cvt_pk_bf16_f32 v99, v11, v15
    v_lshlrev_b32 v11, 16, v100
    v_mfma_f32_16x16x32_bf16 v[52:55], v[228:231], v[240:243], v[52:55]
    v_and_b32 v15, 0xffff0000, v100
    v_fma_f32 v11, v11, v16, v24
    v_fma_f32 v15, v15, v17, v25
    v_cvt_pk_bf16_f32 v100, v11, v15
    v_lshlrev_b32 v11, 16, v101
    v_and_b32 v15, 0xffff0000, v101
    v_fma_f32 v11, v11, v18, v26
    v_mfma_f32_16x16x32_bf16 v[56:59], v[224:227], v[244:247], v[56:59]
    v_fma_f32 v15, v15, v19, v27
    v_cvt_pk_bf16_f32 v101, v11, v15
    v_lshlrev_b32 v11, 16, v102
    v_and_b32 v15, 0xffff0000, v102
    v_fma_f32 v11, v11, v20, v28
    v_fma_f32 v15, v15, v21, v29
    v_cvt_pk_bf16_f32 v102, v11, v15
    v_mfma_f32_16x16x32_bf16 v[60:63], v[228:231], v[244:247], v[60:63]
    v_lshlrev_b32 v11, 16, v103
    v_and_b32 v15, 0xffff0000, v103
    v_fma_f32 v11, v11, v22, v30
    v_fma_f32 v15, v15, v23, v31
    v_cvt_pk_bf16_f32 v103, v11, v15
    ds_write_b128 v9, v[96:99] offset:16384
    ds_write_b128 v9, v[100:103] offset:20992
    ds_write_b128 v9, v[104:107] offset:25600
    ds_write_b128 v9, v[108:111] offset:30208
    ds_write_b128 v9, v[112:115] offset:34816
    ds_write_b128 v9, v[116:119] offset:39424
    ds_read_b128 v[224:227], v12 offset:44096
    ds_read_b128 v[228:231], v12 offset:46400
    ds_read_b128 v[232:235], v14 offset:44096
    ds_read_b128 v[236:239], v14 offset:46400
    ds_read_b128 v[240:243], v14 offset:48704
    ds_read_b128 v[244:247], v14 offset:51008
    s_waitcnt lgkmcnt(12)
    v_mfma_f32_16x16x32_bf16 v[32:35], v[200:203], v[208:211], v[32:35]
    v_mfma_f32_16x16x32_bf16 v[36:39], v[204:207], v[208:211], v[36:39]
    v_mfma_f32_16x16x32_bf16 v[40:43], v[200:203], v[212:215], v[40:43]
    v_mfma_f32_16x16x32_bf16 v[44:47], v[204:207], v[212:215], v[44:47]
    v_mfma_f32_16x16x32_bf16 v[48:51], v[200:203], v[216:219], v[48:51]
    v_mfma_f32_16x16x32_bf16 v[52:55], v[204:207], v[216:219], v[52:55]
    v_mfma_f32_16x16x32_bf16 v[56:59], v[200:203], v[220:223], v[56:59]
    v_mfma_f32_16x16x32_bf16 v[60:63], v[204:207], v[220:223], v[60:63]
    s_waitcnt lgkmcnt(0)
    s_barrier
    ds_read_b128 v[200:203], v12 offset:16384
    ds_read_b128 v[204:207], v12 offset:18688
    ds_read_b128 v[208:211], v14 offset:16384
    ds_read_b128 v[212:215], v14 offset:18688
    ds_read_b128 v[216:219], v14 offset:20992
    ds_read_b128 v[220:223], v14 offset:23296
    ds_read_b128 v[16:19], v10 offset:2304
    ds_read_b128 v[20:23], v10 offset:2320
    ds_read_b128 v[24:27], v10 offset:10496
    ds_read_b128 v[28:31], v10 offset:10512
    buffer_load_dwordx4 v[96:99], v3, s[28:31], s44 offen
    buffer_load_dwordx4 v[100:103], v4, s[28:31], s44 offen
    buffer_load_dwordx4 v[104:107], v5, s[16:19], s45 offen
    buffer_load_dwordx4 v[108:111], v6, s[16:19], s45 offen
    buffer_load_dwordx4 v[112:115], v7, s[16:19], s45 offen
    buffer_load_dwordx4 v[116:119], v8, s[16:19], s45 offen
    s_add_u32 s44, s44, 128
    s_add_u32 s45, s45, 128
    v_mfma_f32_16x16x32_bf16 v[32:35], v[224:227], v[232:235], v[32:35]
    v_mfma_f32_16x16x32_bf16 v[36:39], v[228:231], v[232:235], v[36:39]
    s_waitcnt vmcnt(18) lgkmcnt(0)
    v_mfma_f32_16x16x32_bf16 v[40:43], v[224:227], v[236:239], v[40:43]
    v_lshlrev_b32 v11, 16, v120
    v_and_b32 v15, 0xffff0000, v120
    v_fma_f32 v11, v11, v16, v24
    v_fma_f32 v15, v15, v17, v25
    v_cvt_pk_bf16_f32 v120, v11, v15
    v_lshlrev_b32 v11, 16, v121
    v_and_b32 v15, 0xffff0000, v121
    v_mfma_f32_16x16x32_bf16 v[44:47], v[228:231], v[236:239], v[44:47]
    v_fma_f32 v11, v11, v18, v26
    v_fma_f32 v15, v15, v19, v27
    v_cvt_pk_bf16_f32 v121, v11, v15
    v_lshlrev_b32 v11, 16, v122
    v_and_b32 v15, 0xffff0000, v122
    v_fma_f32 v11, v11, v20, v28
    v_fma_f32 v15, v15, v21, v29
    v_mfma_f32_16x16x32_bf16 v[48:51], v[224:227], v[240:243], v[48:51]
    v_cvt_pk_bf16_f32 v122, v11, v15
    v_lshlrev_b32 v11, 16, v123
    v_and_b32 v15, 0xffff0000, v123
    v_fma_f32 v11, v11, v22, v30
    v_fma_f32 v15, v15, v23, v31
    v_cvt_pk_bf16_f32 v123, v11, v15
    v_lshlrev_b32 v11, 16, v124
    v_mfma_f32_16x16x32_bf16 v[52:55], v[228:231], v[240:243], v[52:55]
    v_and_b32 v15, 0xffff0000, v124
    v_fma_f32 v11, v11, v16, v24
    v_fma_f32 v15, v15, v17, v25
    v_cvt_pk_bf16_f32 v124, v11, v15
    v_lshlrev_b32 v11, 16, v125
    v_and_b32 v15, 0xffff0000, v125
    v_fma_f32 v11, v11, v18, v26
    v_mfma_f32_16x16x32_bf16 v[56:59], v[224:227], v[244:247], v[56:59]
    v_fma_f32 v15, v15, v19, v27
    v_cvt_pk_bf16_f32 v125, v11, v15
    v_lshlrev_b32 v11, 16, v126
    v_and_b32 v15, 0xffff0000, v126
    v_fma_f32 v11, v11, v20, v28
    v_fma_f32 v15, v15, v21, v29
    v_cvt_pk_bf16_f32 v126, v11, v15
    v_mfma_f32_16x16x32_bf16 v[60:63], v[228:231], v[244:247], v[60:63]
    v_lshlrev_b32 v11, 16, v127
    v_and_b32 v15, 0xffff0000, v127
    v_fma_f32 v11, v11, v22, v30
    v_fma_f32 v15, v15, v23, v31
    v_cvt_pk_bf16_f32 v127, v11, v15
    ds_write_b128 v9, v[120:123] offset:44032
    ds_write_b128 v9, v[124:127] offset:48640
    ds_write_b128 v9, v[128:131] offset:53248
    ds_write_b128 v9, v[132:135] offset:57856
    ds_write_b128 v9, v[136:139] offset:62464
    ds_write_b128 v64, v[140:143] offset:34304
    ds_read_b128 v[224:227], v12 offset:16448
    ds_read_b128 v[228:231], v12 offset:18752
    ds_read_b128 v[232:235], v14 offset:16448
    ds_read_b128 v[236:239], v14 offset:18752
    ds_read_b128 v[240:243], v14 offset:21056
    ds_read_b128 v[244:247], v14 offset:23360
    s_waitcnt lgkmcnt(12)
    v_mfma_f32_16x16x32_bf16 v[32:35], v[200:203], v[208:211], v[32:35]
    v_mfma_f32_16x16x32_bf16 v[36:39], v[204:207], v[208:211], v[36:39]
    v_mfma_f32_16x16x32_bf16 v[40:43], v[200:203], v[212:215], v[40:43]
    v_mfma_f32_16x16x32_bf16 v[44:47], v[204:207], v[212:215], v[44:47]
    v_mfma_f32_16x16x32_bf16 v[48:51], v[200:203], v[216:219], v[48:51]
    v_mfma_f32_16x16x32_bf16 v[52:55], v[204:207], v[216:219], v[52:55]
    v_mfma_f32_16x16x32_bf16 v[56:59], v[200:203], v[220:223], v[56:59]
    v_mfma_f32_16x16x32_bf16 v[60:63], v[204:207], v[220:223], v[60:63]
    s_waitcnt lgkmcnt(0)
    s_barrier
    ds_read_b128 v[200:203], v12 offset:44032
    ds_read_b128 v[204:207], v12 offset:46336
    ds_read_b128 v[208:211], v14 offset:44032
    ds_read_b128 v[212:215], v14 offset:46336
    ds_read_b128 v[216:219], v14 offset:48640
    ds_read_b128 v[220:223], v14 offset:50944
    ds_read_b128 v[16:19], v10 offset:2560
    ds_read_b128 v[20:23], v10 offset:2576
    ds_read_b128 v[24:27], v10 offset:10752
    ds_read_b128 v[28:31], v10 offset:10768
    buffer_load_dwordx4 v[120:123], v3, s[28:31], s44 offen
    buffer_load_dwordx4 v[124:127], v4, s[28:31], s44 offen
    buffer_load_dwordx4 v[128:131], v5, s[16:19], s45 offen
    buffer_load_dwordx4 v[132:135], v6, s[16:19], s45 offen
    buffer_load_dwordx4 v[136:139], v7, s[16:19], s45 offen
    buffer_load_dwordx4 v[140:143], v8, s[16:19], s45 offen
    s_add_u32 s44, s44, 128
    s_add_u32 s45, s45, 128
    v_mfma_f32_16x16x32_bf16 v[32:35], v[224:227], v[232:235], v[32:35]
    v_mfma_f32_16x16x32_bf16 v[36:39], v[228:231], v[232:235], v[36:39]
    s_waitcnt vmcnt(18) lgkmcnt(0)
    v_mfma_f32_16x16x32_bf16 v[40:43], v[224:227], v[236:239], v[40:43]
    v_lshlrev_b32 v11, 16, v144
    v_and_b32 v15, 0xffff0000, v144
    v_fma_f32 v11, v11, v16, v24
    v_fma_f32 v15, v15, v17, v25
    v_cvt_pk_bf16_f32 v144, v11, v15
    v_lshlrev_b32 v11, 16, v145
    v_and_b32 v15, 0xffff0000, v145
    v_mfma_f32_16x16x32_bf16 v[44:47], v[228:231], v[236:239], v[44:47]
    v_fma_f32 v11, v11, v18, v26
    v_fma_f32 v15, v15, v19, v27
    v_cvt_pk_bf16_f32 v145, v11, v15
    v_lshlrev_b32 v11, 16, v146
    v_and_b32 v15, 0xffff0000, v146
    v_fma_f32 v11, v11, v20, v28
    v_fma_f32 v15, v15, v21, v29
    v_mfma_f32_16x16x32_bf16 v[48:51], v[224:227], v[240:243], v[48:51]
    v_cvt_pk_bf16_f32 v146, v11, v15
    v_lshlrev_b32 v11, 16, v147
    v_and_b32 v15, 0xffff0000, v147
    v_fma_f32 v11, v11, v22, v30
    v_fma_f32 v15, v15, v23, v31
    v_cvt_pk_bf16_f32 v147, v11, v15
    v_lshlrev_b32 v11, 16, v148
    v_mfma_f32_16x16x32_bf16 v[52:55], v[228:231], v[240:243], v[52:55]
    v_and_b32 v15, 0xffff0000, v148
    v_fma_f32 v11, v11, v16, v24
    v_fma_f32 v15, v15, v17, v25
    v_cvt_pk_bf16_f32 v148, v11, v15
    v_lshlrev_b32 v11, 16, v149
    v_and_b32 v15, 0xffff0000, v149
    v_fma_f32 v11, v11, v18, v26
    v_mfma_f32_16x16x32_bf16 v[56:59], v[224:227], v[244:247], v[56:59]
    v_fma_f32 v15, v15, v19, v27
    v_cvt_pk_bf16_f32 v149, v11, v15
    v_lshlrev_b32 v11, 16, v150
    v_and_b32 v15, 0xffff0000, v150
    v_fma_f32 v11, v11, v20, v28
    v_fma_f32 v15, v15, v21, v29
    v_cvt_pk_bf16_f32 v150, v11, v15
    v_mfma_f32_16x16x32_bf16 v[60:63], v[228:231], v[244:247], v[60:63]
    v_lshlrev_b32 v11, 16, v151
    v_and_b32 v15, 0xffff0000, v151
    v_fma_f32 v11, v11, v22, v30
    v_fma_f32 v15, v15, v23, v31
    v_cvt_pk_bf16_f32 v151, v11, v15
    ds_write_b128 v9, v[144:147] offset:16384
    ds_write_b128 v9, v[148:151] offset:20992
    ds_write_b128 v9, v[152:155] offset:25600
    ds_write_b128 v9, v[156:159] offset:30208
    ds_write_b128 v9, v[160:163] offset:34816
    ds_write_b128 v9, v[164:167] offset:39424
    ds_read_b128 v[224:227], v12 offset:44096
    ds_read_b128 v[228:231], v12 offset:46400
    ds_read_b128 v[232:235], v14 offset:44096
    ds_read_b128 v[236:239], v14 offset:46400
    ds_read_b128 v[240:243], v14 offset:48704
    ds_read_b128 v[244:247], v14 offset:51008
    s_waitcnt lgkmcnt(12)
    v_mfma_f32_16x16x32_bf16 v[32:35], v[200:203], v[208:211], v[32:35]
    v_mfma_f32_16x16x32_bf16 v[36:39], v[204:207], v[208:211], v[36:39]
    v_mfma_f32_16x16x32_bf16 v[40:43], v[200:203], v[212:215], v[40:43]
    v_mfma_f32_16x16x32_bf16 v[44:47], v[204:207], v[212:215], v[44:47]
    v_mfma_f32_16x16x32_bf16 v[48:51], v[200:203], v[216:219], v[48:51]
    v_mfma_f32_16x16x32_bf16 v[52:55], v[204:207], v[216:219], v[52:55]
    v_mfma_f32_16x16x32_bf16 v[56:59], v[200:203], v[220:223], v[56:59]
    v_mfma_f32_16x16x32_bf16 v[60:63], v[204:207], v[220:223], v[60:63]
    s_waitcnt lgkmcnt(0)
    s_barrier
    ds_read_b128 v[200:203], v12 offset:16384
    ds_read_b128 v[204:207], v12 offset:18688
    ds_read_b128 v[208:211], v14 offset:16384
    ds_read_b128 v[212:215], v14 offset:18688
    ds_read_b128 v[216:219], v14 offset:20992
    ds_read_b128 v[220:223], v14 offset:23296
    ds_read_b128 v[16:19], v10 offset:2816
    ds_read_b128 v[20:23], v10 offset:2832
    ds_read_b128 v[24:27], v10 offset:11008
    ds_read_b128 v[28:31], v10 offset:11024
    buffer_load_dwordx4 v[144:147], v3, s[28:31], s44 offen
    buffer_load_dwordx4 v[148:151], v4, s[28:31], s44 offen
    buffer_load_dwordx4 v[152:155], v5, s[16:19], s45 offen
    buffer_load_dwordx4 v[156:159], v6, s[16:19], s45 offen
    buffer_load_dwordx4 v[160:163], v7, s[16:19], s45 offen
    buffer_load_dwordx4 v[164:167], v8, s[16:19], s45 offen
    s_add_u32 s44, s44, 128
    s_add_u32 s45, s45, 128
    v_mfma_f32_16x16x32_bf16 v[32:35], v[224:227], v[232:235], v[32:35]
    v_mfma_f32_16x16x32_bf16 v[36:39], v[228:231], v[232:235], v[36:39]
    s_waitcnt vmcnt(18) lgkmcnt(0)
    v_mfma_f32_16x16x32_bf16 v[40:43], v[224:227], v[236:239], v[40:43]
    v_lshlrev_b32 v11, 16, v168
    v_and_b32 v15, 0xffff0000, v168
    v_fma_f32 v11, v11, v16, v24
    v_fma_f32 v15, v15, v17, v25
    v_cvt_pk_bf16_f32 v168, v11, v15
    v_lshlrev_b32 v11, 16, v169
    v_and_b32 v15, 0xffff0000, v169
    v_mfma_f32_16x16x32_bf16 v[44:47], v[228:231], v[236:239], v[44:47]
    v_fma_f32 v11, v11, v18, v26
    v_fma_f32 v15, v15, v19, v27
    v_cvt_pk_bf16_f32 v169, v11, v15
    v_lshlrev_b32 v11, 16, v170
    v_and_b32 v15, 0xffff0000, v170
    v_fma_f32 v11, v11, v20, v28
    v_fma_f32 v15, v15, v21, v29
    v_mfma_f32_16x16x32_bf16 v[48:51], v[224:227], v[240:243], v[48:51]
    v_cvt_pk_bf16_f32 v170, v11, v15
    v_lshlrev_b32 v11, 16, v171
    v_and_b32 v15, 0xffff0000, v171
    v_fma_f32 v11, v11, v22, v30
    v_fma_f32 v15, v15, v23, v31
    v_cvt_pk_bf16_f32 v171, v11, v15
    v_lshlrev_b32 v11, 16, v172
    v_mfma_f32_16x16x32_bf16 v[52:55], v[228:231], v[240:243], v[52:55]
    v_and_b32 v15, 0xffff0000, v172
    v_fma_f32 v11, v11, v16, v24
    v_fma_f32 v15, v15, v17, v25
    v_cvt_pk_bf16_f32 v172, v11, v15
    v_lshlrev_b32 v11, 16, v173
    v_and_b32 v15, 0xffff0000, v173
    v_fma_f32 v11, v11, v18, v26
    v_mfma_f32_16x16x32_bf16 v[56:59], v[224:227], v[244:247], v[56:59]
    v_fma_f32 v15, v15, v19, v27
    v_cvt_pk_bf16_f32 v173, v11, v15
    v_lshlrev_b32 v11, 16, v174
    v_and_b32 v15, 0xffff0000, v174
    v_fma_f32 v11, v11, v20, v28
    v_fma_f32 v15, v15, v21, v29
    v_cvt_pk_bf16_f32 v174, v11, v15
    v_mfma_f32_16x16x32_bf16 v[60:63], v[228:231], v[244:247], v[60:63]
    v_lshlrev_b32 v11, 16, v175
    v_and_b32 v15, 0xffff0000, v175
    v_fma_f32 v11, v11, v22, v30
    v_fma_f32 v15, v15, v23, v31
    v_cvt_pk_bf16_f32 v175, v11, v15
    ds_write_b128 v9, v[168:171] offset:44032
    ds_write_b128 v9, v[172:175] offset:48640
    ds_write_b128 v9, v[176:179] offset:53248
    ds_write_b128 v9, v[180:183] offset:57856
    ds_write_b128 v9, v[184:187] offset:62464
    ds_write_b128 v64, v[188:191] offset:34304
    ds_read_b128 v[224:227], v12 offset:16448
    ds_read_b128 v[228:231], v12 offset:18752
    ds_read_b128 v[232:235], v14 offset:16448
    ds_read_b128 v[236:239], v14 offset:18752
    ds_read_b128 v[240:243], v14 offset:21056
    ds_read_b128 v[244:247], v14 offset:23360
    s_waitcnt lgkmcnt(12)
    v_mfma_f32_16x16x32_bf16 v[32:35], v[200:203], v[208:211], v[32:35]
    v_mfma_f32_16x16x32_bf16 v[36:39], v[204:207], v[208:211], v[36:39]
    v_mfma_f32_16x16x32_bf16 v[40:43], v[200:203], v[212:215], v[40:43]
    v_mfma_f32_16x16x32_bf16 v[44:47], v[204:207], v[212:215], v[44:47]
    v_mfma_f32_16x16x32_bf16 v[48:51], v[200:203], v[216:219], v[48:51]
    v_mfma_f32_16x16x32_bf16 v[52:55], v[204:207], v[216:219], v[52:55]
    v_mfma_f32_16x16x32_bf16 v[56:59], v[200:203], v[220:223], v[56:59]
    v_mfma_f32_16x16x32_bf16 v[60:63], v[204:207], v[220:223], v[60:63]
    s_waitcnt lgkmcnt(0)
    s_barrier
    ds_read_b128 v[200:203], v12 offset:44032
    ds_read_b128 v[204:207], v12 offset:46336
    ds_read_b128 v[208:211], v14 offset:44032
    ds_read_b128 v[212:215], v14 offset:46336
    ds_read_b128 v[216:219], v14 offset:48640
    ds_read_b128 v[220:223], v14 offset:50944
    ds_read_b128 v[16:19], v10 offset:3072
    ds_read_b128 v[20:23], v10 offset:3088
    ds_read_b128 v[24:27], v10 offset:11264
    ds_read_b128 v[28:31], v10 offset:11280
    buffer_load_dwordx4 v[168:171], v3, s[28:31], s44 offen
    buffer_load_dwordx4 v[172:175], v4, s[28:31], s44 offen
    buffer_load_dwordx4 v[176:179], v5, s[16:19], s45 offen
    buffer_load_dwordx4 v[180:183], v6, s[16:19], s45 offen
    buffer_load_dwordx4 v[184:187], v7, s[16:19], s45 offen
    buffer_load_dwordx4 v[188:191], v8, s[16:19], s45 offen
    s_add_u32 s44, s44, 128
    s_add_u32 s45, s45, 128
    v_mfma_f32_16x16x32_bf16 v[32:35], v[224:227], v[232:235], v[32:35]
    v_mfma_f32_16x16x32_bf16 v[36:39], v[228:231], v[232:235], v[36:39]
    s_waitcnt vmcnt(18) lgkmcnt(0)
    v_mfma_f32_16x16x32_bf16 v[40:43], v[224:227], v[236:239], v[40:43]
    v_lshlrev_b32 v11, 16, v96
    v_and_b32 v15, 0xffff0000, v96
    v_fma_f32 v11, v11, v16, v24
    v_fma_f32 v15, v15, v17, v25
    v_cvt_pk_bf16_f32 v96, v11, v15
    v_lshlrev_b32 v11, 16, v97
    v_and_b32 v15, 0xffff0000, v97
    v_mfma_f32_16x16x32_bf16 v[44:47], v[228:231], v[236:239], v[44:47]
    v_fma_f32 v11, v11, v18, v26
    v_fma_f32 v15, v15, v19, v27
    v_cvt_pk_bf16_f32 v97, v11, v15
    v_lshlrev_b32 v11, 16, v98
    v_and_b32 v15, 0xffff0000, v98
    v_fma_f32 v11, v11, v20, v28
    v_fma_f32 v15, v15, v21, v29
    v_mfma_f32_16x16x32_bf16 v[48:51], v[224:227], v[240:243], v[48:51]
    v_cvt_pk_bf16_f32 v98, v11, v15
    v_lshlrev_b32 v11, 16, v99
    v_and_b32 v15, 0xffff0000, v99
    v_fma_f32 v11, v11, v22, v30
    v_fma_f32 v15, v15, v23, v31
    v_cvt_pk_bf16_f32 v99, v11, v15
    v_lshlrev_b32 v11, 16, v100
    v_mfma_f32_16x16x32_bf16 v[52:55], v[228:231], v[240:243], v[52:55]
    v_and_b32 v15, 0xffff0000, v100
    v_fma_f32 v11, v11, v16, v24
    v_fma_f32 v15, v15, v17, v25
    v_cvt_pk_bf16_f32 v100, v11, v15
    v_lshlrev_b32 v11, 16, v101
    v_and_b32 v15, 0xffff0000, v101
    v_fma_f32 v11, v11, v18, v26
    v_mfma_f32_16x16x32_bf16 v[56:59], v[224:227], v[244:247], v[56:59]
    v_fma_f32 v15, v15, v19, v27
    v_cvt_pk_bf16_f32 v101, v11, v15
    v_lshlrev_b32 v11, 16, v102
    v_and_b32 v15, 0xffff0000, v102
    v_fma_f32 v11, v11, v20, v28
    v_fma_f32 v15, v15, v21, v29
    v_cvt_pk_bf16_f32 v102, v11, v15
    v_mfma_f32_16x16x32_bf16 v[60:63], v[228:231], v[244:247], v[60:63]
    v_lshlrev_b32 v11, 16, v103
    v_and_b32 v15, 0xffff0000, v103
    v_fma_f32 v11, v11, v22, v30
    v_fma_f32 v15, v15, v23, v31
    v_cvt_pk_bf16_f32 v103, v11, v15
    ds_write_b128 v9, v[96:99] offset:16384
    ds_write_b128 v9, v[100:103] offset:20992
    ds_write_b128 v9, v[104:107] offset:25600
    ds_write_b128 v9, v[108:111] offset:30208
    ds_write_b128 v9, v[112:115] offset:34816
    ds_write_b128 v9, v[116:119] offset:39424
    ds_read_b128 v[224:227], v12 offset:44096
    ds_read_b128 v[228:231], v12 offset:46400
    ds_read_b128 v[232:235], v14 offset:44096
    ds_read_b128 v[236:239], v14 offset:46400
    ds_read_b128 v[240:243], v14 offset:48704
    ds_read_b128 v[244:247], v14 offset:51008
    s_waitcnt lgkmcnt(12)
    v_mfma_f32_16x16x32_bf16 v[32:35], v[200:203], v[208:211], v[32:35]
    v_mfma_f32_16x16x32_bf16 v[36:39], v[204:207], v[208:211], v[36:39]
    v_mfma_f32_16x16x32_bf16 v[40:43], v[200:203], v[212:215], v[40:43]
    v_mfma_f32_16x16x32_bf16 v[44:47], v[204:207], v[212:215], v[44:47]
    v_mfma_f32_16x16x32_bf16 v[48:51], v[200:203], v[216:219], v[48:51]
    v_mfma_f32_16x16x32_bf16 v[52:55], v[204:207], v[216:219], v[52:55]
    v_mfma_f32_16x16x32_bf16 v[56:59], v[200:203], v[220:223], v[56:59]
    v_mfma_f32_16x16x32_bf16 v[60:63], v[204:207], v[220:223], v[60:63]
    s_waitcnt lgkmcnt(0)
    s_barrier
    ds_read_b128 v[200:203], v12 offset:16384
    ds_read_b128 v[204:207], v12 offset:18688
    ds_read_b128 v[208:211], v14 offset:16384
    ds_read_b128 v[212:215], v14 offset:18688
    ds_read_b128 v[216:219], v14 offset:20992
    ds_read_b128 v[220:223], v14 offset:23296
    ds_read_b128 v[16:19], v10 offset:3328
    ds_read_b128 v[20:23], v10 offset:3344
    ds_read_b128 v[24:27], v10 offset:11520
    ds_read_b128 v[28:31], v10 offset:11536
    buffer_load_dwordx4 v[96:99], v3, s[28:31], s44 offen
    buffer_load_dwordx4 v[100:103], v4, s[28:31], s44 offen
    buffer_load_dwordx4 v[104:107], v5, s[16:19], s45 offen
    buffer_load_dwordx4 v[108:111], v6, s[16:19], s45 offen
    buffer_load_dwordx4 v[112:115], v7, s[16:19], s45 offen
    buffer_load_dwordx4 v[116:119], v8, s[16:19], s45 offen
    s_add_u32 s44, s44, 128
    s_add_u32 s45, s45, 128
    v_mfma_f32_16x16x32_bf16 v[32:35], v[224:227], v[232:235], v[32:35]
    v_mfma_f32_16x16x32_bf16 v[36:39], v[228:231], v[232:235], v[36:39]
    s_waitcnt vmcnt(18) lgkmcnt(0)
    v_mfma_f32_16x16x32_bf16 v[40:43], v[224:227], v[236:239], v[40:43]
    v_lshlrev_b32 v11, 16, v120
    v_and_b32 v15, 0xffff0000, v120
    v_fma_f32 v11, v11, v16, v24
    v_fma_f32 v15, v15, v17, v25
    v_cvt_pk_bf16_f32 v120, v11, v15
    v_lshlrev_b32 v11, 16, v121
    v_and_b32 v15, 0xffff0000, v121
    v_mfma_f32_16x16x32_bf16 v[44:47], v[228:231], v[236:239], v[44:47]
    v_fma_f32 v11, v11, v18, v26
    v_fma_f32 v15, v15, v19, v27
    v_cvt_pk_bf16_f32 v121, v11, v15
    v_lshlrev_b32 v11, 16, v122
    v_and_b32 v15, 0xffff0000, v122
    v_fma_f32 v11, v11, v20, v28
    v_fma_f32 v15, v15, v21, v29
    v_mfma_f32_16x16x32_bf16 v[48:51], v[224:227], v[240:243], v[48:51]
    v_cvt_pk_bf16_f32 v122, v11, v15
    v_lshlrev_b32 v11, 16, v123
    v_and_b32 v15, 0xffff0000, v123
    v_fma_f32 v11, v11, v22, v30
    v_fma_f32 v15, v15, v23, v31
    v_cvt_pk_bf16_f32 v123, v11, v15
    v_lshlrev_b32 v11, 16, v124
    v_mfma_f32_16x16x32_bf16 v[52:55], v[228:231], v[240:243], v[52:55]
    v_and_b32 v15, 0xffff0000, v124
    v_fma_f32 v11, v11, v16, v24
    v_fma_f32 v15, v15, v17, v25
    v_cvt_pk_bf16_f32 v124, v11, v15
    v_lshlrev_b32 v11, 16, v125
    v_and_b32 v15, 0xffff0000, v125
    v_fma_f32 v11, v11, v18, v26
    v_mfma_f32_16x16x32_bf16 v[56:59], v[224:227], v[244:247], v[56:59]
    v_fma_f32 v15, v15, v19, v27
    v_cvt_pk_bf16_f32 v125, v11, v15
    v_lshlrev_b32 v11, 16, v126
    v_and_b32 v15, 0xffff0000, v126
    v_fma_f32 v11, v11, v20, v28
    v_fma_f32 v15, v15, v21, v29
    v_cvt_pk_bf16_f32 v126, v11, v15
    v_mfma_f32_16x16x32_bf16 v[60:63], v[228:231], v[244:247], v[60:63]
    v_lshlrev_b32 v11, 16, v127
    v_and_b32 v15, 0xffff0000, v127
    v_fma_f32 v11, v11, v22, v30
    v_fma_f32 v15, v15, v23, v31
    v_cvt_pk_bf16_f32 v127, v11, v15
    ds_write_b128 v9, v[120:123] offset:44032
    ds_write_b128 v9, v[124:127] offset:48640
    ds_write_b128 v9, v[128:131] offset:53248
    ds_write_b128 v9, v[132:135] offset:57856
    ds_write_b128 v9, v[136:139] offset:62464
    ds_write_b128 v64, v[140:143] offset:34304
    ds_read_b128 v[224:227], v12 offset:16448
    ds_read_b128 v[228:231], v12 offset:18752
    ds_read_b128 v[232:235], v14 offset:16448
    ds_read_b128 v[236:239], v14 offset:18752
    ds_read_b128 v[240:243], v14 offset:21056
    ds_read_b128 v[244:247], v14 offset:23360
    s_waitcnt lgkmcnt(12)
    v_mfma_f32_16x16x32_bf16 v[32:35], v[200:203], v[208:211], v[32:35]
    v_mfma_f32_16x16x32_bf16 v[36:39], v[204:207], v[208:211], v[36:39]
    v_mfma_f32_16x16x32_bf16 v[40:43], v[200:203], v[212:215], v[40:43]
    v_mfma_f32_16x16x32_bf16 v[44:47], v[204:207], v[212:215], v[44:47]
    v_mfma_f32_16x16x32_bf16 v[48:51], v[200:203], v[216:219], v[48:51]
    v_mfma_f32_16x16x32_bf16 v[52:55], v[204:207], v[216:219], v[52:55]
    v_mfma_f32_16x16x32_bf16 v[56:59], v[200:203], v[220:223], v[56:59]
    v_mfma_f32_16x16x32_bf16 v[60:63], v[204:207], v[220:223], v[60:63]
    s_waitcnt lgkmcnt(0)
    s_barrier
    ds_read_b128 v[200:203], v12 offset:44032
    ds_read_b128 v[204:207], v12 offset:46336
    ds_read_b128 v[208:211], v14 offset:44032
    ds_read_b128 v[212:215], v14 offset:46336
    ds_read_b128 v[216:219], v14 offset:48640
    ds_read_b128 v[220:223], v14 offset:50944
    ds_read_b128 v[16:19], v10 offset:3584
    ds_read_b128 v[20:23], v10 offset:3600
    ds_read_b128 v[24:27], v10 offset:11776
    ds_read_b128 v[28:31], v10 offset:11792
    buffer_load_dwordx4 v[120:123], v3, s[28:31], s44 offen
    buffer_load_dwordx4 v[124:127], v4, s[28:31], s44 offen
    buffer_load_dwordx4 v[128:131], v5, s[16:19], s45 offen
    buffer_load_dwordx4 v[132:135], v6, s[16:19], s45 offen
    buffer_load_dwordx4 v[136:139], v7, s[16:19], s45 offen
    buffer_load_dwordx4 v[140:143], v8, s[16:19], s45 offen
    s_add_u32 s44, s44, 128
    s_add_u32 s45, s45, 128
    v_mfma_f32_16x16x32_bf16 v[32:35], v[224:227], v[232:235], v[32:35]
    v_mfma_f32_16x16x32_bf16 v[36:39], v[228:231], v[232:235], v[36:39]
    s_waitcnt vmcnt(18) lgkmcnt(0)
    v_mfma_f32_16x16x32_bf16 v[40:43], v[224:227], v[236:239], v[40:43]
    v_lshlrev_b32 v11, 16, v144
    v_and_b32 v15, 0xffff0000, v144
    v_fma_f32 v11, v11, v16, v24
    v_fma_f32 v15, v15, v17, v25
    v_cvt_pk_bf16_f32 v144, v11, v15
    v_lshlrev_b32 v11, 16, v145
    v_and_b32 v15, 0xffff0000, v145
    v_mfma_f32_16x16x32_bf16 v[44:47], v[228:231], v[236:239], v[44:47]
    v_fma_f32 v11, v11, v18, v26
    v_fma_f32 v15, v15, v19, v27
    v_cvt_pk_bf16_f32 v145, v11, v15
    v_lshlrev_b32 v11, 16, v146
    v_and_b32 v15, 0xffff0000, v146
    v_fma_f32 v11, v11, v20, v28
    v_fma_f32 v15, v15, v21, v29
    v_mfma_f32_16x16x32_bf16 v[48:51], v[224:227], v[240:243], v[48:51]
    v_cvt_pk_bf16_f32 v146, v11, v15
    v_lshlrev_b32 v11, 16, v147
    v_and_b32 v15, 0xffff0000, v147
    v_fma_f32 v11, v11, v22, v30
    v_fma_f32 v15, v15, v23, v31
    v_cvt_pk_bf16_f32 v147, v11, v15
    v_lshlrev_b32 v11, 16, v148
    v_mfma_f32_16x16x32_bf16 v[52:55], v[228:231], v[240:243], v[52:55]
    v_and_b32 v15, 0xffff0000, v148
    v_fma_f32 v11, v11, v16, v24
    v_fma_f32 v15, v15, v17, v25
    v_cvt_pk_bf16_f32 v148, v11, v15
    v_lshlrev_b32 v11, 16, v149
    v_and_b32 v15, 0xffff0000, v149
    v_fma_f32 v11, v11, v18, v26
    v_mfma_f32_16x16x32_bf16 v[56:59], v[224:227], v[244:247], v[56:59]
    v_fma_f32 v15, v15, v19, v27
    v_cvt_pk_bf16_f32 v149, v11, v15
    v_lshlrev_b32 v11, 16, v150
    v_and_b32 v15, 0xffff0000, v150
    v_fma_f32 v11, v11, v20, v28
    v_fma_f32 v15, v15, v21, v29
    v_cvt_pk_bf16_f32 v150, v11, v15
    v_mfma_f32_16x16x32_bf16 v[60:63], v[228:231], v[244:247], v[60:63]
    v_lshlrev_b32 v11, 16, v151
    v_and_b32 v15, 0xffff0000, v151
    v_fma_f32 v11, v11, v22, v30
    v_fma_f32 v15, v15, v23, v31
    v_cvt_pk_bf16_f32 v151, v11, v15
    ds_write_b128 v9, v[144:147] offset:16384
    ds_write_b128 v9, v[148:151] offset:20992
    ds_write_b128 v9, v[152:155] offset:25600
    ds_write_b128 v9, v[156:159] offset:30208
    ds_write_b128 v9, v[160:163] offset:34816
    ds_write_b128 v9, v[164:167] offset:39424
    ds_read_b128 v[224:227], v12 offset:44096
    ds_read_b128 v[228:231], v12 offset:46400
    ds_read_b128 v[232:235], v14 offset:44096
    ds_read_b128 v[236:239], v14 offset:46400
    ds_read_b128 v[240:243], v14 offset:48704
    ds_read_b128 v[244:247], v14 offset:51008
    s_waitcnt lgkmcnt(12)
    v_mfma_f32_16x16x32_bf16 v[32:35], v[200:203], v[208:211], v[32:35]
    v_mfma_f32_16x16x32_bf16 v[36:39], v[204:207], v[208:211], v[36:39]
    v_mfma_f32_16x16x32_bf16 v[40:43], v[200:203], v[212:215], v[40:43]
    v_mfma_f32_16x16x32_bf16 v[44:47], v[204:207], v[212:215], v[44:47]
    v_mfma_f32_16x16x32_bf16 v[48:51], v[200:203], v[216:219], v[48:51]
    v_mfma_f32_16x16x32_bf16 v[52:55], v[204:207], v[216:219], v[52:55]
    v_mfma_f32_16x16x32_bf16 v[56:59], v[200:203], v[220:223], v[56:59]
    v_mfma_f32_16x16x32_bf16 v[60:63], v[204:207], v[220:223], v[60:63]
    s_waitcnt lgkmcnt(0)
    s_barrier
    ds_read_b128 v[200:203], v12 offset:16384
    ds_read_b128 v[204:207], v12 offset:18688
    ds_read_b128 v[208:211], v14 offset:16384
    ds_read_b128 v[212:215], v14 offset:18688
    ds_read_b128 v[216:219], v14 offset:20992
    ds_read_b128 v[220:223], v14 offset:23296
    ds_read_b128 v[16:19], v10 offset:3840
    ds_read_b128 v[20:23], v10 offset:3856
    ds_read_b128 v[24:27], v10 offset:12032
    ds_read_b128 v[28:31], v10 offset:12048
    buffer_load_dwordx4 v[144:147], v3, s[28:31], s44 offen
    buffer_load_dwordx4 v[148:151], v4, s[28:31], s44 offen
    buffer_load_dwordx4 v[152:155], v5, s[16:19], s45 offen
    buffer_load_dwordx4 v[156:159], v6, s[16:19], s45 offen
    buffer_load_dwordx4 v[160:163], v7, s[16:19], s45 offen
    buffer_load_dwordx4 v[164:167], v8, s[16:19], s45 offen
    s_add_u32 s44, s44, 128
    s_add_u32 s45, s45, 128
    v_mfma_f32_16x16x32_bf16 v[32:35], v[224:227], v[232:235], v[32:35]
    v_mfma_f32_16x16x32_bf16 v[36:39], v[228:231], v[232:235], v[36:39]
    s_waitcnt vmcnt(18) lgkmcnt(0)
    v_mfma_f32_16x16x32_bf16 v[40:43], v[224:227], v[236:239], v[40:43]
    v_lshlrev_b32 v11, 16, v168
    v_and_b32 v15, 0xffff0000, v168
    v_fma_f32 v11, v11, v16, v24
    v_fma_f32 v15, v15, v17, v25
    v_cvt_pk_bf16_f32 v168, v11, v15
    v_lshlrev_b32 v11, 16, v169
    v_and_b32 v15, 0xffff0000, v169
    v_mfma_f32_16x16x32_bf16 v[44:47], v[228:231], v[236:239], v[44:47]
    v_fma_f32 v11, v11, v18, v26
    v_fma_f32 v15, v15, v19, v27
    v_cvt_pk_bf16_f32 v169, v11, v15
    v_lshlrev_b32 v11, 16, v170
    v_and_b32 v15, 0xffff0000, v170
    v_fma_f32 v11, v11, v20, v28
    v_fma_f32 v15, v15, v21, v29
    v_mfma_f32_16x16x32_bf16 v[48:51], v[224:227], v[240:243], v[48:51]
    v_cvt_pk_bf16_f32 v170, v11, v15
    v_lshlrev_b32 v11, 16, v171
    v_and_b32 v15, 0xffff0000, v171
    v_fma_f32 v11, v11, v22, v30
    v_fma_f32 v15, v15, v23, v31
    v_cvt_pk_bf16_f32 v171, v11, v15
    v_lshlrev_b32 v11, 16, v172
    v_mfma_f32_16x16x32_bf16 v[52:55], v[228:231], v[240:243], v[52:55]
    v_and_b32 v15, 0xffff0000, v172
    v_fma_f32 v11, v11, v16, v24
    v_fma_f32 v15, v15, v17, v25
    v_cvt_pk_bf16_f32 v172, v11, v15
    v_lshlrev_b32 v11, 16, v173
    v_and_b32 v15, 0xffff0000, v173
    v_fma_f32 v11, v11, v18, v26
    v_mfma_f32_16x16x32_bf16 v[56:59], v[224:227], v[244:247], v[56:59]
    v_fma_f32 v15, v15, v19, v27
    v_cvt_pk_bf16_f32 v173, v11, v15
    v_lshlrev_b32 v11, 16, v174
    v_and_b32 v15, 0xffff0000, v174
    v_fma_f32 v11, v11, v20, v28
    v_fma_f32 v15, v15, v21, v29
    v_cvt_pk_bf16_f32 v174, v11, v15
    v_mfma_f32_16x16x32_bf16 v[60:63], v[228:231], v[244:247], v[60:63]
    v_lshlrev_b32 v11, 16, v175
    v_and_b32 v15, 0xffff0000, v175
    v_fma_f32 v11, v11, v22, v30
    v_fma_f32 v15, v15, v23, v31
    v_cvt_pk_bf16_f32 v175, v11, v15
    ds_write_b128 v9, v[168:171] offset:44032
    ds_write_b128 v9, v[172:175] offset:48640
    ds_write_b128 v9, v[176:179] offset:53248
    ds_write_b128 v9, v[180:183] offset:57856
    ds_write_b128 v9, v[184:187] offset:62464
    ds_write_b128 v64, v[188:191] offset:34304
    ds_read_b128 v[224:227], v12 offset:16448
    ds_read_b128 v[228:231], v12 offset:18752
    ds_read_b128 v[232:235], v14 offset:16448
    ds_read_b128 v[236:239], v14 offset:18752
    ds_read_b128 v[240:243], v14 offset:21056
    ds_read_b128 v[244:247], v14 offset:23360
    s_waitcnt lgkmcnt(12)
    v_mfma_f32_16x16x32_bf16 v[32:35], v[200:203], v[208:211], v[32:35]
    v_mfma_f32_16x16x32_bf16 v[36:39], v[204:207], v[208:211], v[36:39]
    v_mfma_f32_16x16x32_bf16 v[40:43], v[200:203], v[212:215], v[40:43]
    v_mfma_f32_16x16x32_bf16 v[44:47], v[204:207], v[212:215], v[44:47]
    v_mfma_f32_16x16x32_bf16 v[48:51], v[200:203], v[216:219], v[48:51]
    v_mfma_f32_16x16x32_bf16 v[52:55], v[204:207], v[216:219], v[52:55]
    v_mfma_f32_16x16x32_bf16 v[56:59], v[200:203], v[220:223], v[56:59]
    v_mfma_f32_16x16x32_bf16 v[60:63], v[204:207], v[220:223], v[60:63]
    s_waitcnt lgkmcnt(0)
    s_barrier
    ds_read_b128 v[200:203], v12 offset:44032
    ds_read_b128 v[204:207], v12 offset:46336
    ds_read_b128 v[208:211], v14 offset:44032
    ds_read_b128 v[212:215], v14 offset:46336
    ds_read_b128 v[216:219], v14 offset:48640
    ds_read_b128 v[220:223], v14 offset:50944
    ds_read_b128 v[16:19], v10 offset:4096
    ds_read_b128 v[20:23], v10 offset:4112
    ds_read_b128 v[24:27], v10 offset:12288
    ds_read_b128 v[28:31], v10 offset:12304
    buffer_load_dwordx4 v[168:171], v3, s[28:31], s44 offen
    buffer_load_dwordx4 v[172:175], v4, s[28:31], s44 offen
    buffer_load_dwordx4 v[176:179], v5, s[16:19], s45 offen
    buffer_load_dwordx4 v[180:183], v6, s[16:19], s45 offen
    buffer_load_dwordx4 v[184:187], v7, s[16:19], s45 offen
    buffer_load_dwordx4 v[188:191], v8, s[16:19], s45 offen
    s_add_u32 s44, s44, 128
    s_add_u32 s45, s45, 128
    v_mfma_f32_16x16x32_bf16 v[32:35], v[224:227], v[232:235], v[32:35]
    v_mfma_f32_16x16x32_bf16 v[36:39], v[228:231], v[232:235], v[36:39]
    s_waitcnt vmcnt(18) lgkmcnt(0)
    v_mfma_f32_16x16x32_bf16 v[40:43], v[224:227], v[236:239], v[40:43]
    v_lshlrev_b32 v11, 16, v96
    v_and_b32 v15, 0xffff0000, v96
    v_fma_f32 v11, v11, v16, v24
    v_fma_f32 v15, v15, v17, v25
    v_cvt_pk_bf16_f32 v96, v11, v15
    v_lshlrev_b32 v11, 16, v97
    v_and_b32 v15, 0xffff0000, v97
    v_mfma_f32_16x16x32_bf16 v[44:47], v[228:231], v[236:239], v[44:47]
    v_fma_f32 v11, v11, v18, v26
    v_fma_f32 v15, v15, v19, v27
    v_cvt_pk_bf16_f32 v97, v11, v15
    v_lshlrev_b32 v11, 16, v98
    v_and_b32 v15, 0xffff0000, v98
    v_fma_f32 v11, v11, v20, v28
    v_fma_f32 v15, v15, v21, v29
    v_mfma_f32_16x16x32_bf16 v[48:51], v[224:227], v[240:243], v[48:51]
    v_cvt_pk_bf16_f32 v98, v11, v15
    v_lshlrev_b32 v11, 16, v99
    v_and_b32 v15, 0xffff0000, v99
    v_fma_f32 v11, v11, v22, v30
    v_fma_f32 v15, v15, v23, v31
    v_cvt_pk_bf16_f32 v99, v11, v15
    v_lshlrev_b32 v11, 16, v100
    v_mfma_f32_16x16x32_bf16 v[52:55], v[228:231], v[240:243], v[52:55]
    v_and_b32 v15, 0xffff0000, v100
    v_fma_f32 v11, v11, v16, v24
    v_fma_f32 v15, v15, v17, v25
    v_cvt_pk_bf16_f32 v100, v11, v15
    v_lshlrev_b32 v11, 16, v101
    v_and_b32 v15, 0xffff0000, v101
    v_fma_f32 v11, v11, v18, v26
    v_mfma_f32_16x16x32_bf16 v[56:59], v[224:227], v[244:247], v[56:59]
    v_fma_f32 v15, v15, v19, v27
    v_cvt_pk_bf16_f32 v101, v11, v15
    v_lshlrev_b32 v11, 16, v102
    v_and_b32 v15, 0xffff0000, v102
    v_fma_f32 v11, v11, v20, v28
    v_fma_f32 v15, v15, v21, v29
    v_cvt_pk_bf16_f32 v102, v11, v15
    v_mfma_f32_16x16x32_bf16 v[60:63], v[228:231], v[244:247], v[60:63]
    v_lshlrev_b32 v11, 16, v103
    v_and_b32 v15, 0xffff0000, v103
    v_fma_f32 v11, v11, v22, v30
    v_fma_f32 v15, v15, v23, v31
    v_cvt_pk_bf16_f32 v103, v11, v15
    ds_write_b128 v9, v[96:99] offset:16384
    ds_write_b128 v9, v[100:103] offset:20992
    ds_write_b128 v9, v[104:107] offset:25600
    ds_write_b128 v9, v[108:111] offset:30208
    ds_write_b128 v9, v[112:115] offset:34816
    ds_write_b128 v9, v[116:119] offset:39424
    ds_read_b128 v[224:227], v12 offset:44096
    ds_read_b128 v[228:231], v12 offset:46400
    ds_read_b128 v[232:235], v14 offset:44096
    ds_read_b128 v[236:239], v14 offset:46400
    ds_read_b128 v[240:243], v14 offset:48704
    ds_read_b128 v[244:247], v14 offset:51008
    s_waitcnt lgkmcnt(12)
    v_mfma_f32_16x16x32_bf16 v[32:35], v[200:203], v[208:211], v[32:35]
    v_mfma_f32_16x16x32_bf16 v[36:39], v[204:207], v[208:211], v[36:39]
    v_mfma_f32_16x16x32_bf16 v[40:43], v[200:203], v[212:215], v[40:43]
    v_mfma_f32_16x16x32_bf16 v[44:47], v[204:207], v[212:215], v[44:47]
    v_mfma_f32_16x16x32_bf16 v[48:51], v[200:203], v[216:219], v[48:51]
    v_mfma_f32_16x16x32_bf16 v[52:55], v[204:207], v[216:219], v[52:55]
    v_mfma_f32_16x16x32_bf16 v[56:59], v[200:203], v[220:223], v[56:59]
    v_mfma_f32_16x16x32_bf16 v[60:63], v[204:207], v[220:223], v[60:63]
    s_waitcnt lgkmcnt(0)
    s_barrier
    ds_read_b128 v[200:203], v12 offset:16384
    ds_read_b128 v[204:207], v12 offset:18688
    ds_read_b128 v[208:211], v14 offset:16384
    ds_read_b128 v[212:215], v14 offset:18688
    ds_read_b128 v[216:219], v14 offset:20992
    ds_read_b128 v[220:223], v14 offset:23296
    ds_read_b128 v[16:19], v10 offset:4352
    ds_read_b128 v[20:23], v10 offset:4368
    ds_read_b128 v[24:27], v10 offset:12544
    ds_read_b128 v[28:31], v10 offset:12560
    buffer_load_dwordx4 v[96:99], v3, s[28:31], s44 offen
    buffer_load_dwordx4 v[100:103], v4, s[28:31], s44 offen
    buffer_load_dwordx4 v[104:107], v5, s[16:19], s45 offen
    buffer_load_dwordx4 v[108:111], v6, s[16:19], s45 offen
    buffer_load_dwordx4 v[112:115], v7, s[16:19], s45 offen
    buffer_load_dwordx4 v[116:119], v8, s[16:19], s45 offen
    s_add_u32 s44, s44, 128
    s_add_u32 s45, s45, 128
    v_mfma_f32_16x16x32_bf16 v[32:35], v[224:227], v[232:235], v[32:35]
    v_mfma_f32_16x16x32_bf16 v[36:39], v[228:231], v[232:235], v[36:39]
    s_waitcnt vmcnt(18) lgkmcnt(0)
    v_mfma_f32_16x16x32_bf16 v[40:43], v[224:227], v[236:239], v[40:43]
    v_lshlrev_b32 v11, 16, v120
    v_and_b32 v15, 0xffff0000, v120
    v_fma_f32 v11, v11, v16, v24
    v_fma_f32 v15, v15, v17, v25
    v_cvt_pk_bf16_f32 v120, v11, v15
    v_lshlrev_b32 v11, 16, v121
    v_and_b32 v15, 0xffff0000, v121
    v_mfma_f32_16x16x32_bf16 v[44:47], v[228:231], v[236:239], v[44:47]
    v_fma_f32 v11, v11, v18, v26
    v_fma_f32 v15, v15, v19, v27
    v_cvt_pk_bf16_f32 v121, v11, v15
    v_lshlrev_b32 v11, 16, v122
    v_and_b32 v15, 0xffff0000, v122
    v_fma_f32 v11, v11, v20, v28
    v_fma_f32 v15, v15, v21, v29
    v_mfma_f32_16x16x32_bf16 v[48:51], v[224:227], v[240:243], v[48:51]
    v_cvt_pk_bf16_f32 v122, v11, v15
    v_lshlrev_b32 v11, 16, v123
    v_and_b32 v15, 0xffff0000, v123
    v_fma_f32 v11, v11, v22, v30
    v_fma_f32 v15, v15, v23, v31
    v_cvt_pk_bf16_f32 v123, v11, v15
    v_lshlrev_b32 v11, 16, v124
    v_mfma_f32_16x16x32_bf16 v[52:55], v[228:231], v[240:243], v[52:55]
    v_and_b32 v15, 0xffff0000, v124
    v_fma_f32 v11, v11, v16, v24
    v_fma_f32 v15, v15, v17, v25
    v_cvt_pk_bf16_f32 v124, v11, v15
    v_lshlrev_b32 v11, 16, v125
    v_and_b32 v15, 0xffff0000, v125
    v_fma_f32 v11, v11, v18, v26
    v_mfma_f32_16x16x32_bf16 v[56:59], v[224:227], v[244:247], v[56:59]
    v_fma_f32 v15, v15, v19, v27
    v_cvt_pk_bf16_f32 v125, v11, v15
    v_lshlrev_b32 v11, 16, v126
    v_and_b32 v15, 0xffff0000, v126
    v_fma_f32 v11, v11, v20, v28
    v_fma_f32 v15, v15, v21, v29
    v_cvt_pk_bf16_f32 v126, v11, v15
    v_mfma_f32_16x16x32_bf16 v[60:63], v[228:231], v[244:247], v[60:63]
    v_lshlrev_b32 v11, 16, v127
    v_and_b32 v15, 0xffff0000, v127
    v_fma_f32 v11, v11, v22, v30
    v_fma_f32 v15, v15, v23, v31
    v_cvt_pk_bf16_f32 v127, v11, v15
    ds_write_b128 v9, v[120:123] offset:44032
    ds_write_b128 v9, v[124:127] offset:48640
    ds_write_b128 v9, v[128:131] offset:53248
    ds_write_b128 v9, v[132:135] offset:57856
    ds_write_b128 v9, v[136:139] offset:62464
    ds_write_b128 v64, v[140:143] offset:34304
    ds_read_b128 v[224:227], v12 offset:16448
    ds_read_b128 v[228:231], v12 offset:18752
    ds_read_b128 v[232:235], v14 offset:16448
    ds_read_b128 v[236:239], v14 offset:18752
    ds_read_b128 v[240:243], v14 offset:21056
    ds_read_b128 v[244:247], v14 offset:23360
    s_waitcnt lgkmcnt(12)
    v_mfma_f32_16x16x32_bf16 v[32:35], v[200:203], v[208:211], v[32:35]
    v_mfma_f32_16x16x32_bf16 v[36:39], v[204:207], v[208:211], v[36:39]
    v_mfma_f32_16x16x32_bf16 v[40:43], v[200:203], v[212:215], v[40:43]
    v_mfma_f32_16x16x32_bf16 v[44:47], v[204:207], v[212:215], v[44:47]
    v_mfma_f32_16x16x32_bf16 v[48:51], v[200:203], v[216:219], v[48:51]
    v_mfma_f32_16x16x32_bf16 v[52:55], v[204:207], v[216:219], v[52:55]
    v_mfma_f32_16x16x32_bf16 v[56:59], v[200:203], v[220:223], v[56:59]
    v_mfma_f32_16x16x32_bf16 v[60:63], v[204:207], v[220:223], v[60:63]
    s_waitcnt lgkmcnt(0)
    s_barrier
    ds_read_b128 v[200:203], v12 offset:44032
    ds_read_b128 v[204:207], v12 offset:46336
    ds_read_b128 v[208:211], v14 offset:44032
    ds_read_b128 v[212:215], v14 offset:46336
    ds_read_b128 v[216:219], v14 offset:48640
    ds_read_b128 v[220:223], v14 offset:50944
    ds_read_b128 v[16:19], v10 offset:4608
    ds_read_b128 v[20:23], v10 offset:4624
    ds_read_b128 v[24:27], v10 offset:12800
    ds_read_b128 v[28:31], v10 offset:12816
    buffer_load_dwordx4 v[120:123], v3, s[28:31], s44 offen
    buffer_load_dwordx4 v[124:127], v4, s[28:31], s44 offen
    buffer_load_dwordx4 v[128:131], v5, s[16:19], s45 offen
    buffer_load_dwordx4 v[132:135], v6, s[16:19], s45 offen
    buffer_load_dwordx4 v[136:139], v7, s[16:19], s45 offen
    buffer_load_dwordx4 v[140:143], v8, s[16:19], s45 offen
    s_add_u32 s44, s44, 128
    s_add_u32 s45, s45, 128
    v_mfma_f32_16x16x32_bf16 v[32:35], v[224:227], v[232:235], v[32:35]
    v_mfma_f32_16x16x32_bf16 v[36:39], v[228:231], v[232:235], v[36:39]
    s_waitcnt vmcnt(18) lgkmcnt(0)
    v_mfma_f32_16x16x32_bf16 v[40:43], v[224:227], v[236:239], v[40:43]
    v_lshlrev_b32 v11, 16, v144
    v_and_b32 v15, 0xffff0000, v144
    v_fma_f32 v11, v11, v16, v24
    v_fma_f32 v15, v15, v17, v25
    v_cvt_pk_bf16_f32 v144, v11, v15
    v_lshlrev_b32 v11, 16, v145
    v_and_b32 v15, 0xffff0000, v145
    v_mfma_f32_16x16x32_bf16 v[44:47], v[228:231], v[236:239], v[44:47]
    v_fma_f32 v11, v11, v18, v26
    v_fma_f32 v15, v15, v19, v27
    v_cvt_pk_bf16_f32 v145, v11, v15
    v_lshlrev_b32 v11, 16, v146
    v_and_b32 v15, 0xffff0000, v146
    v_fma_f32 v11, v11, v20, v28
    v_fma_f32 v15, v15, v21, v29
    v_mfma_f32_16x16x32_bf16 v[48:51], v[224:227], v[240:243], v[48:51]
    v_cvt_pk_bf16_f32 v146, v11, v15
    v_lshlrev_b32 v11, 16, v147
    v_and_b32 v15, 0xffff0000, v147
    v_fma_f32 v11, v11, v22, v30
    v_fma_f32 v15, v15, v23, v31
    v_cvt_pk_bf16_f32 v147, v11, v15
    v_lshlrev_b32 v11, 16, v148
    v_mfma_f32_16x16x32_bf16 v[52:55], v[228:231], v[240:243], v[52:55]
    v_and_b32 v15, 0xffff0000, v148
    v_fma_f32 v11, v11, v16, v24
    v_fma_f32 v15, v15, v17, v25
    v_cvt_pk_bf16_f32 v148, v11, v15
    v_lshlrev_b32 v11, 16, v149
    v_and_b32 v15, 0xffff0000, v149
    v_fma_f32 v11, v11, v18, v26
    v_mfma_f32_16x16x32_bf16 v[56:59], v[224:227], v[244:247], v[56:59]
    v_fma_f32 v15, v15, v19, v27
    v_cvt_pk_bf16_f32 v149, v11, v15
    v_lshlrev_b32 v11, 16, v150
    v_and_b32 v15, 0xffff0000, v150
    v_fma_f32 v11, v11, v20, v28
    v_fma_f32 v15, v15, v21, v29
    v_cvt_pk_bf16_f32 v150, v11, v15
    v_mfma_f32_16x16x32_bf16 v[60:63], v[228:231], v[244:247], v[60:63]
    v_lshlrev_b32 v11, 16, v151
    v_and_b32 v15, 0xffff0000, v151
    v_fma_f32 v11, v11, v22, v30
    v_fma_f32 v15, v15, v23, v31
    v_cvt_pk_bf16_f32 v151, v11, v15
    ds_write_b128 v9, v[144:147] offset:16384
    ds_write_b128 v9, v[148:151] offset:20992
    ds_write_b128 v9, v[152:155] offset:25600
    ds_write_b128 v9, v[156:159] offset:30208
    ds_write_b128 v9, v[160:163] offset:34816
    ds_write_b128 v9, v[164:167] offset:39424
    ds_read_b128 v[224:227], v12 offset:44096
    ds_read_b128 v[228:231], v12 offset:46400
    ds_read_b128 v[232:235], v14 offset:44096
    ds_read_b128 v[236:239], v14 offset:46400
    ds_read_b128 v[240:243], v14 offset:48704
    ds_read_b128 v[244:247], v14 offset:51008
    s_waitcnt lgkmcnt(12)
    v_mfma_f32_16x16x32_bf16 v[32:35], v[200:203], v[208:211], v[32:35]
    v_mfma_f32_16x16x32_bf16 v[36:39], v[204:207], v[208:211], v[36:39]
    v_mfma_f32_16x16x32_bf16 v[40:43], v[200:203], v[212:215], v[40:43]
    v_mfma_f32_16x16x32_bf16 v[44:47], v[204:207], v[212:215], v[44:47]
    v_mfma_f32_16x16x32_bf16 v[48:51], v[200:203], v[216:219], v[48:51]
    v_mfma_f32_16x16x32_bf16 v[52:55], v[204:207], v[216:219], v[52:55]
    v_mfma_f32_16x16x32_bf16 v[56:59], v[200:203], v[220:223], v[56:59]
    v_mfma_f32_16x16x32_bf16 v[60:63], v[204:207], v[220:223], v[60:63]
    s_waitcnt lgkmcnt(0)
    s_barrier
    ds_read_b128 v[200:203], v12 offset:16384
    ds_read_b128 v[204:207], v12 offset:18688
    ds_read_b128 v[208:211], v14 offset:16384
    ds_read_b128 v[212:215], v14 offset:18688
    ds_read_b128 v[216:219], v14 offset:20992
    ds_read_b128 v[220:223], v14 offset:23296
    ds_read_b128 v[16:19], v10 offset:4864
    ds_read_b128 v[20:23], v10 offset:4880
    ds_read_b128 v[24:27], v10 offset:13056
    ds_read_b128 v[28:31], v10 offset:13072
    buffer_load_dwordx4 v[144:147], v3, s[28:31], s44 offen
    buffer_load_dwordx4 v[148:151], v4, s[28:31], s44 offen
    buffer_load_dwordx4 v[152:155], v5, s[16:19], s45 offen
    buffer_load_dwordx4 v[156:159], v6, s[16:19], s45 offen
    buffer_load_dwordx4 v[160:163], v7, s[16:19], s45 offen
    buffer_load_dwordx4 v[164:167], v8, s[16:19], s45 offen
    s_add_u32 s44, s44, 128
    s_add_u32 s45, s45, 128
    v_mfma_f32_16x16x32_bf16 v[32:35], v[224:227], v[232:235], v[32:35]
    v_mfma_f32_16x16x32_bf16 v[36:39], v[228:231], v[232:235], v[36:39]
    s_waitcnt vmcnt(18) lgkmcnt(0)
    v_mfma_f32_16x16x32_bf16 v[40:43], v[224:227], v[236:239], v[40:43]
    v_lshlrev_b32 v11, 16, v168
    v_and_b32 v15, 0xffff0000, v168
    v_fma_f32 v11, v11, v16, v24
    v_fma_f32 v15, v15, v17, v25
    v_cvt_pk_bf16_f32 v168, v11, v15
    v_lshlrev_b32 v11, 16, v169
    v_and_b32 v15, 0xffff0000, v169
    v_mfma_f32_16x16x32_bf16 v[44:47], v[228:231], v[236:239], v[44:47]
    v_fma_f32 v11, v11, v18, v26
    v_fma_f32 v15, v15, v19, v27
    v_cvt_pk_bf16_f32 v169, v11, v15
    v_lshlrev_b32 v11, 16, v170
    v_and_b32 v15, 0xffff0000, v170
    v_fma_f32 v11, v11, v20, v28
    v_fma_f32 v15, v15, v21, v29
    v_mfma_f32_16x16x32_bf16 v[48:51], v[224:227], v[240:243], v[48:51]
    v_cvt_pk_bf16_f32 v170, v11, v15
    v_lshlrev_b32 v11, 16, v171
    v_and_b32 v15, 0xffff0000, v171
    v_fma_f32 v11, v11, v22, v30
    v_fma_f32 v15, v15, v23, v31
    v_cvt_pk_bf16_f32 v171, v11, v15
    v_lshlrev_b32 v11, 16, v172
    v_mfma_f32_16x16x32_bf16 v[52:55], v[228:231], v[240:243], v[52:55]
    v_and_b32 v15, 0xffff0000, v172
    v_fma_f32 v11, v11, v16, v24
    v_fma_f32 v15, v15, v17, v25
    v_cvt_pk_bf16_f32 v172, v11, v15
    v_lshlrev_b32 v11, 16, v173
    v_and_b32 v15, 0xffff0000, v173
    v_fma_f32 v11, v11, v18, v26
    v_mfma_f32_16x16x32_bf16 v[56:59], v[224:227], v[244:247], v[56:59]
    v_fma_f32 v15, v15, v19, v27
    v_cvt_pk_bf16_f32 v173, v11, v15
    v_lshlrev_b32 v11, 16, v174
    v_and_b32 v15, 0xffff0000, v174
    v_fma_f32 v11, v11, v20, v28
    v_fma_f32 v15, v15, v21, v29
    v_cvt_pk_bf16_f32 v174, v11, v15
    v_mfma_f32_16x16x32_bf16 v[60:63], v[228:231], v[244:247], v[60:63]
    v_lshlrev_b32 v11, 16, v175
    v_and_b32 v15, 0xffff0000, v175
    v_fma_f32 v11, v11, v22, v30
    v_fma_f32 v15, v15, v23, v31
    v_cvt_pk_bf16_f32 v175, v11, v15
    ds_write_b128 v9, v[168:171] offset:44032
    ds_write_b128 v9, v[172:175] offset:48640
    ds_write_b128 v9, v[176:179] offset:53248
    ds_write_b128 v9, v[180:183] offset:57856
    ds_write_b128 v9, v[184:187] offset:62464
    ds_write_b128 v64, v[188:191] offset:34304
    ds_read_b128 v[224:227], v12 offset:16448
    ds_read_b128 v[228:231], v12 offset:18752
    ds_read_b128 v[232:235], v14 offset:16448
    ds_read_b128 v[236:239], v14 offset:18752
    ds_read_b128 v[240:243], v14 offset:21056
    ds_read_b128 v[244:247], v14 offset:23360
    s_waitcnt lgkmcnt(12)
    v_mfma_f32_16x16x32_bf16 v[32:35], v[200:203], v[208:211], v[32:35]
    v_mfma_f32_16x16x32_bf16 v[36:39], v[204:207], v[208:211], v[36:39]
    v_mfma_f32_16x16x32_bf16 v[40:43], v[200:203], v[212:215], v[40:43]
    v_mfma_f32_16x16x32_bf16 v[44:47], v[204:207], v[212:215], v[44:47]
    v_mfma_f32_16x16x32_bf16 v[48:51], v[200:203], v[216:219], v[48:51]
    v_mfma_f32_16x16x32_bf16 v[52:55], v[204:207], v[216:219], v[52:55]
    v_mfma_f32_16x16x32_bf16 v[56:59], v[200:203], v[220:223], v[56:59]
    v_mfma_f32_16x16x32_bf16 v[60:63], v[204:207], v[220:223], v[60:63]
    s_waitcnt lgkmcnt(0)
    s_barrier
    ds_read_b128 v[200:203], v12 offset:44032
    ds_read_b128 v[204:207], v12 offset:46336
    ds_read_b128 v[208:211], v14 offset:44032
    ds_read_b128 v[212:215], v14 offset:46336
    ds_read_b128 v[216:219], v14 offset:48640
    ds_read_b128 v[220:223], v14 offset:50944
    ds_read_b128 v[16:19], v10 offset:5120
    ds_read_b128 v[20:23], v10 offset:5136
    ds_read_b128 v[24:27], v10 offset:13312
    ds_read_b128 v[28:31], v10 offset:13328
    buffer_load_dwordx4 v[168:171], v3, s[28:31], s44 offen
    buffer_load_dwordx4 v[172:175], v4, s[28:31], s44 offen
    buffer_load_dwordx4 v[176:179], v5, s[16:19], s45 offen
    buffer_load_dwordx4 v[180:183], v6, s[16:19], s45 offen
    buffer_load_dwordx4 v[184:187], v7, s[16:19], s45 offen
    buffer_load_dwordx4 v[188:191], v8, s[16:19], s45 offen
    s_add_u32 s44, s44, 128
    s_add_u32 s45, s45, 128
    v_mfma_f32_16x16x32_bf16 v[32:35], v[224:227], v[232:235], v[32:35]
    v_mfma_f32_16x16x32_bf16 v[36:39], v[228:231], v[232:235], v[36:39]
    s_waitcnt vmcnt(18) lgkmcnt(0)
    v_mfma_f32_16x16x32_bf16 v[40:43], v[224:227], v[236:239], v[40:43]
    v_lshlrev_b32 v11, 16, v96
    v_and_b32 v15, 0xffff0000, v96
    v_fma_f32 v11, v11, v16, v24
    v_fma_f32 v15, v15, v17, v25
    v_cvt_pk_bf16_f32 v96, v11, v15
    v_lshlrev_b32 v11, 16, v97
    v_and_b32 v15, 0xffff0000, v97
    v_mfma_f32_16x16x32_bf16 v[44:47], v[228:231], v[236:239], v[44:47]
    v_fma_f32 v11, v11, v18, v26
    v_fma_f32 v15, v15, v19, v27
    v_cvt_pk_bf16_f32 v97, v11, v15
    v_lshlrev_b32 v11, 16, v98
    v_and_b32 v15, 0xffff0000, v98
    v_fma_f32 v11, v11, v20, v28
    v_fma_f32 v15, v15, v21, v29
    v_mfma_f32_16x16x32_bf16 v[48:51], v[224:227], v[240:243], v[48:51]
    v_cvt_pk_bf16_f32 v98, v11, v15
    v_lshlrev_b32 v11, 16, v99
    v_and_b32 v15, 0xffff0000, v99
    v_fma_f32 v11, v11, v22, v30
    v_fma_f32 v15, v15, v23, v31
    v_cvt_pk_bf16_f32 v99, v11, v15
    v_lshlrev_b32 v11, 16, v100
    v_mfma_f32_16x16x32_bf16 v[52:55], v[228:231], v[240:243], v[52:55]
    v_and_b32 v15, 0xffff0000, v100
    v_fma_f32 v11, v11, v16, v24
    v_fma_f32 v15, v15, v17, v25
    v_cvt_pk_bf16_f32 v100, v11, v15
    v_lshlrev_b32 v11, 16, v101
    v_and_b32 v15, 0xffff0000, v101
    v_fma_f32 v11, v11, v18, v26
    v_mfma_f32_16x16x32_bf16 v[56:59], v[224:227], v[244:247], v[56:59]
    v_fma_f32 v15, v15, v19, v27
    v_cvt_pk_bf16_f32 v101, v11, v15
    v_lshlrev_b32 v11, 16, v102
    v_and_b32 v15, 0xffff0000, v102
    v_fma_f32 v11, v11, v20, v28
    v_fma_f32 v15, v15, v21, v29
    v_cvt_pk_bf16_f32 v102, v11, v15
    v_mfma_f32_16x16x32_bf16 v[60:63], v[228:231], v[244:247], v[60:63]
    v_lshlrev_b32 v11, 16, v103
    v_and_b32 v15, 0xffff0000, v103
    v_fma_f32 v11, v11, v22, v30
    v_fma_f32 v15, v15, v23, v31
    v_cvt_pk_bf16_f32 v103, v11, v15
    ds_write_b128 v9, v[96:99] offset:16384
    ds_write_b128 v9, v[100:103] offset:20992
    ds_write_b128 v9, v[104:107] offset:25600
    ds_write_b128 v9, v[108:111] offset:30208
    ds_write_b128 v9, v[112:115] offset:34816
    ds_write_b128 v9, v[116:119] offset:39424
    ds_read_b128 v[224:227], v12 offset:44096
    ds_read_b128 v[228:231], v12 offset:46400
    ds_read_b128 v[232:235], v14 offset:44096
    ds_read_b128 v[236:239], v14 offset:46400
    ds_read_b128 v[240:243], v14 offset:48704
    ds_read_b128 v[244:247], v14 offset:51008
    s_waitcnt lgkmcnt(12)
    v_mfma_f32_16x16x32_bf16 v[32:35], v[200:203], v[208:211], v[32:35]
    v_mfma_f32_16x16x32_bf16 v[36:39], v[204:207], v[208:211], v[36:39]
    v_mfma_f32_16x16x32_bf16 v[40:43], v[200:203], v[212:215], v[40:43]
    v_mfma_f32_16x16x32_bf16 v[44:47], v[204:207], v[212:215], v[44:47]
    v_mfma_f32_16x16x32_bf16 v[48:51], v[200:203], v[216:219], v[48:51]
    v_mfma_f32_16x16x32_bf16 v[52:55], v[204:207], v[216:219], v[52:55]
    v_mfma_f32_16x16x32_bf16 v[56:59], v[200:203], v[220:223], v[56:59]
    v_mfma_f32_16x16x32_bf16 v[60:63], v[204:207], v[220:223], v[60:63]
    s_waitcnt lgkmcnt(0)
    s_barrier
    ds_read_b128 v[200:203], v12 offset:16384
    ds_read_b128 v[204:207], v12 offset:18688
    ds_read_b128 v[208:211], v14 offset:16384
    ds_read_b128 v[212:215], v14 offset:18688
    ds_read_b128 v[216:219], v14 offset:20992
    ds_read_b128 v[220:223], v14 offset:23296
    ds_read_b128 v[16:19], v10 offset:5376
    ds_read_b128 v[20:23], v10 offset:5392
    ds_read_b128 v[24:27], v10 offset:13568
    ds_read_b128 v[28:31], v10 offset:13584
    buffer_load_dwordx4 v[96:99], v3, s[28:31], s44 offen
    buffer_load_dwordx4 v[100:103], v4, s[28:31], s44 offen
    buffer_load_dwordx4 v[104:107], v5, s[16:19], s45 offen
    buffer_load_dwordx4 v[108:111], v6, s[16:19], s45 offen
    buffer_load_dwordx4 v[112:115], v7, s[16:19], s45 offen
    buffer_load_dwordx4 v[116:119], v8, s[16:19], s45 offen
    s_add_u32 s44, s44, 128
    s_add_u32 s45, s45, 128
    v_mfma_f32_16x16x32_bf16 v[32:35], v[224:227], v[232:235], v[32:35]
    v_mfma_f32_16x16x32_bf16 v[36:39], v[228:231], v[232:235], v[36:39]
    s_waitcnt vmcnt(18) lgkmcnt(0)
    v_mfma_f32_16x16x32_bf16 v[40:43], v[224:227], v[236:239], v[40:43]
    v_lshlrev_b32 v11, 16, v120
    v_and_b32 v15, 0xffff0000, v120
    v_fma_f32 v11, v11, v16, v24
    v_fma_f32 v15, v15, v17, v25
    v_cvt_pk_bf16_f32 v120, v11, v15
    v_lshlrev_b32 v11, 16, v121
    v_and_b32 v15, 0xffff0000, v121
    v_mfma_f32_16x16x32_bf16 v[44:47], v[228:231], v[236:239], v[44:47]
    v_fma_f32 v11, v11, v18, v26
    v_fma_f32 v15, v15, v19, v27
    v_cvt_pk_bf16_f32 v121, v11, v15
    v_lshlrev_b32 v11, 16, v122
    v_and_b32 v15, 0xffff0000, v122
    v_fma_f32 v11, v11, v20, v28
    v_fma_f32 v15, v15, v21, v29
    v_mfma_f32_16x16x32_bf16 v[48:51], v[224:227], v[240:243], v[48:51]
    v_cvt_pk_bf16_f32 v122, v11, v15
    v_lshlrev_b32 v11, 16, v123
    v_and_b32 v15, 0xffff0000, v123
    v_fma_f32 v11, v11, v22, v30
    v_fma_f32 v15, v15, v23, v31
    v_cvt_pk_bf16_f32 v123, v11, v15
    v_lshlrev_b32 v11, 16, v124
    v_mfma_f32_16x16x32_bf16 v[52:55], v[228:231], v[240:243], v[52:55]
    v_and_b32 v15, 0xffff0000, v124
    v_fma_f32 v11, v11, v16, v24
    v_fma_f32 v15, v15, v17, v25
    v_cvt_pk_bf16_f32 v124, v11, v15
    v_lshlrev_b32 v11, 16, v125
    v_and_b32 v15, 0xffff0000, v125
    v_fma_f32 v11, v11, v18, v26
    v_mfma_f32_16x16x32_bf16 v[56:59], v[224:227], v[244:247], v[56:59]
    v_fma_f32 v15, v15, v19, v27
    v_cvt_pk_bf16_f32 v125, v11, v15
    v_lshlrev_b32 v11, 16, v126
    v_and_b32 v15, 0xffff0000, v126
    v_fma_f32 v11, v11, v20, v28
    v_fma_f32 v15, v15, v21, v29
    v_cvt_pk_bf16_f32 v126, v11, v15
    v_mfma_f32_16x16x32_bf16 v[60:63], v[228:231], v[244:247], v[60:63]
    v_lshlrev_b32 v11, 16, v127
    v_and_b32 v15, 0xffff0000, v127
    v_fma_f32 v11, v11, v22, v30
    v_fma_f32 v15, v15, v23, v31
    v_cvt_pk_bf16_f32 v127, v11, v15
    ds_write_b128 v9, v[120:123] offset:44032
    ds_write_b128 v9, v[124:127] offset:48640
    ds_write_b128 v9, v[128:131] offset:53248
    ds_write_b128 v9, v[132:135] offset:57856
    ds_write_b128 v9, v[136:139] offset:62464
    ds_write_b128 v64, v[140:143] offset:34304
    ds_read_b128 v[224:227], v12 offset:16448
    ds_read_b128 v[228:231], v12 offset:18752
    ds_read_b128 v[232:235], v14 offset:16448
    ds_read_b128 v[236:239], v14 offset:18752
    ds_read_b128 v[240:243], v14 offset:21056
    ds_read_b128 v[244:247], v14 offset:23360
    s_waitcnt lgkmcnt(12)
    v_mfma_f32_16x16x32_bf16 v[32:35], v[200:203], v[208:211], v[32:35]
    v_mfma_f32_16x16x32_bf16 v[36:39], v[204:207], v[208:211], v[36:39]
    v_mfma_f32_16x16x32_bf16 v[40:43], v[200:203], v[212:215], v[40:43]
    v_mfma_f32_16x16x32_bf16 v[44:47], v[204:207], v[212:215], v[44:47]
    v_mfma_f32_16x16x32_bf16 v[48:51], v[200:203], v[216:219], v[48:51]
    v_mfma_f32_16x16x32_bf16 v[52:55], v[204:207], v[216:219], v[52:55]
    v_mfma_f32_16x16x32_bf16 v[56:59], v[200:203], v[220:223], v[56:59]
    v_mfma_f32_16x16x32_bf16 v[60:63], v[204:207], v[220:223], v[60:63]
    s_waitcnt lgkmcnt(0)
    s_barrier
    ds_read_b128 v[200:203], v12 offset:44032
    ds_read_b128 v[204:207], v12 offset:46336
    ds_read_b128 v[208:211], v14 offset:44032
    ds_read_b128 v[212:215], v14 offset:46336
    ds_read_b128 v[216:219], v14 offset:48640
    ds_read_b128 v[220:223], v14 offset:50944
    ds_read_b128 v[16:19], v10 offset:5632
    ds_read_b128 v[20:23], v10 offset:5648
    ds_read_b128 v[24:27], v10 offset:13824
    ds_read_b128 v[28:31], v10 offset:13840
    buffer_load_dwordx4 v[120:123], v3, s[28:31], s44 offen
    buffer_load_dwordx4 v[124:127], v4, s[28:31], s44 offen
    buffer_load_dwordx4 v[128:131], v5, s[16:19], s45 offen
    buffer_load_dwordx4 v[132:135], v6, s[16:19], s45 offen
    buffer_load_dwordx4 v[136:139], v7, s[16:19], s45 offen
    buffer_load_dwordx4 v[140:143], v8, s[16:19], s45 offen
    s_add_u32 s44, s44, 128
    s_add_u32 s45, s45, 128
    v_mfma_f32_16x16x32_bf16 v[32:35], v[224:227], v[232:235], v[32:35]
    v_mfma_f32_16x16x32_bf16 v[36:39], v[228:231], v[232:235], v[36:39]
    s_waitcnt vmcnt(18) lgkmcnt(0)
    v_mfma_f32_16x16x32_bf16 v[40:43], v[224:227], v[236:239], v[40:43]
    v_lshlrev_b32 v11, 16, v144
    v_and_b32 v15, 0xffff0000, v144
    v_fma_f32 v11, v11, v16, v24
    v_fma_f32 v15, v15, v17, v25
    v_cvt_pk_bf16_f32 v144, v11, v15
    v_lshlrev_b32 v11, 16, v145
    v_and_b32 v15, 0xffff0000, v145
    v_mfma_f32_16x16x32_bf16 v[44:47], v[228:231], v[236:239], v[44:47]
    v_fma_f32 v11, v11, v18, v26
    v_fma_f32 v15, v15, v19, v27
    v_cvt_pk_bf16_f32 v145, v11, v15
    v_lshlrev_b32 v11, 16, v146
    v_and_b32 v15, 0xffff0000, v146
    v_fma_f32 v11, v11, v20, v28
    v_fma_f32 v15, v15, v21, v29
    v_mfma_f32_16x16x32_bf16 v[48:51], v[224:227], v[240:243], v[48:51]
    v_cvt_pk_bf16_f32 v146, v11, v15
    v_lshlrev_b32 v11, 16, v147
    v_and_b32 v15, 0xffff0000, v147
    v_fma_f32 v11, v11, v22, v30
    v_fma_f32 v15, v15, v23, v31
    v_cvt_pk_bf16_f32 v147, v11, v15
    v_lshlrev_b32 v11, 16, v148
    v_mfma_f32_16x16x32_bf16 v[52:55], v[228:231], v[240:243], v[52:55]
    v_and_b32 v15, 0xffff0000, v148
    v_fma_f32 v11, v11, v16, v24
    v_fma_f32 v15, v15, v17, v25
    v_cvt_pk_bf16_f32 v148, v11, v15
    v_lshlrev_b32 v11, 16, v149
    v_and_b32 v15, 0xffff0000, v149
    v_fma_f32 v11, v11, v18, v26
    v_mfma_f32_16x16x32_bf16 v[56:59], v[224:227], v[244:247], v[56:59]
    v_fma_f32 v15, v15, v19, v27
    v_cvt_pk_bf16_f32 v149, v11, v15
    v_lshlrev_b32 v11, 16, v150
    v_and_b32 v15, 0xffff0000, v150
    v_fma_f32 v11, v11, v20, v28
    v_fma_f32 v15, v15, v21, v29
    v_cvt_pk_bf16_f32 v150, v11, v15
    v_mfma_f32_16x16x32_bf16 v[60:63], v[228:231], v[244:247], v[60:63]
    v_lshlrev_b32 v11, 16, v151
    v_and_b32 v15, 0xffff0000, v151
    v_fma_f32 v11, v11, v22, v30
    v_fma_f32 v15, v15, v23, v31
    v_cvt_pk_bf16_f32 v151, v11, v15
    ds_write_b128 v9, v[144:147] offset:16384
    ds_write_b128 v9, v[148:151] offset:20992
    ds_write_b128 v9, v[152:155] offset:25600
    ds_write_b128 v9, v[156:159] offset:30208
    ds_write_b128 v9, v[160:163] offset:34816
    ds_write_b128 v9, v[164:167] offset:39424
    ds_read_b128 v[224:227], v12 offset:44096
    ds_read_b128 v[228:231], v12 offset:46400
    ds_read_b128 v[232:235], v14 offset:44096
    ds_read_b128 v[236:239], v14 offset:46400
    ds_read_b128 v[240:243], v14 offset:48704
    ds_read_b128 v[244:247], v14 offset:51008
    s_waitcnt lgkmcnt(12)
    v_mfma_f32_16x16x32_bf16 v[32:35], v[200:203], v[208:211], v[32:35]
    v_mfma_f32_16x16x32_bf16 v[36:39], v[204:207], v[208:211], v[36:39]
    v_mfma_f32_16x16x32_bf16 v[40:43], v[200:203], v[212:215], v[40:43]
    v_mfma_f32_16x16x32_bf16 v[44:47], v[204:207], v[212:215], v[44:47]
    v_mfma_f32_16x16x32_bf16 v[48:51], v[200:203], v[216:219], v[48:51]
    v_mfma_f32_16x16x32_bf16 v[52:55], v[204:207], v[216:219], v[52:55]
    v_mfma_f32_16x16x32_bf16 v[56:59], v[200:203], v[220:223], v[56:59]
    v_mfma_f32_16x16x32_bf16 v[60:63], v[204:207], v[220:223], v[60:63]
    s_waitcnt lgkmcnt(0)
    s_barrier
    ds_read_b128 v[200:203], v12 offset:16384
    ds_read_b128 v[204:207], v12 offset:18688
    ds_read_b128 v[208:211], v14 offset:16384
    ds_read_b128 v[212:215], v14 offset:18688
    ds_read_b128 v[216:219], v14 offset:20992
    ds_read_b128 v[220:223], v14 offset:23296
    ds_read_b128 v[16:19], v10 offset:5888
    ds_read_b128 v[20:23], v10 offset:5904
    ds_read_b128 v[24:27], v10 offset:14080
    ds_read_b128 v[28:31], v10 offset:14096
    buffer_load_dwordx4 v[144:147], v3, s[28:31], s44 offen
    buffer_load_dwordx4 v[148:151], v4, s[28:31], s44 offen
    buffer_load_dwordx4 v[152:155], v5, s[16:19], s45 offen
    buffer_load_dwordx4 v[156:159], v6, s[16:19], s45 offen
    buffer_load_dwordx4 v[160:163], v7, s[16:19], s45 offen
    buffer_load_dwordx4 v[164:167], v8, s[16:19], s45 offen
    s_add_u32 s44, s44, 128
    s_add_u32 s45, s45, 128
    v_mfma_f32_16x16x32_bf16 v[32:35], v[224:227], v[232:235], v[32:35]
    v_mfma_f32_16x16x32_bf16 v[36:39], v[228:231], v[232:235], v[36:39]
    s_waitcnt vmcnt(18) lgkmcnt(0)
    v_mfma_f32_16x16x32_bf16 v[40:43], v[224:227], v[236:239], v[40:43]
    v_lshlrev_b32 v11, 16, v168
    v_and_b32 v15, 0xffff0000, v168
    v_fma_f32 v11, v11, v16, v24
    v_fma_f32 v15, v15, v17, v25
    v_cvt_pk_bf16_f32 v168, v11, v15
    v_lshlrev_b32 v11, 16, v169
    v_and_b32 v15, 0xffff0000, v169
    v_mfma_f32_16x16x32_bf16 v[44:47], v[228:231], v[236:239], v[44:47]
    v_fma_f32 v11, v11, v18, v26
    v_fma_f32 v15, v15, v19, v27
    v_cvt_pk_bf16_f32 v169, v11, v15
    v_lshlrev_b32 v11, 16, v170
    v_and_b32 v15, 0xffff0000, v170
    v_fma_f32 v11, v11, v20, v28
    v_fma_f32 v15, v15, v21, v29
    v_mfma_f32_16x16x32_bf16 v[48:51], v[224:227], v[240:243], v[48:51]
    v_cvt_pk_bf16_f32 v170, v11, v15
    v_lshlrev_b32 v11, 16, v171
    v_and_b32 v15, 0xffff0000, v171
    v_fma_f32 v11, v11, v22, v30
    v_fma_f32 v15, v15, v23, v31
    v_cvt_pk_bf16_f32 v171, v11, v15
    v_lshlrev_b32 v11, 16, v172
    v_mfma_f32_16x16x32_bf16 v[52:55], v[228:231], v[240:243], v[52:55]
    v_and_b32 v15, 0xffff0000, v172
    v_fma_f32 v11, v11, v16, v24
    v_fma_f32 v15, v15, v17, v25
    v_cvt_pk_bf16_f32 v172, v11, v15
    v_lshlrev_b32 v11, 16, v173
    v_and_b32 v15, 0xffff0000, v173
    v_fma_f32 v11, v11, v18, v26
    v_mfma_f32_16x16x32_bf16 v[56:59], v[224:227], v[244:247], v[56:59]
    v_fma_f32 v15, v15, v19, v27
    v_cvt_pk_bf16_f32 v173, v11, v15
    v_lshlrev_b32 v11, 16, v174
    v_and_b32 v15, 0xffff0000, v174
    v_fma_f32 v11, v11, v20, v28
    v_fma_f32 v15, v15, v21, v29
    v_cvt_pk_bf16_f32 v174, v11, v15
    v_mfma_f32_16x16x32_bf16 v[60:63], v[228:231], v[244:247], v[60:63]
    v_lshlrev_b32 v11, 16, v175
    v_and_b32 v15, 0xffff0000, v175
    v_fma_f32 v11, v11, v22, v30
    v_fma_f32 v15, v15, v23, v31
    v_cvt_pk_bf16_f32 v175, v11, v15
    ds_write_b128 v9, v[168:171] offset:44032
    ds_write_b128 v9, v[172:175] offset:48640
    ds_write_b128 v9, v[176:179] offset:53248
    ds_write_b128 v9, v[180:183] offset:57856
    ds_write_b128 v9, v[184:187] offset:62464
    ds_write_b128 v64, v[188:191] offset:34304
    ds_read_b128 v[224:227], v12 offset:16448
    ds_read_b128 v[228:231], v12 offset:18752
    ds_read_b128 v[232:235], v14 offset:16448
    ds_read_b128 v[236:239], v14 offset:18752
    ds_read_b128 v[240:243], v14 offset:21056
    ds_read_b128 v[244:247], v14 offset:23360
    s_waitcnt lgkmcnt(12)
    v_mfma_f32_16x16x32_bf16 v[32:35], v[200:203], v[208:211], v[32:35]
    v_mfma_f32_16x16x32_bf16 v[36:39], v[204:207], v[208:211], v[36:39]
    v_mfma_f32_16x16x32_bf16 v[40:43], v[200:203], v[212:215], v[40:43]
    v_mfma_f32_16x16x32_bf16 v[44:47], v[204:207], v[212:215], v[44:47]
    v_mfma_f32_16x16x32_bf16 v[48:51], v[200:203], v[216:219], v[48:51]
    v_mfma_f32_16x16x32_bf16 v[52:55], v[204:207], v[216:219], v[52:55]
    v_mfma_f32_16x16x32_bf16 v[56:59], v[200:203], v[220:223], v[56:59]
    v_mfma_f32_16x16x32_bf16 v[60:63], v[204:207], v[220:223], v[60:63]
    s_waitcnt lgkmcnt(0)
    s_barrier
    ds_read_b128 v[200:203], v12 offset:44032
    ds_read_b128 v[204:207], v12 offset:46336
    ds_read_b128 v[208:211], v14 offset:44032
    ds_read_b128 v[212:215], v14 offset:46336
    ds_read_b128 v[216:219], v14 offset:48640
    ds_read_b128 v[220:223], v14 offset:50944
    ds_read_b128 v[16:19], v10 offset:6144
    ds_read_b128 v[20:23], v10 offset:6160
    ds_read_b128 v[24:27], v10 offset:14336
    ds_read_b128 v[28:31], v10 offset:14352
    buffer_load_dwordx4 v[168:171], v3, s[28:31], s44 offen
    buffer_load_dwordx4 v[172:175], v4, s[28:31], s44 offen
    buffer_load_dwordx4 v[176:179], v5, s[16:19], s45 offen
    buffer_load_dwordx4 v[180:183], v6, s[16:19], s45 offen
    buffer_load_dwordx4 v[184:187], v7, s[16:19], s45 offen
    buffer_load_dwordx4 v[188:191], v8, s[16:19], s45 offen
    s_add_u32 s44, s44, 128
    s_add_u32 s45, s45, 128
    v_mfma_f32_16x16x32_bf16 v[32:35], v[224:227], v[232:235], v[32:35]
    v_mfma_f32_16x16x32_bf16 v[36:39], v[228:231], v[232:235], v[36:39]
    s_waitcnt vmcnt(18) lgkmcnt(0)
    v_mfma_f32_16x16x32_bf16 v[40:43], v[224:227], v[236:239], v[40:43]
    v_lshlrev_b32 v11, 16, v96
    v_and_b32 v15, 0xffff0000, v96
    v_fma_f32 v11, v11, v16, v24
    v_fma_f32 v15, v15, v17, v25
    v_cvt_pk_bf16_f32 v96, v11, v15
    v_lshlrev_b32 v11, 16, v97
    v_and_b32 v15, 0xffff0000, v97
    v_mfma_f32_16x16x32_bf16 v[44:47], v[228:231], v[236:239], v[44:47]
    v_fma_f32 v11, v11, v18, v26
    v_fma_f32 v15, v15, v19, v27
    v_cvt_pk_bf16_f32 v97, v11, v15
    v_lshlrev_b32 v11, 16, v98
    v_and_b32 v15, 0xffff0000, v98
    v_fma_f32 v11, v11, v20, v28
    v_fma_f32 v15, v15, v21, v29
    v_mfma_f32_16x16x32_bf16 v[48:51], v[224:227], v[240:243], v[48:51]
    v_cvt_pk_bf16_f32 v98, v11, v15
    v_lshlrev_b32 v11, 16, v99
    v_and_b32 v15, 0xffff0000, v99
    v_fma_f32 v11, v11, v22, v30
    v_fma_f32 v15, v15, v23, v31
    v_cvt_pk_bf16_f32 v99, v11, v15
    v_lshlrev_b32 v11, 16, v100
    v_mfma_f32_16x16x32_bf16 v[52:55], v[228:231], v[240:243], v[52:55]
    v_and_b32 v15, 0xffff0000, v100
    v_fma_f32 v11, v11, v16, v24
    v_fma_f32 v15, v15, v17, v25
    v_cvt_pk_bf16_f32 v100, v11, v15
    v_lshlrev_b32 v11, 16, v101
    v_and_b32 v15, 0xffff0000, v101
    v_fma_f32 v11, v11, v18, v26
    v_mfma_f32_16x16x32_bf16 v[56:59], v[224:227], v[244:247], v[56:59]
    v_fma_f32 v15, v15, v19, v27
    v_cvt_pk_bf16_f32 v101, v11, v15
    v_lshlrev_b32 v11, 16, v102
    v_and_b32 v15, 0xffff0000, v102
    v_fma_f32 v11, v11, v20, v28
    v_fma_f32 v15, v15, v21, v29
    v_cvt_pk_bf16_f32 v102, v11, v15
    v_mfma_f32_16x16x32_bf16 v[60:63], v[228:231], v[244:247], v[60:63]
    v_lshlrev_b32 v11, 16, v103
    v_and_b32 v15, 0xffff0000, v103
    v_fma_f32 v11, v11, v22, v30
    v_fma_f32 v15, v15, v23, v31
    v_cvt_pk_bf16_f32 v103, v11, v15
    ds_write_b128 v9, v[96:99] offset:16384
    ds_write_b128 v9, v[100:103] offset:20992
    ds_write_b128 v9, v[104:107] offset:25600
    ds_write_b128 v9, v[108:111] offset:30208
    ds_write_b128 v9, v[112:115] offset:34816
    ds_write_b128 v9, v[116:119] offset:39424
    ds_read_b128 v[224:227], v12 offset:44096
    ds_read_b128 v[228:231], v12 offset:46400
    ds_read_b128 v[232:235], v14 offset:44096
    ds_read_b128 v[236:239], v14 offset:46400
    ds_read_b128 v[240:243], v14 offset:48704
    ds_read_b128 v[244:247], v14 offset:51008
    s_waitcnt lgkmcnt(12)
    v_mfma_f32_16x16x32_bf16 v[32:35], v[200:203], v[208:211], v[32:35]
    v_mfma_f32_16x16x32_bf16 v[36:39], v[204:207], v[208:211], v[36:39]
    v_mfma_f32_16x16x32_bf16 v[40:43], v[200:203], v[212:215], v[40:43]
    v_mfma_f32_16x16x32_bf16 v[44:47], v[204:207], v[212:215], v[44:47]
    v_mfma_f32_16x16x32_bf16 v[48:51], v[200:203], v[216:219], v[48:51]
    v_mfma_f32_16x16x32_bf16 v[52:55], v[204:207], v[216:219], v[52:55]
    v_mfma_f32_16x16x32_bf16 v[56:59], v[200:203], v[220:223], v[56:59]
    v_mfma_f32_16x16x32_bf16 v[60:63], v[204:207], v[220:223], v[60:63]
    s_waitcnt lgkmcnt(0)
    s_barrier
    ds_read_b128 v[200:203], v12 offset:16384
    ds_read_b128 v[204:207], v12 offset:18688
    ds_read_b128 v[208:211], v14 offset:16384
    ds_read_b128 v[212:215], v14 offset:18688
    ds_read_b128 v[216:219], v14 offset:20992
    ds_read_b128 v[220:223], v14 offset:23296
    ds_read_b128 v[16:19], v10 offset:6400
    ds_read_b128 v[20:23], v10 offset:6416
    ds_read_b128 v[24:27], v10 offset:14592
    ds_read_b128 v[28:31], v10 offset:14608
    buffer_load_dwordx4 v[96:99], v3, s[28:31], s44 offen
    buffer_load_dwordx4 v[100:103], v4, s[28:31], s44 offen
    buffer_load_dwordx4 v[104:107], v5, s[16:19], s45 offen
    buffer_load_dwordx4 v[108:111], v6, s[16:19], s45 offen
    buffer_load_dwordx4 v[112:115], v7, s[16:19], s45 offen
    buffer_load_dwordx4 v[116:119], v8, s[16:19], s45 offen
    s_add_u32 s44, s44, 128
    s_add_u32 s45, s45, 128
    v_mfma_f32_16x16x32_bf16 v[32:35], v[224:227], v[232:235], v[32:35]
    v_mfma_f32_16x16x32_bf16 v[36:39], v[228:231], v[232:235], v[36:39]
    s_waitcnt vmcnt(18) lgkmcnt(0)
    v_mfma_f32_16x16x32_bf16 v[40:43], v[224:227], v[236:239], v[40:43]
    v_lshlrev_b32 v11, 16, v120
    v_and_b32 v15, 0xffff0000, v120
    v_fma_f32 v11, v11, v16, v24
    v_fma_f32 v15, v15, v17, v25
    v_cvt_pk_bf16_f32 v120, v11, v15
    v_lshlrev_b32 v11, 16, v121
    v_and_b32 v15, 0xffff0000, v121
    v_mfma_f32_16x16x32_bf16 v[44:47], v[228:231], v[236:239], v[44:47]
    v_fma_f32 v11, v11, v18, v26
    v_fma_f32 v15, v15, v19, v27
    v_cvt_pk_bf16_f32 v121, v11, v15
    v_lshlrev_b32 v11, 16, v122
    v_and_b32 v15, 0xffff0000, v122
    v_fma_f32 v11, v11, v20, v28
    v_fma_f32 v15, v15, v21, v29
    v_mfma_f32_16x16x32_bf16 v[48:51], v[224:227], v[240:243], v[48:51]
    v_cvt_pk_bf16_f32 v122, v11, v15
    v_lshlrev_b32 v11, 16, v123
    v_and_b32 v15, 0xffff0000, v123
    v_fma_f32 v11, v11, v22, v30
    v_fma_f32 v15, v15, v23, v31
    v_cvt_pk_bf16_f32 v123, v11, v15
    v_lshlrev_b32 v11, 16, v124
    v_mfma_f32_16x16x32_bf16 v[52:55], v[228:231], v[240:243], v[52:55]
    v_and_b32 v15, 0xffff0000, v124
    v_fma_f32 v11, v11, v16, v24
    v_fma_f32 v15, v15, v17, v25
    v_cvt_pk_bf16_f32 v124, v11, v15
    v_lshlrev_b32 v11, 16, v125
    v_and_b32 v15, 0xffff0000, v125
    v_fma_f32 v11, v11, v18, v26
    v_mfma_f32_16x16x32_bf16 v[56:59], v[224:227], v[244:247], v[56:59]
    v_fma_f32 v15, v15, v19, v27
    v_cvt_pk_bf16_f32 v125, v11, v15
    v_lshlrev_b32 v11, 16, v126
    v_and_b32 v15, 0xffff0000, v126
    v_fma_f32 v11, v11, v20, v28
    v_fma_f32 v15, v15, v21, v29
    v_cvt_pk_bf16_f32 v126, v11, v15
    v_mfma_f32_16x16x32_bf16 v[60:63], v[228:231], v[244:247], v[60:63]
    v_lshlrev_b32 v11, 16, v127
    v_and_b32 v15, 0xffff0000, v127
    v_fma_f32 v11, v11, v22, v30
    v_fma_f32 v15, v15, v23, v31
    v_cvt_pk_bf16_f32 v127, v11, v15
    ds_write_b128 v9, v[120:123] offset:44032
    ds_write_b128 v9, v[124:127] offset:48640
    ds_write_b128 v9, v[128:131] offset:53248
    ds_write_b128 v9, v[132:135] offset:57856
    ds_write_b128 v9, v[136:139] offset:62464
    ds_write_b128 v64, v[140:143] offset:34304
    ds_read_b128 v[224:227], v12 offset:16448
    ds_read_b128 v[228:231], v12 offset:18752
    ds_read_b128 v[232:235], v14 offset:16448
    ds_read_b128 v[236:239], v14 offset:18752
    ds_read_b128 v[240:243], v14 offset:21056
    ds_read_b128 v[244:247], v14 offset:23360
    s_waitcnt lgkmcnt(12)
    v_mfma_f32_16x16x32_bf16 v[32:35], v[200:203], v[208:211], v[32:35]
    v_mfma_f32_16x16x32_bf16 v[36:39], v[204:207], v[208:211], v[36:39]
    v_mfma_f32_16x16x32_bf16 v[40:43], v[200:203], v[212:215], v[40:43]
    v_mfma_f32_16x16x32_bf16 v[44:47], v[204:207], v[212:215], v[44:47]
    v_mfma_f32_16x16x32_bf16 v[48:51], v[200:203], v[216:219], v[48:51]
    v_mfma_f32_16x16x32_bf16 v[52:55], v[204:207], v[216:219], v[52:55]
    v_mfma_f32_16x16x32_bf16 v[56:59], v[200:203], v[220:223], v[56:59]
    v_mfma_f32_16x16x32_bf16 v[60:63], v[204:207], v[220:223], v[60:63]
    s_waitcnt lgkmcnt(0)
    s_barrier
    ds_read_b128 v[200:203], v12 offset:44032
    ds_read_b128 v[204:207], v12 offset:46336
    ds_read_b128 v[208:211], v14 offset:44032
    ds_read_b128 v[212:215], v14 offset:46336
    ds_read_b128 v[216:219], v14 offset:48640
    ds_read_b128 v[220:223], v14 offset:50944
    ds_read_b128 v[16:19], v10 offset:6656
    ds_read_b128 v[20:23], v10 offset:6672
    ds_read_b128 v[24:27], v10 offset:14848
    ds_read_b128 v[28:31], v10 offset:14864
    buffer_load_dwordx4 v[120:123], v3, s[28:31], s44 offen
    buffer_load_dwordx4 v[124:127], v4, s[28:31], s44 offen
    buffer_load_dwordx4 v[128:131], v5, s[16:19], s45 offen
    buffer_load_dwordx4 v[132:135], v6, s[16:19], s45 offen
    buffer_load_dwordx4 v[136:139], v7, s[16:19], s45 offen
    buffer_load_dwordx4 v[140:143], v8, s[16:19], s45 offen
    s_add_u32 s44, s44, 128
    s_add_u32 s45, s45, 128
    v_mfma_f32_16x16x32_bf16 v[32:35], v[224:227], v[232:235], v[32:35]
    v_mfma_f32_16x16x32_bf16 v[36:39], v[228:231], v[232:235], v[36:39]
    s_waitcnt vmcnt(18) lgkmcnt(0)
    v_mfma_f32_16x16x32_bf16 v[40:43], v[224:227], v[236:239], v[40:43]
    v_lshlrev_b32 v11, 16, v144
    v_and_b32 v15, 0xffff0000, v144
    v_fma_f32 v11, v11, v16, v24
    v_fma_f32 v15, v15, v17, v25
    v_cvt_pk_bf16_f32 v144, v11, v15
    v_lshlrev_b32 v11, 16, v145
    v_and_b32 v15, 0xffff0000, v145
    v_mfma_f32_16x16x32_bf16 v[44:47], v[228:231], v[236:239], v[44:47]
    v_fma_f32 v11, v11, v18, v26
    v_fma_f32 v15, v15, v19, v27
    v_cvt_pk_bf16_f32 v145, v11, v15
    v_lshlrev_b32 v11, 16, v146
    v_and_b32 v15, 0xffff0000, v146
    v_fma_f32 v11, v11, v20, v28
    v_fma_f32 v15, v15, v21, v29
    v_mfma_f32_16x16x32_bf16 v[48:51], v[224:227], v[240:243], v[48:51]
    v_cvt_pk_bf16_f32 v146, v11, v15
    v_lshlrev_b32 v11, 16, v147
    v_and_b32 v15, 0xffff0000, v147
    v_fma_f32 v11, v11, v22, v30
    v_fma_f32 v15, v15, v23, v31
    v_cvt_pk_bf16_f32 v147, v11, v15
    v_lshlrev_b32 v11, 16, v148
    v_mfma_f32_16x16x32_bf16 v[52:55], v[228:231], v[240:243], v[52:55]
    v_and_b32 v15, 0xffff0000, v148
    v_fma_f32 v11, v11, v16, v24
    v_fma_f32 v15, v15, v17, v25
    v_cvt_pk_bf16_f32 v148, v11, v15
    v_lshlrev_b32 v11, 16, v149
    v_and_b32 v15, 0xffff0000, v149
    v_fma_f32 v11, v11, v18, v26
    v_mfma_f32_16x16x32_bf16 v[56:59], v[224:227], v[244:247], v[56:59]
    v_fma_f32 v15, v15, v19, v27
    v_cvt_pk_bf16_f32 v149, v11, v15
    v_lshlrev_b32 v11, 16, v150
    v_and_b32 v15, 0xffff0000, v150
    v_fma_f32 v11, v11, v20, v28
    v_fma_f32 v15, v15, v21, v29
    v_cvt_pk_bf16_f32 v150, v11, v15
    v_mfma_f32_16x16x32_bf16 v[60:63], v[228:231], v[244:247], v[60:63]
    v_lshlrev_b32 v11, 16, v151
    v_and_b32 v15, 0xffff0000, v151
    v_fma_f32 v11, v11, v22, v30
    v_fma_f32 v15, v15, v23, v31
    v_cvt_pk_bf16_f32 v151, v11, v15
    ds_write_b128 v9, v[144:147] offset:16384
    ds_write_b128 v9, v[148:151] offset:20992
    ds_write_b128 v9, v[152:155] offset:25600
    ds_write_b128 v9, v[156:159] offset:30208
    ds_write_b128 v9, v[160:163] offset:34816
    ds_write_b128 v9, v[164:167] offset:39424
    ds_read_b128 v[224:227], v12 offset:44096
    ds_read_b128 v[228:231], v12 offset:46400
    ds_read_b128 v[232:235], v14 offset:44096
    ds_read_b128 v[236:239], v14 offset:46400
    ds_read_b128 v[240:243], v14 offset:48704
    ds_read_b128 v[244:247], v14 offset:51008
    s_waitcnt lgkmcnt(12)
    v_mfma_f32_16x16x32_bf16 v[32:35], v[200:203], v[208:211], v[32:35]
    v_mfma_f32_16x16x32_bf16 v[36:39], v[204:207], v[208:211], v[36:39]
    v_mfma_f32_16x16x32_bf16 v[40:43], v[200:203], v[212:215], v[40:43]
    v_mfma_f32_16x16x32_bf16 v[44:47], v[204:207], v[212:215], v[44:47]
    v_mfma_f32_16x16x32_bf16 v[48:51], v[200:203], v[216:219], v[48:51]
    v_mfma_f32_16x16x32_bf16 v[52:55], v[204:207], v[216:219], v[52:55]
    v_mfma_f32_16x16x32_bf16 v[56:59], v[200:203], v[220:223], v[56:59]
    v_mfma_f32_16x16x32_bf16 v[60:63], v[204:207], v[220:223], v[60:63]
    s_waitcnt lgkmcnt(0)
    s_barrier
    ds_read_b128 v[200:203], v12 offset:16384
    ds_read_b128 v[204:207], v12 offset:18688
    ds_read_b128 v[208:211], v14 offset:16384
    ds_read_b128 v[212:215], v14 offset:18688
    ds_read_b128 v[216:219], v14 offset:20992
    ds_read_b128 v[220:223], v14 offset:23296
    ds_read_b128 v[16:19], v10 offset:6912
    ds_read_b128 v[20:23], v10 offset:6928
    ds_read_b128 v[24:27], v10 offset:15104
    ds_read_b128 v[28:31], v10 offset:15120
    buffer_load_dwordx4 v[144:147], v3, s[28:31], s44 offen
    buffer_load_dwordx4 v[148:151], v4, s[28:31], s44 offen
    buffer_load_dwordx4 v[152:155], v5, s[16:19], s45 offen
    buffer_load_dwordx4 v[156:159], v6, s[16:19], s45 offen
    buffer_load_dwordx4 v[160:163], v7, s[16:19], s45 offen
    buffer_load_dwordx4 v[164:167], v8, s[16:19], s45 offen
    s_add_u32 s44, s44, 128
    s_add_u32 s45, s45, 128
    v_mfma_f32_16x16x32_bf16 v[32:35], v[224:227], v[232:235], v[32:35]
    v_mfma_f32_16x16x32_bf16 v[36:39], v[228:231], v[232:235], v[36:39]
    s_waitcnt vmcnt(18) lgkmcnt(0)
    v_mfma_f32_16x16x32_bf16 v[40:43], v[224:227], v[236:239], v[40:43]
    v_lshlrev_b32 v11, 16, v168
    v_and_b32 v15, 0xffff0000, v168
    v_fma_f32 v11, v11, v16, v24
    v_fma_f32 v15, v15, v17, v25
    v_cvt_pk_bf16_f32 v168, v11, v15
    v_lshlrev_b32 v11, 16, v169
    v_and_b32 v15, 0xffff0000, v169
    v_mfma_f32_16x16x32_bf16 v[44:47], v[228:231], v[236:239], v[44:47]
    v_fma_f32 v11, v11, v18, v26
    v_fma_f32 v15, v15, v19, v27
    v_cvt_pk_bf16_f32 v169, v11, v15
    v_lshlrev_b32 v11, 16, v170
    v_and_b32 v15, 0xffff0000, v170
    v_fma_f32 v11, v11, v20, v28
    v_fma_f32 v15, v15, v21, v29
    v_mfma_f32_16x16x32_bf16 v[48:51], v[224:227], v[240:243], v[48:51]
    v_cvt_pk_bf16_f32 v170, v11, v15
    v_lshlrev_b32 v11, 16, v171
    v_and_b32 v15, 0xffff0000, v171
    v_fma_f32 v11, v11, v22, v30
    v_fma_f32 v15, v15, v23, v31
    v_cvt_pk_bf16_f32 v171, v11, v15
    v_lshlrev_b32 v11, 16, v172
    v_mfma_f32_16x16x32_bf16 v[52:55], v[228:231], v[240:243], v[52:55]
    v_and_b32 v15, 0xffff0000, v172
    v_fma_f32 v11, v11, v16, v24
    v_fma_f32 v15, v15, v17, v25
    v_cvt_pk_bf16_f32 v172, v11, v15
    v_lshlrev_b32 v11, 16, v173
    v_and_b32 v15, 0xffff0000, v173
    v_fma_f32 v11, v11, v18, v26
    v_mfma_f32_16x16x32_bf16 v[56:59], v[224:227], v[244:247], v[56:59]
    v_fma_f32 v15, v15, v19, v27
    v_cvt_pk_bf16_f32 v173, v11, v15
    v_lshlrev_b32 v11, 16, v174
    v_and_b32 v15, 0xffff0000, v174
    v_fma_f32 v11, v11, v20, v28
    v_fma_f32 v15, v15, v21, v29
    v_cvt_pk_bf16_f32 v174, v11, v15
    v_mfma_f32_16x16x32_bf16 v[60:63], v[228:231], v[244:247], v[60:63]
    v_lshlrev_b32 v11, 16, v175
    v_and_b32 v15, 0xffff0000, v175
    v_fma_f32 v11, v11, v22, v30
    v_fma_f32 v15, v15, v23, v31
    v_cvt_pk_bf16_f32 v175, v11, v15
    ds_write_b128 v9, v[168:171] offset:44032
    ds_write_b128 v9, v[172:175] offset:48640
    ds_write_b128 v9, v[176:179] offset:53248
    ds_write_b128 v9, v[180:183] offset:57856
    ds_write_b128 v9, v[184:187] offset:62464
    ds_write_b128 v64, v[188:191] offset:34304
    ds_read_b128 v[224:227], v12 offset:16448
    ds_read_b128 v[228:231], v12 offset:18752
    ds_read_b128 v[232:235], v14 offset:16448
    ds_read_b128 v[236:239], v14 offset:18752
    ds_read_b128 v[240:243], v14 offset:21056
    ds_read_b128 v[244:247], v14 offset:23360
    s_waitcnt lgkmcnt(12)
    v_mfma_f32_16x16x32_bf16 v[32:35], v[200:203], v[208:211], v[32:35]
    v_mfma_f32_16x16x32_bf16 v[36:39], v[204:207], v[208:211], v[36:39]
    v_mfma_f32_16x16x32_bf16 v[40:43], v[200:203], v[212:215], v[40:43]
    v_mfma_f32_16x16x32_bf16 v[44:47], v[204:207], v[212:215], v[44:47]
    v_mfma_f32_16x16x32_bf16 v[48:51], v[200:203], v[216:219], v[48:51]
    v_mfma_f32_16x16x32_bf16 v[52:55], v[204:207], v[216:219], v[52:55]
    v_mfma_f32_16x16x32_bf16 v[56:59], v[200:203], v[220:223], v[56:59]
    v_mfma_f32_16x16x32_bf16 v[60:63], v[204:207], v[220:223], v[60:63]
    s_waitcnt lgkmcnt(0)
    s_barrier
    ds_read_b128 v[200:203], v12 offset:44032
    ds_read_b128 v[204:207], v12 offset:46336
    ds_read_b128 v[208:211], v14 offset:44032
    ds_read_b128 v[212:215], v14 offset:46336
    ds_read_b128 v[216:219], v14 offset:48640
    ds_read_b128 v[220:223], v14 offset:50944
    ds_read_b128 v[16:19], v10 offset:7168
    ds_read_b128 v[20:23], v10 offset:7184
    ds_read_b128 v[24:27], v10 offset:15360
    ds_read_b128 v[28:31], v10 offset:15376
    buffer_load_dwordx4 v[168:171], v3, s[28:31], s44 offen
    buffer_load_dwordx4 v[172:175], v4, s[28:31], s44 offen
    buffer_load_dwordx4 v[176:179], v5, s[16:19], s45 offen
    buffer_load_dwordx4 v[180:183], v6, s[16:19], s45 offen
    buffer_load_dwordx4 v[184:187], v7, s[16:19], s45 offen
    buffer_load_dwordx4 v[188:191], v8, s[16:19], s45 offen
    s_add_u32 s44, s44, 128
    s_add_u32 s45, s45, 128
    v_mfma_f32_16x16x32_bf16 v[32:35], v[224:227], v[232:235], v[32:35]
    v_mfma_f32_16x16x32_bf16 v[36:39], v[228:231], v[232:235], v[36:39]
    s_waitcnt vmcnt(18) lgkmcnt(0)
    v_mfma_f32_16x16x32_bf16 v[40:43], v[224:227], v[236:239], v[40:43]
    v_lshlrev_b32 v11, 16, v96
    v_and_b32 v15, 0xffff0000, v96
    v_fma_f32 v11, v11, v16, v24
    v_fma_f32 v15, v15, v17, v25
    v_cvt_pk_bf16_f32 v96, v11, v15
    v_lshlrev_b32 v11, 16, v97
    v_and_b32 v15, 0xffff0000, v97
    v_mfma_f32_16x16x32_bf16 v[44:47], v[228:231], v[236:239], v[44:47]
    v_fma_f32 v11, v11, v18, v26
    v_fma_f32 v15, v15, v19, v27
    v_cvt_pk_bf16_f32 v97, v11, v15
    v_lshlrev_b32 v11, 16, v98
    v_and_b32 v15, 0xffff0000, v98
    v_fma_f32 v11, v11, v20, v28
    v_fma_f32 v15, v15, v21, v29
    v_mfma_f32_16x16x32_bf16 v[48:51], v[224:227], v[240:243], v[48:51]
    v_cvt_pk_bf16_f32 v98, v11, v15
    v_lshlrev_b32 v11, 16, v99
    v_and_b32 v15, 0xffff0000, v99
    v_fma_f32 v11, v11, v22, v30
    v_fma_f32 v15, v15, v23, v31
    v_cvt_pk_bf16_f32 v99, v11, v15
    v_lshlrev_b32 v11, 16, v100
    v_mfma_f32_16x16x32_bf16 v[52:55], v[228:231], v[240:243], v[52:55]
    v_and_b32 v15, 0xffff0000, v100
    v_fma_f32 v11, v11, v16, v24
    v_fma_f32 v15, v15, v17, v25
    v_cvt_pk_bf16_f32 v100, v11, v15
    v_lshlrev_b32 v11, 16, v101
    v_and_b32 v15, 0xffff0000, v101
    v_fma_f32 v11, v11, v18, v26
    v_mfma_f32_16x16x32_bf16 v[56:59], v[224:227], v[244:247], v[56:59]
    v_fma_f32 v15, v15, v19, v27
    v_cvt_pk_bf16_f32 v101, v11, v15
    v_lshlrev_b32 v11, 16, v102
    v_and_b32 v15, 0xffff0000, v102
    v_fma_f32 v11, v11, v20, v28
    v_fma_f32 v15, v15, v21, v29
    v_cvt_pk_bf16_f32 v102, v11, v15
    v_mfma_f32_16x16x32_bf16 v[60:63], v[228:231], v[244:247], v[60:63]
    v_lshlrev_b32 v11, 16, v103
    v_and_b32 v15, 0xffff0000, v103
    v_fma_f32 v11, v11, v22, v30
    v_fma_f32 v15, v15, v23, v31
    v_cvt_pk_bf16_f32 v103, v11, v15
    ds_write_b128 v9, v[96:99] offset:16384
    ds_write_b128 v9, v[100:103] offset:20992
    ds_write_b128 v9, v[104:107] offset:25600
    ds_write_b128 v9, v[108:111] offset:30208
    ds_write_b128 v9, v[112:115] offset:34816
    ds_write_b128 v9, v[116:119] offset:39424
    ds_read_b128 v[224:227], v12 offset:44096
    ds_read_b128 v[228:231], v12 offset:46400
    ds_read_b128 v[232:235], v14 offset:44096
    ds_read_b128 v[236:239], v14 offset:46400
    ds_read_b128 v[240:243], v14 offset:48704
    ds_read_b128 v[244:247], v14 offset:51008
    s_waitcnt lgkmcnt(12)
    v_mfma_f32_16x16x32_bf16 v[32:35], v[200:203], v[208:211], v[32:35]
    v_mfma_f32_16x16x32_bf16 v[36:39], v[204:207], v[208:211], v[36:39]
    v_mfma_f32_16x16x32_bf16 v[40:43], v[200:203], v[212:215], v[40:43]
    v_mfma_f32_16x16x32_bf16 v[44:47], v[204:207], v[212:215], v[44:47]
    v_mfma_f32_16x16x32_bf16 v[48:51], v[200:203], v[216:219], v[48:51]
    v_mfma_f32_16x16x32_bf16 v[52:55], v[204:207], v[216:219], v[52:55]
    v_mfma_f32_16x16x32_bf16 v[56:59], v[200:203], v[220:223], v[56:59]
    v_mfma_f32_16x16x32_bf16 v[60:63], v[204:207], v[220:223], v[60:63]
    s_waitcnt lgkmcnt(0)
    s_barrier
    ds_read_b128 v[200:203], v12 offset:16384
    ds_read_b128 v[204:207], v12 offset:18688
    ds_read_b128 v[208:211], v14 offset:16384
    ds_read_b128 v[212:215], v14 offset:18688
    ds_read_b128 v[216:219], v14 offset:20992
    ds_read_b128 v[220:223], v14 offset:23296
    ds_read_b128 v[16:19], v10 offset:7424
    ds_read_b128 v[20:23], v10 offset:7440
    ds_read_b128 v[24:27], v10 offset:15616
    ds_read_b128 v[28:31], v10 offset:15632
    v_mfma_f32_16x16x32_bf16 v[32:35], v[224:227], v[232:235], v[32:35]
    v_mfma_f32_16x16x32_bf16 v[36:39], v[228:231], v[232:235], v[36:39]
    s_waitcnt vmcnt(12) lgkmcnt(0)
    v_mfma_f32_16x16x32_bf16 v[40:43], v[224:227], v[236:239], v[40:43]
    v_lshlrev_b32 v11, 16, v120
    v_and_b32 v15, 0xffff0000, v120
    v_fma_f32 v11, v11, v16, v24
    v_fma_f32 v15, v15, v17, v25
    v_cvt_pk_bf16_f32 v120, v11, v15
    v_lshlrev_b32 v11, 16, v121
    v_and_b32 v15, 0xffff0000, v121
    v_mfma_f32_16x16x32_bf16 v[44:47], v[228:231], v[236:239], v[44:47]
    v_fma_f32 v11, v11, v18, v26
    v_fma_f32 v15, v15, v19, v27
    v_cvt_pk_bf16_f32 v121, v11, v15
    v_lshlrev_b32 v11, 16, v122
    v_and_b32 v15, 0xffff0000, v122
    v_fma_f32 v11, v11, v20, v28
    v_fma_f32 v15, v15, v21, v29
    v_mfma_f32_16x16x32_bf16 v[48:51], v[224:227], v[240:243], v[48:51]
    v_cvt_pk_bf16_f32 v122, v11, v15
    v_lshlrev_b32 v11, 16, v123
    v_and_b32 v15, 0xffff0000, v123
    v_fma_f32 v11, v11, v22, v30
    v_fma_f32 v15, v15, v23, v31
    v_cvt_pk_bf16_f32 v123, v11, v15
    v_lshlrev_b32 v11, 16, v124
    v_mfma_f32_16x16x32_bf16 v[52:55], v[228:231], v[240:243], v[52:55]
    v_and_b32 v15, 0xffff0000, v124
    v_fma_f32 v11, v11, v16, v24
    v_fma_f32 v15, v15, v17, v25
    v_cvt_pk_bf16_f32 v124, v11, v15
    v_lshlrev_b32 v11, 16, v125
    v_and_b32 v15, 0xffff0000, v125
    v_fma_f32 v11, v11, v18, v26
    v_mfma_f32_16x16x32_bf16 v[56:59], v[224:227], v[244:247], v[56:59]
    v_fma_f32 v15, v15, v19, v27
    v_cvt_pk_bf16_f32 v125, v11, v15
    v_lshlrev_b32 v11, 16, v126
    v_and_b32 v15, 0xffff0000, v126
    v_fma_f32 v11, v11, v20, v28
    v_fma_f32 v15, v15, v21, v29
    v_cvt_pk_bf16_f32 v126, v11, v15
    v_mfma_f32_16x16x32_bf16 v[60:63], v[228:231], v[244:247], v[60:63]
    v_lshlrev_b32 v11, 16, v127
    v_and_b32 v15, 0xffff0000, v127
    v_fma_f32 v11, v11, v22, v30
    v_fma_f32 v15, v15, v23, v31
    v_cvt_pk_bf16_f32 v127, v11, v15
    ds_write_b128 v9, v[120:123] offset:44032
    ds_write_b128 v9, v[124:127] offset:48640
    ds_write_b128 v9, v[128:131] offset:53248
    ds_write_b128 v9, v[132:135] offset:57856
    ds_write_b128 v9, v[136:139] offset:62464
    ds_write_b128 v64, v[140:143] offset:34304
    ds_read_b128 v[224:227], v12 offset:16448
    ds_read_b128 v[228:231], v12 offset:18752
    ds_read_b128 v[232:235], v14 offset:16448
    ds_read_b128 v[236:239], v14 offset:18752
    ds_read_b128 v[240:243], v14 offset:21056
    ds_read_b128 v[244:247], v14 offset:23360
    s_waitcnt lgkmcnt(12)
    v_mfma_f32_16x16x32_bf16 v[32:35], v[200:203], v[208:211], v[32:35]
    v_mfma_f32_16x16x32_bf16 v[36:39], v[204:207], v[208:211], v[36:39]
    v_mfma_f32_16x16x32_bf16 v[40:43], v[200:203], v[212:215], v[40:43]
    v_mfma_f32_16x16x32_bf16 v[44:47], v[204:207], v[212:215], v[44:47]
    v_mfma_f32_16x16x32_bf16 v[48:51], v[200:203], v[216:219], v[48:51]
    v_mfma_f32_16x16x32_bf16 v[52:55], v[204:207], v[216:219], v[52:55]
    v_mfma_f32_16x16x32_bf16 v[56:59], v[200:203], v[220:223], v[56:59]
    v_mfma_f32_16x16x32_bf16 v[60:63], v[204:207], v[220:223], v[60:63]
    s_waitcnt lgkmcnt(0)
    s_barrier
    ds_read_b128 v[200:203], v12 offset:44032
    ds_read_b128 v[204:207], v12 offset:46336
    ds_read_b128 v[208:211], v14 offset:44032
    ds_read_b128 v[212:215], v14 offset:46336
    ds_read_b128 v[216:219], v14 offset:48640
    ds_read_b128 v[220:223], v14 offset:50944
    ds_read_b128 v[16:19], v10 offset:7680
    ds_read_b128 v[20:23], v10 offset:7696
    ds_read_b128 v[24:27], v10 offset:15872
    ds_read_b128 v[28:31], v10 offset:15888
    v_mfma_f32_16x16x32_bf16 v[32:35], v[224:227], v[232:235], v[32:35]
    v_mfma_f32_16x16x32_bf16 v[36:39], v[228:231], v[232:235], v[36:39]
    s_waitcnt vmcnt(6) lgkmcnt(0)
    v_mfma_f32_16x16x32_bf16 v[40:43], v[224:227], v[236:239], v[40:43]
    v_lshlrev_b32 v11, 16, v144
    v_and_b32 v15, 0xffff0000, v144
    v_fma_f32 v11, v11, v16, v24
    v_fma_f32 v15, v15, v17, v25
    v_cvt_pk_bf16_f32 v144, v11, v15
    v_lshlrev_b32 v11, 16, v145
    v_and_b32 v15, 0xffff0000, v145
    v_mfma_f32_16x16x32_bf16 v[44:47], v[228:231], v[236:239], v[44:47]
    v_fma_f32 v11, v11, v18, v26
    v_fma_f32 v15, v15, v19, v27
    v_cvt_pk_bf16_f32 v145, v11, v15
    v_lshlrev_b32 v11, 16, v146
    v_and_b32 v15, 0xffff0000, v146
    v_fma_f32 v11, v11, v20, v28
    v_fma_f32 v15, v15, v21, v29
    v_mfma_f32_16x16x32_bf16 v[48:51], v[224:227], v[240:243], v[48:51]
    v_cvt_pk_bf16_f32 v146, v11, v15
    v_lshlrev_b32 v11, 16, v147
    v_and_b32 v15, 0xffff0000, v147
    v_fma_f32 v11, v11, v22, v30
    v_fma_f32 v15, v15, v23, v31
    v_cvt_pk_bf16_f32 v147, v11, v15
    v_lshlrev_b32 v11, 16, v148
    v_mfma_f32_16x16x32_bf16 v[52:55], v[228:231], v[240:243], v[52:55]
    v_and_b32 v15, 0xffff0000, v148
    v_fma_f32 v11, v11, v16, v24
    v_fma_f32 v15, v15, v17, v25
    v_cvt_pk_bf16_f32 v148, v11, v15
    v_lshlrev_b32 v11, 16, v149
    v_and_b32 v15, 0xffff0000, v149
    v_fma_f32 v11, v11, v18, v26
    v_mfma_f32_16x16x32_bf16 v[56:59], v[224:227], v[244:247], v[56:59]
    v_fma_f32 v15, v15, v19, v27
    v_cvt_pk_bf16_f32 v149, v11, v15
    v_lshlrev_b32 v11, 16, v150
    v_and_b32 v15, 0xffff0000, v150
    v_fma_f32 v11, v11, v20, v28
    v_fma_f32 v15, v15, v21, v29
    v_cvt_pk_bf16_f32 v150, v11, v15
    v_mfma_f32_16x16x32_bf16 v[60:63], v[228:231], v[244:247], v[60:63]
    v_lshlrev_b32 v11, 16, v151
    v_and_b32 v15, 0xffff0000, v151
    v_fma_f32 v11, v11, v22, v30
    v_fma_f32 v15, v15, v23, v31
    v_cvt_pk_bf16_f32 v151, v11, v15
    ds_write_b128 v9, v[144:147] offset:16384
    ds_write_b128 v9, v[148:151] offset:20992
    ds_write_b128 v9, v[152:155] offset:25600
    ds_write_b128 v9, v[156:159] offset:30208
    ds_write_b128 v9, v[160:163] offset:34816
    ds_write_b128 v9, v[164:167] offset:39424
    ds_read_b128 v[224:227], v12 offset:44096
    ds_read_b128 v[228:231], v12 offset:46400
    ds_read_b128 v[232:235], v14 offset:44096
    ds_read_b128 v[236:239], v14 offset:46400
    ds_read_b128 v[240:243], v14 offset:48704
    ds_read_b128 v[244:247], v14 offset:51008
    s_waitcnt lgkmcnt(12)
    v_mfma_f32_16x16x32_bf16 v[32:35], v[200:203], v[208:211], v[32:35]
    v_mfma_f32_16x16x32_bf16 v[36:39], v[204:207], v[208:211], v[36:39]
    v_mfma_f32_16x16x32_bf16 v[40:43], v[200:203], v[212:215], v[40:43]
    v_mfma_f32_16x16x32_bf16 v[44:47], v[204:207], v[212:215], v[44:47]
    v_mfma_f32_16x16x32_bf16 v[48:51], v[200:203], v[216:219], v[48:51]
    v_mfma_f32_16x16x32_bf16 v[52:55], v[204:207], v[216:219], v[52:55]
    v_mfma_f32_16x16x32_bf16 v[56:59], v[200:203], v[220:223], v[56:59]
    v_mfma_f32_16x16x32_bf16 v[60:63], v[204:207], v[220:223], v[60:63]
    s_waitcnt lgkmcnt(0)
    s_barrier
    ds_read_b128 v[200:203], v12 offset:16384
    ds_read_b128 v[204:207], v12 offset:18688
    ds_read_b128 v[208:211], v14 offset:16384
    ds_read_b128 v[212:215], v14 offset:18688
    ds_read_b128 v[216:219], v14 offset:20992
    ds_read_b128 v[220:223], v14 offset:23296
    ds_read_b128 v[16:19], v10 offset:7936
    ds_read_b128 v[20:23], v10 offset:7952
    ds_read_b128 v[24:27], v10 offset:16128
    ds_read_b128 v[28:31], v10 offset:16144
    v_mfma_f32_16x16x32_bf16 v[32:35], v[224:227], v[232:235], v[32:35]
    v_mfma_f32_16x16x32_bf16 v[36:39], v[228:231], v[232:235], v[36:39]
    s_waitcnt vmcnt(0) lgkmcnt(0)
    v_mfma_f32_16x16x32_bf16 v[40:43], v[224:227], v[236:239], v[40:43]
    v_lshlrev_b32 v11, 16, v168
    v_and_b32 v15, 0xffff0000, v168
    v_fma_f32 v11, v11, v16, v24
    v_fma_f32 v15, v15, v17, v25
    v_cvt_pk_bf16_f32 v168, v11, v15
    v_lshlrev_b32 v11, 16, v169
    v_and_b32 v15, 0xffff0000, v169
    v_mfma_f32_16x16x32_bf16 v[44:47], v[228:231], v[236:239], v[44:47]
    v_fma_f32 v11, v11, v18, v26
    v_fma_f32 v15, v15, v19, v27
    v_cvt_pk_bf16_f32 v169, v11, v15
    v_lshlrev_b32 v11, 16, v170
    v_and_b32 v15, 0xffff0000, v170
    v_fma_f32 v11, v11, v20, v28
    v_fma_f32 v15, v15, v21, v29
    v_mfma_f32_16x16x32_bf16 v[48:51], v[224:227], v[240:243], v[48:51]
    v_cvt_pk_bf16_f32 v170, v11, v15
    v_lshlrev_b32 v11, 16, v171
    v_and_b32 v15, 0xffff0000, v171
    v_fma_f32 v11, v11, v22, v30
    v_fma_f32 v15, v15, v23, v31
    v_cvt_pk_bf16_f32 v171, v11, v15
    v_lshlrev_b32 v11, 16, v172
    v_mfma_f32_16x16x32_bf16 v[52:55], v[228:231], v[240:243], v[52:55]
    v_and_b32 v15, 0xffff0000, v172
    v_fma_f32 v11, v11, v16, v24
    v_fma_f32 v15, v15, v17, v25
    v_cvt_pk_bf16_f32 v172, v11, v15
    v_lshlrev_b32 v11, 16, v173
    v_and_b32 v15, 0xffff0000, v173
    v_fma_f32 v11, v11, v18, v26
    v_mfma_f32_16x16x32_bf16 v[56:59], v[224:227], v[244:247], v[56:59]
    v_fma_f32 v15, v15, v19, v27
    v_cvt_pk_bf16_f32 v173, v11, v15
    v_lshlrev_b32 v11, 16, v174
    v_and_b32 v15, 0xffff0000, v174
    v_fma_f32 v11, v11, v20, v28
    v_fma_f32 v15, v15, v21, v29
    v_cvt_pk_bf16_f32 v174, v11, v15
    v_mfma_f32_16x16x32_bf16 v[60:63], v[228:231], v[244:247], v[60:63]
    v_lshlrev_b32 v11, 16, v175
    v_and_b32 v15, 0xffff0000, v175
    v_fma_f32 v11, v11, v22, v30
    v_fma_f32 v15, v15, v23, v31
    v_cvt_pk_bf16_f32 v175, v11, v15
    ds_write_b128 v9, v[168:171] offset:44032
    ds_write_b128 v9, v[172:175] offset:48640
    ds_write_b128 v9, v[176:179] offset:53248
    ds_write_b128 v9, v[180:183] offset:57856
    ds_write_b128 v9, v[184:187] offset:62464
    ds_write_b128 v64, v[188:191] offset:34304
    ds_read_b128 v[224:227], v12 offset:16448
    ds_read_b128 v[228:231], v12 offset:18752
    ds_read_b128 v[232:235], v14 offset:16448
    ds_read_b128 v[236:239], v14 offset:18752
    ds_read_b128 v[240:243], v14 offset:21056
    ds_read_b128 v[244:247], v14 offset:23360
    s_waitcnt lgkmcnt(12)
    v_mfma_f32_16x16x32_bf16 v[32:35], v[200:203], v[208:211], v[32:35]
    v_mfma_f32_16x16x32_bf16 v[36:39], v[204:207], v[208:211], v[36:39]
    v_mfma_f32_16x16x32_bf16 v[40:43], v[200:203], v[212:215], v[40:43]
    v_mfma_f32_16x16x32_bf16 v[44:47], v[204:207], v[212:215], v[44:47]
    v_mfma_f32_16x16x32_bf16 v[48:51], v[200:203], v[216:219], v[48:51]
    v_mfma_f32_16x16x32_bf16 v[52:55], v[204:207], v[216:219], v[52:55]
    v_mfma_f32_16x16x32_bf16 v[56:59], v[200:203], v[220:223], v[56:59]
    v_mfma_f32_16x16x32_bf16 v[60:63], v[204:207], v[220:223], v[60:63]
    s_waitcnt lgkmcnt(0)
    s_barrier
    ds_read_b128 v[200:203], v12 offset:44032
    ds_read_b128 v[204:207], v12 offset:46336
    ds_read_b128 v[208:211], v14 offset:44032
    ds_read_b128 v[212:215], v14 offset:46336
    ds_read_b128 v[216:219], v14 offset:48640
    ds_read_b128 v[220:223], v14 offset:50944
    v_mfma_f32_16x16x32_bf16 v[32:35], v[224:227], v[232:235], v[32:35]
    v_mfma_f32_16x16x32_bf16 v[36:39], v[228:231], v[232:235], v[36:39]
    v_mfma_f32_16x16x32_bf16 v[40:43], v[224:227], v[236:239], v[40:43]
    v_mfma_f32_16x16x32_bf16 v[44:47], v[228:231], v[236:239], v[44:47]
    v_mfma_f32_16x16x32_bf16 v[48:51], v[224:227], v[240:243], v[48:51]
    v_mfma_f32_16x16x32_bf16 v[52:55], v[228:231], v[240:243], v[52:55]
    v_mfma_f32_16x16x32_bf16 v[56:59], v[224:227], v[244:247], v[56:59]
    v_mfma_f32_16x16x32_bf16 v[60:63], v[228:231], v[244:247], v[60:63]
    ds_read_b128 v[224:227], v12 offset:44096
    ds_read_b128 v[228:231], v12 offset:46400
    ds_read_b128 v[232:235], v14 offset:44096
    ds_read_b128 v[236:239], v14 offset:46400
    ds_read_b128 v[240:243], v14 offset:48704
    ds_read_b128 v[244:247], v14 offset:51008
    s_waitcnt lgkmcnt(6)
    v_mfma_f32_16x16x32_bf16 v[32:35], v[200:203], v[208:211], v[32:35]
    v_mfma_f32_16x16x32_bf16 v[36:39], v[204:207], v[208:211], v[36:39]
    v_mfma_f32_16x16x32_bf16 v[40:43], v[200:203], v[212:215], v[40:43]
    v_mfma_f32_16x16x32_bf16 v[44:47], v[204:207], v[212:215], v[44:47]
    v_mfma_f32_16x16x32_bf16 v[48:51], v[200:203], v[216:219], v[48:51]
    v_mfma_f32_16x16x32_bf16 v[52:55], v[204:207], v[216:219], v[52:55]
    v_mfma_f32_16x16x32_bf16 v[56:59], v[200:203], v[220:223], v[56:59]
    v_mfma_f32_16x16x32_bf16 v[60:63], v[204:207], v[220:223], v[60:63]
    s_waitcnt lgkmcnt(0)
    v_mfma_f32_16x16x32_bf16 v[32:35], v[224:227], v[232:235], v[32:35]
    v_mfma_f32_16x16x32_bf16 v[36:39], v[228:231], v[232:235], v[36:39]
    v_mfma_f32_16x16x32_bf16 v[40:43], v[224:227], v[236:239], v[40:43]
    v_mfma_f32_16x16x32_bf16 v[44:47], v[228:231], v[236:239], v[44:47]
    v_mfma_f32_16x16x32_bf16 v[48:51], v[224:227], v[240:243], v[48:51]
    v_mfma_f32_16x16x32_bf16 v[52:55], v[228:231], v[240:243], v[52:55]
    v_mfma_f32_16x16x32_bf16 v[56:59], v[224:227], v[244:247], v[56:59]
    v_mfma_f32_16x16x32_bf16 v[60:63], v[228:231], v[244:247], v[60:63]
    s_nop 15
    s_nop 7
    s_waitcnt vmcnt(0)
    s_mov_b32 s59, 13467648
    v_lshlrev_b32 v82, 16, v82
    v_add_u32 v7, 0, v65
    v_cvt_pk_bf16_f32 v16, v32, v33
    v_lshlrev_b32 v17, 16, v16
    v_and_b32 v18, 0xffff0000, v16
    v_add_f32 v17, v17, v82
    v_add_f32 v18, v18, v82
    v_cvt_pk_bf16_f32 v16, v17, v18
    v_lshlrev_b32 v17, 16, v16
    v_and_b32 v18, 0xffff0000, v16
    v_lshlrev_b32 v19, 16, v66
    v_and_b32 v20, 0xffff0000, v66
    v_mul_f32 v17, v17, v19
    v_mul_f32 v18, v18, v20
    v_cvt_pk_bf16_f32 v66, v17, v18
    v_cvt_pk_bf16_f32 v16, v34, v35
    v_lshlrev_b32 v17, 16, v16
    v_and_b32 v18, 0xffff0000, v16
    v_add_f32 v17, v17, v82
    v_add_f32 v18, v18, v82
    v_cvt_pk_bf16_f32 v16, v17, v18
    v_lshlrev_b32 v17, 16, v16
    v_and_b32 v18, 0xffff0000, v16
    v_lshlrev_b32 v19, 16, v67
    v_and_b32 v20, 0xffff0000, v67
    v_mul_f32 v17, v17, v19
    v_mul_f32 v18, v18, v20
    v_cvt_pk_bf16_f32 v67, v17, v18
    buffer_store_dwordx2 v[66:67], v7, s[28:31], s59 offen offset:0
    v_cvt_pk_bf16_f32 v16, v36, v37
    v_lshlrev_b32 v17, 16, v16
    v_and_b32 v18, 0xffff0000, v16
    v_add_f32 v17, v17, v82
    v_add_f32 v18, v18, v82
    v_cvt_pk_bf16_f32 v16, v17, v18
    v_lshlrev_b32 v17, 16, v16
    v_and_b32 v18, 0xffff0000, v16
    v_lshlrev_b32 v19, 16, v68
    v_and_b32 v20, 0xffff0000, v68
    v_mul_f32 v17, v17, v19
    v_mul_f32 v18, v18, v20
    v_cvt_pk_bf16_f32 v68, v17, v18
    v_cvt_pk_bf16_f32 v16, v38, v39
    v_lshlrev_b32 v17, 16, v16
    v_and_b32 v18, 0xffff0000, v16
    v_add_f32 v17, v17, v82
    v_add_f32 v18, v18, v82
    v_cvt_pk_bf16_f32 v16, v17, v18
    v_lshlrev_b32 v17, 16, v16
    v_and_b32 v18, 0xffff0000, v16
    v_lshlrev_b32 v19, 16, v69
    v_and_b32 v20, 0xffff0000, v69
    v_mul_f32 v17, v17, v19
    v_mul_f32 v18, v18, v20
    v_cvt_pk_bf16_f32 v69, v17, v18
    buffer_store_dwordx2 v[68:69], v7, s[28:31], s59 offen offset:32
    v_lshlrev_b32 v83, 16, v83
    v_add_u32 v7, 28672, v65
    v_cvt_pk_bf16_f32 v16, v40, v41
    v_lshlrev_b32 v17, 16, v16
    v_and_b32 v18, 0xffff0000, v16
    v_add_f32 v17, v17, v83
    v_add_f32 v18, v18, v83
    v_cvt_pk_bf16_f32 v16, v17, v18
    v_lshlrev_b32 v17, 16, v16
    v_and_b32 v18, 0xffff0000, v16
    v_lshlrev_b32 v19, 16, v70
    v_and_b32 v20, 0xffff0000, v70
    v_mul_f32 v17, v17, v19
    v_mul_f32 v18, v18, v20
    v_cvt_pk_bf16_f32 v70, v17, v18
    v_cvt_pk_bf16_f32 v16, v42, v43
    v_lshlrev_b32 v17, 16, v16
    v_and_b32 v18, 0xffff0000, v16
    v_add_f32 v17, v17, v83
    v_add_f32 v18, v18, v83
    v_cvt_pk_bf16_f32 v16, v17, v18
    v_lshlrev_b32 v17, 16, v16
    v_and_b32 v18, 0xffff0000, v16
    v_lshlrev_b32 v19, 16, v71
    v_and_b32 v20, 0xffff0000, v71
    v_mul_f32 v17, v17, v19
    v_mul_f32 v18, v18, v20
    v_cvt_pk_bf16_f32 v71, v17, v18
    buffer_store_dwordx2 v[70:71], v7, s[28:31], s59 offen offset:0
    v_cvt_pk_bf16_f32 v16, v44, v45
    v_lshlrev_b32 v17, 16, v16
    v_and_b32 v18, 0xffff0000, v16
    v_add_f32 v17, v17, v83
    v_add_f32 v18, v18, v83
    v_cvt_pk_bf16_f32 v16, v17, v18
    v_lshlrev_b32 v17, 16, v16
    v_and_b32 v18, 0xffff0000, v16
    v_lshlrev_b32 v19, 16, v72
    v_and_b32 v20, 0xffff0000, v72
    v_mul_f32 v17, v17, v19
    v_mul_f32 v18, v18, v20
    v_cvt_pk_bf16_f32 v72, v17, v18
    v_cvt_pk_bf16_f32 v16, v46, v47
    v_lshlrev_b32 v17, 16, v16
    v_and_b32 v18, 0xffff0000, v16
    v_add_f32 v17, v17, v83
    v_add_f32 v18, v18, v83
    v_cvt_pk_bf16_f32 v16, v17, v18
    v_lshlrev_b32 v17, 16, v16
    v_and_b32 v18, 0xffff0000, v16
    v_lshlrev_b32 v19, 16, v73
    v_and_b32 v20, 0xffff0000, v73
    v_mul_f32 v17, v17, v19
    v_mul_f32 v18, v18, v20
    v_cvt_pk_bf16_f32 v73, v17, v18
    buffer_store_dwordx2 v[72:73], v7, s[28:31], s59 offen offset:32
    v_lshlrev_b32 v84, 16, v84
    v_add_u32 v7, 57344, v65
    v_cvt_pk_bf16_f32 v16, v48, v49
    v_lshlrev_b32 v17, 16, v16
    v_and_b32 v18, 0xffff0000, v16
    v_add_f32 v17, v17, v84
    v_add_f32 v18, v18, v84
    v_cvt_pk_bf16_f32 v16, v17, v18
    v_lshlrev_b32 v17, 16, v16
    v_and_b32 v18, 0xffff0000, v16
    v_lshlrev_b32 v19, 16, v74
    v_and_b32 v20, 0xffff0000, v74
    v_mul_f32 v17, v17, v19
    v_mul_f32 v18, v18, v20
    v_cvt_pk_bf16_f32 v74, v17, v18
    v_cvt_pk_bf16_f32 v16, v50, v51
    v_lshlrev_b32 v17, 16, v16
    v_and_b32 v18, 0xffff0000, v16
    v_add_f32 v17, v17, v84
    v_add_f32 v18, v18, v84
    v_cvt_pk_bf16_f32 v16, v17, v18
    v_lshlrev_b32 v17, 16, v16
    v_and_b32 v18, 0xffff0000, v16
    v_lshlrev_b32 v19, 16, v75
    v_and_b32 v20, 0xffff0000, v75
    v_mul_f32 v17, v17, v19
    v_mul_f32 v18, v18, v20
    v_cvt_pk_bf16_f32 v75, v17, v18
    buffer_store_dwordx2 v[74:75], v7, s[28:31], s59 offen offset:0
    v_cvt_pk_bf16_f32 v16, v52, v53
    v_lshlrev_b32 v17, 16, v16
    v_and_b32 v18, 0xffff0000, v16
    v_add_f32 v17, v17, v84
    v_add_f32 v18, v18, v84
    v_cvt_pk_bf16_f32 v16, v17, v18
    v_lshlrev_b32 v17, 16, v16
    v_and_b32 v18, 0xffff0000, v16
    v_lshlrev_b32 v19, 16, v76
    v_and_b32 v20, 0xffff0000, v76
    v_mul_f32 v17, v17, v19
    v_mul_f32 v18, v18, v20
    v_cvt_pk_bf16_f32 v76, v17, v18
    v_cvt_pk_bf16_f32 v16, v54, v55
    v_lshlrev_b32 v17, 16, v16
    v_and_b32 v18, 0xffff0000, v16
    v_add_f32 v17, v17, v84
    v_add_f32 v18, v18, v84
    v_cvt_pk_bf16_f32 v16, v17, v18
    v_lshlrev_b32 v17, 16, v16
    v_and_b32 v18, 0xffff0000, v16
    v_lshlrev_b32 v19, 16, v77
    v_and_b32 v20, 0xffff0000, v77
    v_mul_f32 v17, v17, v19
    v_mul_f32 v18, v18, v20
    v_cvt_pk_bf16_f32 v77, v17, v18
    buffer_store_dwordx2 v[76:77], v7, s[28:31], s59 offen offset:32
    v_lshlrev_b32 v85, 16, v85
    v_add_u32 v7, 86016, v65
    v_cvt_pk_bf16_f32 v16, v56, v57
    v_lshlrev_b32 v17, 16, v16
    v_and_b32 v18, 0xffff0000, v16
    v_add_f32 v17, v17, v85
    v_add_f32 v18, v18, v85
    v_cvt_pk_bf16_f32 v16, v17, v18
    v_lshlrev_b32 v17, 16, v16
    v_and_b32 v18, 0xffff0000, v16
    v_lshlrev_b32 v19, 16, v78
    v_and_b32 v20, 0xffff0000, v78
    v_mul_f32 v17, v17, v19
    v_mul_f32 v18, v18, v20
    v_cvt_pk_bf16_f32 v78, v17, v18
    v_cvt_pk_bf16_f32 v16, v58, v59
    v_lshlrev_b32 v17, 16, v16
    v_and_b32 v18, 0xffff0000, v16
    v_add_f32 v17, v17, v85
    v_add_f32 v18, v18, v85
    v_cvt_pk_bf16_f32 v16, v17, v18
    v_lshlrev_b32 v17, 16, v16
    v_and_b32 v18, 0xffff0000, v16
    v_lshlrev_b32 v19, 16, v79
    v_and_b32 v20, 0xffff0000, v79
    v_mul_f32 v17, v17, v19
    v_mul_f32 v18, v18, v20
    v_cvt_pk_bf16_f32 v79, v17, v18
    buffer_store_dwordx2 v[78:79], v7, s[28:31], s59 offen offset:0
    v_cvt_pk_bf16_f32 v16, v60, v61
    v_lshlrev_b32 v17, 16, v16
    v_and_b32 v18, 0xffff0000, v16
    v_add_f32 v17, v17, v85
    v_add_f32 v18, v18, v85
    v_cvt_pk_bf16_f32 v16, v17, v18
    v_lshlrev_b32 v17, 16, v16
    v_and_b32 v18, 0xffff0000, v16
    v_lshlrev_b32 v19, 16, v80
    v_and_b32 v20, 0xffff0000, v80
    v_mul_f32 v17, v17, v19
    v_mul_f32 v18, v18, v20
    v_cvt_pk_bf16_f32 v80, v17, v18
    v_cvt_pk_bf16_f32 v16, v62, v63
    v_lshlrev_b32 v17, 16, v16
    v_and_b32 v18, 0xffff0000, v16
    v_add_f32 v17, v17, v85
    v_add_f32 v18, v18, v85
    v_cvt_pk_bf16_f32 v16, v17, v18
    v_lshlrev_b32 v17, 16, v16
    v_and_b32 v18, 0xffff0000, v16
    v_lshlrev_b32 v19, 16, v81
    v_and_b32 v20, 0xffff0000, v81
    v_mul_f32 v17, v17, v19
    v_mul_f32 v18, v18, v20
    v_cvt_pk_bf16_f32 v81, v17, v18
    buffer_store_dwordx2 v[80:81], v7, s[28:31], s59 offen offset:32
    s_waitcnt vmcnt(0)
K3_END:
    s_endpgm
.globl k4_gemm3_kernel
.p2align 8
.type k4_gemm3_kernel,@function
k4_gemm3_kernel:
    s_cmp_ge_u32 s2, 224
    s_cbranch_scc1 K4_END
    s_load_dwordx2 s[14:15], s[0:1], 120
    s_load_dwordx2 s[6:7], s[0:1], 104
    s_lshr_b32 s40, s2, 3
    s_mul_i32 s41, s40, 37
    s_lshr_b32 s41, s41, 8
    s_mul_i32 s42, s41, 7
    s_sub_u32 s43, s40, s42
    s_and_b32 s40, s2, 7
    s_lshl_b32 s40, s40, 2
    s_add_u32 s40, s40, s41
    s_lshl_b32 s42, s40, 6
    s_lshl_b32 s43, s43, 6
    s_waitcnt lgkmcnt(0)
    s_mov_b32 s28, s14
    s_and_b32 s29, s15, 0xffff
    s_mov_b32 s30, 268435456
    s_mov_b32 s31, 0x00020000
    v_lshrrev_b32 v1, 3, v0
    v_and_b32 v2, 7, v0
    v_lshlrev_b32 v2, 4, v2
    v_add_u32 v3, s43, v1
    v_mul_u32_u24 v3, 1792, v3
    v_add_u32 v3, v3, v2
    v_add_u32 v4, 57344, v3
    v_add_u32 v5, s42, v1
    v_mul_u32_u24 v5, 1792, v5
    v_add_u32 v5, v5, v2
    v_add_u32 v6, 57344, v5
    s_mov_b32 s44, 3457024
    s_mov_b32 s45, 13467648
    v_mul_u32_u24 v9, 144, v1
    v_add_u32 v9, v9, v2
    v_add_u32 v64, 0x8000, v9
    v_lshrrev_b32 v11, 6, v0
    s_nop 0
    v_readfirstlane_b32 s54, v11
    s_and_b32 s55, s54, 1
    s_lshr_b32 s56, s54, 1
    v_and_b32 v11, 63, v0
    v_and_b32 v12, 15, v11
    v_lshrrev_b32 v13, 4, v11
    s_mul_i32 s57, s55, 32
    s_add_u32 s57, s57, s42
    v_add_u32 v14, s57, v12
    s_lshl_b32 s57, s56, 5
    s_add_u32 s57, s57, s43
    v_lshlrev_b32 v15, 2, v13
    v_add_u32 v15, s57, v15
    buffer_load_dwordx4 v[96:99], v3, s[28:31], s44 offen
    buffer_load_dwordx4 v[100:103], v4, s[28:31], s44 offen
    buffer_load_dwordx4 v[104:107], v5, s[28:31], s45 offen
    buffer_load_dwordx4 v[108:111], v6, s[28:31], s45 offen
    s_add_u32 s44, s44, 128
    s_add_u32 s45, s45, 128
    buffer_load_dwordx4 v[112:115], v3, s[28:31], s44 offen
    buffer_load_dwordx4 v[116:119], v4, s[28:31], s44 offen
    buffer_load_dwordx4 v[120:123], v5, s[28:31], s45 offen
    buffer_load_dwordx4 v[124:127], v6, s[28:31], s45 offen
    s_add_u32 s44, s44, 128
    s_add_u32 s45, s45, 128
    buffer_load_dwordx4 v[128:131], v3, s[28:31], s44 offen
    buffer_load_dwordx4 v[132:135], v4, s[28:31], s44 offen
    buffer_load_dwordx4 v[136:139], v5, s[28:31], s45 offen
    buffer_load_dwordx4 v[140:143], v6, s[28:31], s45 offen
    s_add_u32 s44, s44, 128
    s_add_u32 s45, s45, 128
    buffer_load_dwordx4 v[144:147], v3, s[28:31], s44 offen
    buffer_load_dwordx4 v[148:151], v4, s[28:31], s44 offen
    buffer_load_dwordx4 v[152:155], v5, s[28:31], s45 offen
    buffer_load_dwordx4 v[156:159], v6, s[28:31], s45 offen
    s_add_u32 s44, s44, 128
    s_add_u32 s45, s45, 128
    s_mov_b32 s20, s6
    s_and_b32 s21, s7, 0xffff
    s_mov_b32 s22, 1835008
    s_mov_b32 s23, 0x00020000
    v_lshlrev_b32 v65, 2, v15
    s_movk_i32 s59, 8960
    buffer_load_dwordx4 v[82:85], v65, s[28:31], s59 offen offset:0
    buffer_load_dwordx4 v[86:89], v65, s[28:31], s59 offen offset:64
    v_mul_u32_u24 v65, 896, v14
    v_lshlrev_b32 v15, 1, v15
    v_add_u32 v65, v65, v15
    s_mov_b32 s58, 4259840
    v_add_u32 v15, 0, v65
    buffer_load_dwordx2 v[66:67], v15, s[28:31], s58 offen offset:0
    buffer_load_dwordx2 v[68:69], v15, s[28:31], s58 offen offset:32
    v_add_u32 v15, 14336, v65
    buffer_load_dwordx2 v[70:71], v15, s[28:31], s58 offen offset:0
    buffer_load_dwordx2 v[72:73], v15, s[28:31], s58 offen offset:32
    s_waitcnt vmcnt(18)
    ds_write_b128 v9, v[96:99] offset:0
    ds_write_b128 v9, v[100:103] offset:4608
    ds_write_b128 v9, v[104:107] offset:9216
    ds_write_b128 v9, v[108:111] offset:13824
    v_mul_u32_u24 v14, 144, v12
    v_lshlrev_b32 v15, 4, v13
    v_add_u32 v14, v14, v15
    s_mul_i32 s57, s56, 4608
    v_add_u32 v15, s57, v14
    s_mul_i32 s57, s55, 4608
    s_add_u32 s57, s57, 9216
    v_add_u32 v14, s57, v14
    v_mov_b32 v12, v15
    v_mov_b32 v32, 0
    v_mov_b32 v33, 0
    v_mov_b32 v34, 0
    v_mov_b32 v35, 0
    v_mov_b32 v36, 0
    v_mov_b32 v37, 0
    v_mov_b32 v38, 0
    v_mov_b32 v39, 0
    v_mov_b32 v40, 0
    v_mov_b32 v41, 0
    v_mov_b32 v42, 0
    v_mov_b32 v43, 0
    v_mov_b32 v44, 0
    v_mov_b32 v45, 0
    v_mov_b32 v46, 0
    v_mov_b32 v47, 0
    s_waitcnt lgkmcnt(0)
    s_barrier
    ds_read_b128 v[200:203], v12 offset:0
    ds_read_b128 v[204:207], v12 offset:2304
    ds_read_b128 v[208:211], v14 offset:0
    ds_read_b128 v[212:215], v14 offset:2304
    buffer_load_dwordx4 v[96:99], v3, s[28:31], s44 offen
    buffer_load_dwordx4 v[100:103], v4, s[28:31], s44 offen
    buffer_load_dwordx4 v[104:107], v5, s[28:31], s45 offen
    buffer_load_dwordx4 v[108:111], v6, s[28:31], s45 offen
    s_add_u32 s44, s44, 128
    s_add_u32 s45, s45, 128
    s_waitcnt vmcnt(12) lgkmcnt(0)
    ds_write_b128 v9, v[112:115] offset:18432
    ds_write_b128 v9, v[116:119] offset:23040
    ds_write_b128 v9, v[120:123] offset:27648
    ds_write_b128 v9, v[124:127] offset:32256
    ds_read_b128 v[224:227], v12 offset:64
    ds_read_b128 v[228:231], v12 offset:2368
    ds_read_b128 v[232:235], v14 offset:64
    ds_read_b128 v[236:239], v14 offset:2368
    s_waitcnt lgkmcnt(8)
    v_mfma_f32_16x16x32_bf16 v[32:35], v[200:203], v[208:211], v[32:35]
    v_mfma_f32_16x16x32_bf16 v[36:39], v[204:207], v[208:211], v[36:39]
    v_mfma_f32_16x16x32_bf16 v[40:43], v[200:203], v[212:215], v[40:43]
    v_mfma_f32_16x16x32_bf16 v[44:47], v[204:207], v[212:215], v[44:47]
    s_waitcnt lgkmcnt(0)
    s_barrier
    ds_read_b128 v[200:203], v12 offset:18432
    ds_read_b128 v[204:207], v12 offset:20736
    ds_read_b128 v[208:211], v14 offset:18432
    ds_read_b128 v[212:215], v14 offset:20736
    buffer_load_dwordx4 v[112:115], v3, s[28:31], s44 offen
    buffer_load_dwordx4 v[116:119], v4, s[28:31], s44 offen
    buffer_load_dwordx4 v[120:123], v5, s[28:31], s45 offen
    buffer_load_dwordx4 v[124:127], v6, s[28:31], s45 offen
    s_add_u32 s44, s44, 128
    s_add_u32 s45, s45, 128
    v_mfma_f32_16x16x32_bf16 v[32:35], v[224:227], v[232:235], v[32:35]
    v_mfma_f32_16x16x32_bf16 v[36:39], v[228:231], v[232:235], v[36:39]
    s_waitcnt vmcnt(12) lgkmcnt(0)
    v_mfma_f32_16x16x32_bf16 v[40:43], v[224:227], v[236:239], v[40:43]
    v_mfma_f32_16x16x32_bf16 v[44:47], v[228:231], v[236:239], v[44:47]
    ds_write_b128 v9, v[128:131] offset:0
    ds_write_b128 v9, v[132:135] offset:4608
    ds_write_b128 v9, v[136:139] offset:9216
    ds_write_b128 v9, v[140:143] offset:13824
    ds_read_b128 v[224:227], v12 offset:18496
    ds_read_b128 v[228:231], v12 offset:20800
    ds_read_b128 v[232:235], v14 offset:18496
    ds_read_b128 v[236:239], v14 offset:20800
    s_waitcnt lgkmcnt(8)
    v_mfma_f32_16x16x32_bf16 v[32:35], v[200:203], v[208:211], v[32:35]
    v_mfma_f32_16x16x32_bf16 v[36:39], v[204:207], v[208:211], v[36:39]
    v_mfma_f32_16x16x32_bf16 v[40:43], v[200:203], v[212:215], v[40:43]
    v_mfma_f32_16x16x32_bf16 v[44:47], v[204:207], v[212:215], v[44:47]
    s_waitcnt lgkmcnt(0)
    s_barrier
    ds_read_b128 v[200:203], v12 offset:0
    ds_read_b128 v[204:207], v12 offset:2304
    ds_read_b128 v[208:211], v14 offset:0
    ds_read_b128 v[212:215], v14 offset:2304
    buffer_load_dwordx4 v[128:131], v3, s[28:31], s44 offen
    buffer_load_dwordx4 v[132:135], v4, s[28:31], s44 offen
    buffer_load_dwordx4 v[136:139], v5, s[28:31], s45 offen
    buffer_load_dwordx4 v[140:143], v6, s[28:31], s45 offen
    s_add_u32 s44, s44, 128
    s_add_u32 s45, s45, 128
    v_mfma_f32_16x16x32_bf16 v[32:35], v[224:227], v[232:235], v[32:35]
    v_mfma_f32_16x16x32_bf16 v[36:39], v[228:231], v[232:235], v[36:39]
    s_waitcnt vmcnt(12) lgkmcnt(0)
    v_mfma_f32_16x16x32_bf16 v[40:43], v[224:227], v[236:239], v[40:43]
    v_mfma_f32_16x16x32_bf16 v[44:47], v[228:231], v[236:239], v[44:47]
    ds_write_b128 v9, v[144:147] offset:18432
    ds_write_b128 v9, v[148:151] offset:23040
    ds_write_b128 v9, v[152:155] offset:27648
    ds_write_b128 v9, v[156:159] offset:32256
    ds_read_b128 v[224:227], v12 offset:64
    ds_read_b128 v[228:231], v12 offset:2368
    ds_read_b128 v[232:235], v14 offset:64
    ds_read_b128 v[236:239], v14 offset:2368
    s_waitcnt lgkmcnt(8)
    v_mfma_f32_16x16x32_bf16 v[32:35], v[200:203], v[208:211], v[32:35]
    v_mfma_f32_16x16x32_bf16 v[36:39], v[204:207], v[208:211], v[36:39]
    v_mfma_f32_16x16x32_bf16 v[40:43], v[200:203], v[212:215], v[40:43]
    v_mfma_f32_16x16x32_bf16 v[44:47], v[204:207], v[212:215], v[44:47]
    s_waitcnt lgkmcnt(0)
    s_barrier
    ds_read_b128 v[200:203], v12 offset:18432
    ds_read_b128 v[204:207], v12 offset:20736
    ds_read_b128 v[208:211], v14 offset:18432
    ds_read_b128 v[212:215], v14 offset:20736
    buffer_load_dwordx4 v[144:147], v3, s[28:31], s44 offen
    buffer_load_dwordx4 v[148:151], v4, s[28:31], s44 offen
    buffer_load_dwordx4 v[152:155], v5, s[28:31], s45 offen
    buffer_load_dwordx4 v[156:159], v6, s[28:31], s45 offen
    s_add_u32 s44, s44, 128
    s_add_u32 s45, s45, 128
    v_mfma_f32_16x16x32_bf16 v[32:35], v[224:227], v[232:235], v[32:35]
    v_mfma_f32_16x16x32_bf16 v[36:39], v[228:231], v[232:235], v[36:39]
    s_waitcnt vmcnt(12) lgkmcnt(0)
    v_mfma_f32_16x16x32_bf16 v[40:43], v[224:227], v[236:239], v[40:43]
    v_mfma_f32_16x16x32_bf16 v[44:47], v[228:231], v[236:239], v[44:47]
    ds_write_b128 v9, v[96:99] offset:0
    ds_write_b128 v9, v[100:103] offset:4608
    ds_write_b128 v9, v[104:107] offset:9216
    ds_write_b128 v9, v[108:111] offset:13824
    ds_read_b128 v[224:227], v12 offset:18496
    ds_read_b128 v[228:231], v12 offset:20800
    ds_read_b128 v[232:235], v14 offset:18496
    ds_read_b128 v[236:239], v14 offset:20800
    s_waitcnt lgkmcnt(8)
    v_mfma_f32_16x16x32_bf16 v[32:35], v[200:203], v[208:211], v[32:35]
    v_mfma_f32_16x16x32_bf16 v[36:39], v[204:207], v[208:211], v[36:39]
    v_mfma_f32_16x16x32_bf16 v[40:43], v[200:203], v[212:215], v[40:43]
    v_mfma_f32_16x16x32_bf16 v[44:47], v[204:207], v[212:215], v[44:47]
    s_waitcnt lgkmcnt(0)
    s_barrier
    ds_read_b128 v[200:203], v12 offset:0
    ds_read_b128 v[204:207], v12 offset:2304
    ds_read_b128 v[208:211], v14 offset:0
    ds_read_b128 v[212:215], v14 offset:2304
    buffer_load_dwordx4 v[96:99], v3, s[28:31], s44 offen
    buffer_load_dwordx4 v[100:103], v4, s[28:31], s44 offen
    buffer_load_dwordx4 v[104:107], v5, s[28:31], s45 offen
    buffer_load_dwordx4 v[108:111], v6, s[28:31], s45 offen
    s_add_u32 s44, s44, 128
    s_add_u32 s45, s45, 128
    v_mfma_f32_16x16x32_bf16 v[32:35], v[224:227], v[232:235], v[32:35]
    v_mfma_f32_16x16x32_bf16 v[36:39], v[228:231], v[232:235], v[36:39]
    s_waitcnt vmcnt(12) lgkmcnt(0)
    v_mfma_f32_16x16x32_bf16 v[40:43], v[224:227], v[236:239], v[40:43]
    v_mfma_f32_16x16x32_bf16 v[44:47], v[228:231], v[236:239], v[44:47]
    ds_write_b128 v9, v[112:115] offset:18432
    ds_write_b128 v9, v[116:119] offset:23040
    ds_write_b128 v9, v[120:123] offset:27648
    ds_write_b128 v9, v[124:127] offset:32256
    ds_read_b128 v[224:227], v12 offset:64
    ds_read_b128 v[228:231], v12 offset:2368
    ds_read_b128 v[232:235], v14 offset:64
    ds_read_b128 v[236:239], v14 offset:2368
    s_waitcnt lgkmcnt(8)
    v_mfma_f32_16x16x32_bf16 v[32:35], v[200:203], v[208:211], v[32:35]
    v_mfma_f32_16x16x32_bf16 v[36:39], v[204:207], v[208:211], v[36:39]
    v_mfma_f32_16x16x32_bf16 v[40:43], v[200:203], v[212:215], v[40:43]
    v_mfma_f32_16x16x32_bf16 v[44:47], v[204:207], v[212:215], v[44:47]
    s_waitcnt lgkmcnt(0)
    s_barrier
    ds_read_b128 v[200:203], v12 offset:18432
    ds_read_b128 v[204:207], v12 offset:20736
    ds_read_b128 v[208:211], v14 offset:18432
    ds_read_b128 v[212:215], v14 offset:20736
    buffer_load_dwordx4 v[112:115], v3, s[28:31], s44 offen
    buffer_load_dwordx4 v[116:119], v4, s[28:31], s44 offen
    buffer_load_dwordx4 v[120:123], v5, s[28:31], s45 offen
    buffer_load_dwordx4 v[124:127], v6, s[28:31], s45 offen
    s_add_u32 s44, s44, 128
    s_add_u32 s45, s45, 128
    v_mfma_f32_16x16x32_bf16 v[32:35], v[224:227], v[232:235], v[32:35]
    v_mfma_f32_16x16x32_bf16 v[36:39], v[228:231], v[232:235], v[36:39]
    s_waitcnt vmcnt(12) lgkmcnt(0)
    v_mfma_f32_16x16x32_bf16 v[40:43], v[224:227], v[236:239], v[40:43]
    v_mfma_f32_16x16x32_bf16 v[44:47], v[228:231], v[236:239], v[44:47]
    ds_write_b128 v9, v[128:131] offset:0
    ds_write_b128 v9, v[132:135] offset:4608
    ds_write_b128 v9, v[136:139] offset:9216
    ds_write_b128 v9, v[140:143] offset:13824
    ds_read_b128 v[224:227], v12 offset:18496
    ds_read_b128 v[228:231], v12 offset:20800
    ds_read_b128 v[232:235], v14 offset:18496
    ds_read_b128 v[236:239], v14 offset:20800
    s_waitcnt lgkmcnt(8)
    v_mfma_f32_16x16x32_bf16 v[32:35], v[200:203], v[208:211], v[32:35]
    v_mfma_f32_16x16x32_bf16 v[36:39], v[204:207], v[208:211], v[36:39]
    v_mfma_f32_16x16x32_bf16 v[40:43], v[200:203], v[212:215], v[40:43]
    v_mfma_f32_16x16x32_bf16 v[44:47], v[204:207], v[212:215], v[44:47]
    s_waitcnt lgkmcnt(0)
    s_barrier
    ds_read_b128 v[200:203], v12 offset:0
    ds_read_b128 v[204:207], v12 offset:2304
    ds_read_b128 v[208:211], v14 offset:0
    ds_read_b128 v[212:215], v14 offset:2304
    buffer_load_dwordx4 v[128:131], v3, s[28:31], s44 offen
    buffer_load_dwordx4 v[132:135], v4, s[28:31], s44 offen
    buffer_load_dwordx4 v[136:139], v5, s[28:31], s45 offen
    buffer_load_dwordx4 v[140:143], v6, s[28:31], s45 offen
    s_add_u32 s44, s44, 128
    s_add_u32 s45, s45, 128
    v_mfma_f32_16x16x32_bf16 v[32:35], v[224:227], v[232:235], v[32:35]
    v_mfma_f32_16x16x32_bf16 v[36:39], v[228:231], v[232:235], v[36:39]
    s_waitcnt vmcnt(12) lgkmcnt(0)
    v_mfma_f32_16x16x32_bf16 v[40:43], v[224:227], v[236:239], v[40:43]
    v_mfma_f32_16x16x32_bf16 v[44:47], v[228:231], v[236:239], v[44:47]
    ds_write_b128 v9, v[144:147] offset:18432
    ds_write_b128 v9, v[148:151] offset:23040
    ds_write_b128 v9, v[152:155] offset:27648
    ds_write_b128 v9, v[156:159] offset:32256
    ds_read_b128 v[224:227], v12 offset:64
    ds_read_b128 v[228:231], v12 offset:2368
    ds_read_b128 v[232:235], v14 offset:64
    ds_read_b128 v[236:239], v14 offset:2368
    s_waitcnt lgkmcnt(8)
    v_mfma_f32_16x16x32_bf16 v[32:35], v[200:203], v[208:211], v[32:35]
    v_mfma_f32_16x16x32_bf16 v[36:39], v[204:207], v[208:211], v[36:39]
    v_mfma_f32_16x16x32_bf16 v[40:43], v[200:203], v[212:215], v[40:43]
    v_mfma_f32_16x16x32_bf16 v[44:47], v[204:207], v[212:215], v[44:47]
    s_waitcnt lgkmcnt(0)
    s_barrier
    ds_read_b128 v[200:203], v12 offset:18432
    ds_read_b128 v[204:207], v12 offset:20736
    ds_read_b128 v[208:211], v14 offset:18432
    ds_read_b128 v[212:215], v14 offset:20736
    buffer_load_dwordx4 v[144:147], v3, s[28:31], s44 offen
    buffer_load_dwordx4 v[148:151], v4, s[28:31], s44 offen
    buffer_load_dwordx4 v[152:155], v5, s[28:31], s45 offen
    buffer_load_dwordx4 v[156:159], v6, s[28:31], s45 offen
    s_add_u32 s44, s44, 128
    s_add_u32 s45, s45, 128
    v_mfma_f32_16x16x32_bf16 v[32:35], v[224:227], v[232:235], v[32:35]
    v_mfma_f32_16x16x32_bf16 v[36:39], v[228:231], v[232:235], v[36:39]
    s_waitcnt vmcnt(12) lgkmcnt(0)
    v_mfma_f32_16x16x32_bf16 v[40:43], v[224:227], v[236:239], v[40:43]
    v_mfma_f32_16x16x32_bf16 v[44:47], v[228:231], v[236:239], v[44:47]
    ds_write_b128 v9, v[96:99] offset:0
    ds_write_b128 v9, v[100:103] offset:4608
    ds_write_b128 v9, v[104:107] offset:9216
    ds_write_b128 v9, v[108:111] offset:13824
    ds_read_b128 v[224:227], v12 offset:18496
    ds_read_b128 v[228:231], v12 offset:20800
    ds_read_b128 v[232:235], v14 offset:18496
    ds_read_b128 v[236:239], v14 offset:20800
    s_waitcnt lgkmcnt(8)
    v_mfma_f32_16x16x32_bf16 v[32:35], v[200:203], v[208:211], v[32:35]
    v_mfma_f32_16x16x32_bf16 v[36:39], v[204:207], v[208:211], v[36:39]
    v_mfma_f32_16x16x32_bf16 v[40:43], v[200:203], v[212:215], v[40:43]
    v_mfma_f32_16x16x32_bf16 v[44:47], v[204:207], v[212:215], v[44:47]
    s_waitcnt lgkmcnt(0)
    s_barrier
    ds_read_b128 v[200:203], v12 offset:0
    ds_read_b128 v[204:207], v12 offset:2304
    ds_read_b128 v[208:211], v14 offset:0
    ds_read_b128 v[212:215], v14 offset:2304
    buffer_load_dwordx4 v[96:99], v3, s[28:31], s44 offen
    buffer_load_dwordx4 v[100:103], v4, s[28:31], s44 offen
    buffer_load_dwordx4 v[104:107], v5, s[28:31], s45 offen
    buffer_load_dwordx4 v[108:111], v6, s[28:31], s45 offen
    s_add_u32 s44, s44, 128
    s_add_u32 s45, s45, 128
    v_mfma_f32_16x16x32_bf16 v[32:35], v[224:227], v[232:235], v[32:35]
    v_mfma_f32_16x16x32_bf16 v[36:39], v[228:231], v[232:235], v[36:39]
    s_waitcnt vmcnt(12) lgkmcnt(0)
    v_mfma_f32_16x16x32_bf16 v[40:43], v[224:227], v[236:239], v[40:43]
    v_mfma_f32_16x16x32_bf16 v[44:47], v[228:231], v[236:239], v[44:47]
    ds_write_b128 v9, v[112:115] offset:18432
    ds_write_b128 v9, v[116:119] offset:23040
    ds_write_b128 v9, v[120:123] offset:27648
    ds_write_b128 v9, v[124:127] offset:32256
    ds_read_b128 v[224:227], v12 offset:64
    ds_read_b128 v[228:231], v12 offset:2368
    ds_read_b128 v[232:235], v14 offset:64
    ds_read_b128 v[236:239], v14 offset:2368
    s_waitcnt lgkmcnt(8)
    v_mfma_f32_16x16x32_bf16 v[32:35], v[200:203], v[208:211], v[32:35]
    v_mfma_f32_16x16x32_bf16 v[36:39], v[204:207], v[208:211], v[36:39]
    v_mfma_f32_16x16x32_bf16 v[40:43], v[200:203], v[212:215], v[40:43]
    v_mfma_f32_16x16x32_bf16 v[44:47], v[204:207], v[212:215], v[44:47]
    s_waitcnt lgkmcnt(0)
    s_barrier
    ds_read_b128 v[200:203], v12 offset:18432
    ds_read_b128 v[204:207], v12 offset:20736
    ds_read_b128 v[208:211], v14 offset:18432
    ds_read_b128 v[212:215], v14 offset:20736
    buffer_load_dwordx4 v[112:115], v3, s[28:31], s44 offen
    buffer_load_dwordx4 v[116:119], v4, s[28:31], s44 offen
    buffer_load_dwordx4 v[120:123], v5, s[28:31], s45 offen
    buffer_load_dwordx4 v[124:127], v6, s[28:31], s45 offen
    s_add_u32 s44, s44, 128
    s_add_u32 s45, s45, 128
    v_mfma_f32_16x16x32_bf16 v[32:35], v[224:227], v[232:235], v[32:35]
    v_mfma_f32_16x16x32_bf16 v[36:39], v[228:231], v[232:235], v[36:39]
    s_waitcnt vmcnt(12) lgkmcnt(0)
    v_mfma_f32_16x16x32_bf16 v[40:43], v[224:227], v[236:239], v[40:43]
    v_mfma_f32_16x16x32_bf16 v[44:47], v[228:231], v[236:239], v[44:47]
    ds_write_b128 v9, v[128:131] offset:0
    ds_write_b128 v9, v[132:135] offset:4608
    ds_write_b128 v9, v[136:139] offset:9216
    ds_write_b128 v9, v[140:143] offset:13824
    ds_read_b128 v[224:227], v12 offset:18496
    ds_read_b128 v[228:231], v12 offset:20800
    ds_read_b128 v[232:235], v14 offset:18496
    ds_read_b128 v[236:239], v14 offset:20800
    s_waitcnt lgkmcnt(8)
    v_mfma_f32_16x16x32_bf16 v[32:35], v[200:203], v[208:211], v[32:35]
    v_mfma_f32_16x16x32_bf16 v[36:39], v[204:207], v[208:211], v[36:39]
    v_mfma_f32_16x16x32_bf16 v[40:43], v[200:203], v[212:215], v[40:43]
    v_mfma_f32_16x16x32_bf16 v[44:47], v[204:207], v[212:215], v[44:47]
    s_waitcnt lgkmcnt(0)
    s_barrier
    ds_read_b128 v[200:203], v12 offset:0
    ds_read_b128 v[204:207], v12 offset:2304
    ds_read_b128 v[208:211], v14 offset:0
    ds_read_b128 v[212:215], v14 offset:2304
    v_mfma_f32_16x16x32_bf16 v[32:35], v[224:227], v[232:235], v[32:35]
    v_mfma_f32_16x16x32_bf16 v[36:39], v[228:231], v[232:235], v[36:39]
    s_waitcnt vmcnt(8) lgkmcnt(0)
    v_mfma_f32_16x16x32_bf16 v[40:43], v[224:227], v[236:239], v[40:43]
    v_mfma_f32_16x16x32_bf16 v[44:47], v[228:231], v[236:239], v[44:47]
    ds_write_b128 v9, v[144:147] offset:18432
    ds_write_b128 v9, v[148:151] offset:23040
    ds_write_b128 v9, v[152:155] offset:27648
    ds_write_b128 v9, v[156:159] offset:32256
    ds_read_b128 v[224:227], v12 offset:64
    ds_read_b128 v[228:231], v12 offset:2368
    ds_read_b128 v[232:235], v14 offset:64
    ds_read_b128 v[236:239], v14 offset:2368
    s_waitcnt lgkmcnt(8)
    v_mfma_f32_16x16x32_bf16 v[32:35], v[200:203], v[208:211], v[32:35]
    v_mfma_f32_16x16x32_bf16 v[36:39], v[204:207], v[208:211], v[36:39]
    v_mfma_f32_16x16x32_bf16 v[40:43], v[200:203], v[212:215], v[40:43]
    v_mfma_f32_16x16x32_bf16 v[44:47], v[204:207], v[212:215], v[44:47]
    s_waitcnt lgkmcnt(0)
    s_barrier
    ds_read_b128 v[200:203], v12 offset:18432
    ds_read_b128 v[204:207], v12 offset:20736
    ds_read_b128 v[208:211], v14 offset:18432
    ds_read_b128 v[212:215], v14 offset:20736
    v_mfma_f32_16x16x32_bf16 v[32:35], v[224:227], v[232:235], v[32:35]
    v_mfma_f32_16x16x32_bf16 v[36:39], v[228:231], v[232:235], v[36:39]
    s_waitcnt vmcnt(4) lgkmcnt(0)
    v_mfma_f32_16x16x32_bf16 v[40:43], v[224:227], v[236:239], v[40:43]
    v_mfma_f32_16x16x32_bf16 v[44:47], v[228:231], v[236:239], v[44:47]
    ds_write_b128 v9, v[96:99] offset:0
    ds_write_b128 v9, v[100:103] offset:4608
    ds_write_b128 v9, v[104:107] offset:9216
    ds_write_b128 v9, v[108:111] offset:13824
    ds_read_b128 v[224:227], v12 offset:18496
    ds_read_b128 v[228:231], v12 offset:20800
    ds_read_b128 v[232:235], v14 offset:18496
    ds_read_b128 v[236:239], v14 offset:20800
    s_waitcnt lgkmcnt(8)
    v_mfma_f32_16x16x32_bf16 v[32:35], v[200:203], v[208:211], v[32:35]
    v_mfma_f32_16x16x32_bf16 v[36:39], v[204:207], v[208:211], v[36:39]
    v_mfma_f32_16x16x32_bf16 v[40:43], v[200:203], v[212:215], v[40:43]
    v_mfma_f32_16x16x32_bf16 v[44:47], v[204:207], v[212:215], v[44:47]
    s_waitcnt lgkmcnt(0)
    s_barrier
    ds_read_b128 v[200:203], v12 offset:0
    ds_read_b128 v[204:207], v12 offset:2304
    ds_read_b128 v[208:211], v14 offset:0
    ds_read_b128 v[212:215], v14 offset:2304
    v_mfma_f32_16x16x32_bf16 v[32:35], v[224:227], v[232:235], v[32:35]
    v_mfma_f32_16x16x32_bf16 v[36:39], v[228:231], v[232:235], v[36:39]
    s_waitcnt vmcnt(0) lgkmcnt(0)
    v_mfma_f32_16x16x32_bf16 v[40:43], v[224:227], v[236:239], v[40:43]
    v_mfma_f32_16x16x32_bf16 v[44:47], v[228:231], v[236:239], v[44:47]
    ds_write_b128 v9, v[112:115] offset:18432
    ds_write_b128 v9, v[116:119] offset:23040
    ds_write_b128 v9, v[120:123] offset:27648
    ds_write_b128 v9, v[124:127] offset:32256
    ds_read_b128 v[224:227], v12 offset:64
    ds_read_b128 v[228:231], v12 offset:2368
    ds_read_b128 v[232:235], v14 offset:64
    ds_read_b128 v[236:239], v14 offset:2368
    s_waitcnt lgkmcnt(8)
    v_mfma_f32_16x16x32_bf16 v[32:35], v[200:203], v[208:211], v[32:35]
    v_mfma_f32_16x16x32_bf16 v[36:39], v[204:207], v[208:211], v[36:39]
    v_mfma_f32_16x16x32_bf16 v[40:43], v[200:203], v[212:215], v[40:43]
    v_mfma_f32_16x16x32_bf16 v[44:47], v[204:207], v[212:215], v[44:47]
    s_waitcnt lgkmcnt(0)
    s_barrier
    ds_read_b128 v[200:203], v12 offset:18432
    ds_read_b128 v[204:207], v12 offset:20736
    ds_read_b128 v[208:211], v14 offset:18432
    ds_read_b128 v[212:215], v14 offset:20736
    v_mfma_f32_16x16x32_bf16 v[32:35], v[224:227], v[232:235], v[32:35]
    v_mfma_f32_16x16x32_bf16 v[36:39], v[228:231], v[232:235], v[36:39]
    v_mfma_f32_16x16x32_bf16 v[40:43], v[224:227], v[236:239], v[40:43]
    v_mfma_f32_16x16x32_bf16 v[44:47], v[228:231], v[236:239], v[44:47]
    ds_read_b128 v[224:227], v12 offset:18496
    ds_read_b128 v[228:231], v12 offset:20800
    ds_read_b128 v[232:235], v14 offset:18496
    ds_read_b128 v[236:239], v14 offset:20800
    s_waitcnt lgkmcnt(4)
    v_mfma_f32_16x16x32_bf16 v[32:35], v[200:203], v[208:211], v[32:35]
    v_mfma_f32_16x16x32_bf16 v[36:39], v[204:207], v[208:211], v[36:39]
    v_mfma_f32_16x16x32_bf16 v[40:43], v[200:203], v[212:215], v[40:43]
    v_mfma_f32_16x16x32_bf16 v[44:47], v[204:207], v[212:215], v[44:47]
    s_waitcnt lgkmcnt(0)
    v_mfma_f32_16x16x32_bf16 v[32:35], v[224:227], v[232:235], v[32:35]
    v_mfma_f32_16x16x32_bf16 v[36:39], v[228:231], v[232:235], v[36:39]
    v_mfma_f32_16x16x32_bf16 v[40:43], v[224:227], v[236:239], v[40:43]
    v_mfma_f32_16x16x32_bf16 v[44:47], v[228:231], v[236:239], v[44:47]
    s_nop 15
    s_nop 7
    s_waitcnt vmcnt(0)
    v_add_u32 v7, 0, v65
    v_cvt_pk_bf16_f32 v16, v32, v33
    v_lshlrev_b32 v17, 16, v16
    v_and_b32 v18, 0xffff0000, v16
    v_mul_f32 v17, v17, v82
    v_mul_f32 v18, v18, v83
    v_cvt_pk_bf16_f32 v16, v17, v18
    v_lshlrev_b32 v17, 16, v16
    v_and_b32 v18, 0xffff0000, v16
    v_lshlrev_b32 v19, 16, v66
    v_and_b32 v20, 0xffff0000, v66
    v_add_f32 v17, v17, v19
    v_add_f32 v18, v18, v20
    v_cvt_pk_bf16_f32 v66, v17, v18
    v_cvt_pk_bf16_f32 v16, v34, v35
    v_lshlrev_b32 v17, 16, v16
    v_and_b32 v18, 0xffff0000, v16
    v_mul_f32 v17, v17, v84
    v_mul_f32 v18, v18, v85
    v_cvt_pk_bf16_f32 v16, v17, v18
    v_lshlrev_b32 v17, 16, v16
    v_and_b32 v18, 0xffff0000, v16
    v_lshlrev_b32 v19, 16, v67
    v_and_b32 v20, 0xffff0000, v67
    v_add_f32 v17, v17, v19
    v_add_f32 v18, v18, v20
    v_cvt_pk_bf16_f32 v67, v17, v18
    buffer_store_dwordx2 v[66:67], v7, s[20:23], 0 offen offset:0
    v_cvt_pk_bf16_f32 v16, v36, v37
    v_lshlrev_b32 v17, 16, v16
    v_and_b32 v18, 0xffff0000, v16
    v_mul_f32 v17, v17, v86
    v_mul_f32 v18, v18, v87
    v_cvt_pk_bf16_f32 v16, v17, v18
    v_lshlrev_b32 v17, 16, v16
    v_and_b32 v18, 0xffff0000, v16
    v_lshlrev_b32 v19, 16, v68
    v_and_b32 v20, 0xffff0000, v68
    v_add_f32 v17, v17, v19
    v_add_f32 v18, v18, v20
    v_cvt_pk_bf16_f32 v68, v17, v18
    v_cvt_pk_bf16_f32 v16, v38, v39
    v_lshlrev_b32 v17, 16, v16
    v_and_b32 v18, 0xffff0000, v16
    v_mul_f32 v17, v17, v88
    v_mul_f32 v18, v18, v89
    v_cvt_pk_bf16_f32 v16, v17, v18
    v_lshlrev_b32 v17, 16, v16
    v_and_b32 v18, 0xffff0000, v16
    v_lshlrev_b32 v19, 16, v69
    v_and_b32 v20, 0xffff0000, v69
    v_add_f32 v17, v17, v19
    v_add_f32 v18, v18, v20
    v_cvt_pk_bf16_f32 v69, v17, v18
    buffer_store_dwordx2 v[68:69], v7, s[20:23], 0 offen offset:32
    v_add_u32 v7, 14336, v65
    v_cvt_pk_bf16_f32 v16, v40, v41
    v_lshlrev_b32 v17, 16, v16
    v_and_b32 v18, 0xffff0000, v16
    v_mul_f32 v17, v17, v82
    v_mul_f32 v18, v18, v83
    v_cvt_pk_bf16_f32 v16, v17, v18
    v_lshlrev_b32 v17, 16, v16
    v_and_b32 v18, 0xffff0000, v16
    v_lshlrev_b32 v19, 16, v70
    v_and_b32 v20, 0xffff0000, v70
    v_add_f32 v17, v17, v19
    v_add_f32 v18, v18, v20
    v_cvt_pk_bf16_f32 v70, v17, v18
    v_cvt_pk_bf16_f32 v16, v42, v43
    v_lshlrev_b32 v17, 16, v16
    v_and_b32 v18, 0xffff0000, v16
    v_mul_f32 v17, v17, v84
    v_mul_f32 v18, v18, v85
    v_cvt_pk_bf16_f32 v16, v17, v18
    v_lshlrev_b32 v17, 16, v16
    v_and_b32 v18, 0xffff0000, v16
    v_lshlrev_b32 v19, 16, v71
    v_and_b32 v20, 0xffff0000, v71
    v_add_f32 v17, v17, v19
    v_add_f32 v18, v18, v20
    v_cvt_pk_bf16_f32 v71, v17, v18
    buffer_store_dwordx2 v[70:71], v7, s[20:23], 0 offen offset:0
    v_cvt_pk_bf16_f32 v16, v44, v45
    v_lshlrev_b32 v17, 16, v16
    v_and_b32 v18, 0xffff0000, v16
    v_mul_f32 v17, v17, v86
    v_mul_f32 v18, v18, v87
    v_cvt_pk_bf16_f32 v16, v17, v18
    v_lshlrev_b32 v17, 16, v16
    v_and_b32 v18, 0xffff0000, v16
    v_lshlrev_b32 v19, 16, v72
    v_and_b32 v20, 0xffff0000, v72
    v_add_f32 v17, v17, v19
    v_add_f32 v18, v18, v20
    v_cvt_pk_bf16_f32 v72, v17, v18
    v_cvt_pk_bf16_f32 v16, v46, v47
    v_lshlrev_b32 v17, 16, v16
    v_and_b32 v18, 0xffff0000, v16
    v_mul_f32 v17, v17, v88
    v_mul_f32 v18, v18, v89
    v_cvt_pk_bf16_f32 v16, v17, v18
    v_lshlrev_b32 v17, 16, v16
    v_and_b32 v18, 0xffff0000, v16
    v_lshlrev_b32 v19, 16, v73
    v_and_b32 v20, 0xffff0000, v73
    v_add_f32 v17, v17, v19
    v_add_f32 v18, v18, v20
    v_cvt_pk_bf16_f32 v73, v17, v18
    buffer_store_dwordx2 v[72:73], v7, s[20:23], 0 offen offset:32
K4_END:
    s_endpgm
.section .rodata,"a"
.p2align 6
.amdhsa_kernel k1_conv_kernel
  .amdhsa_next_free_vgpr 128
  .amdhsa_next_free_sgpr 102
  .amdhsa_accum_offset 128
  .amdhsa_group_segment_fixed_size 0
  .amdhsa_kernarg_size 128
  .amdhsa_user_sgpr_count 2
  .amdhsa_user_sgpr_kernarg_segment_ptr 1
  .amdhsa_system_sgpr_workgroup_id_x 1
.end_amdhsa_kernel
.p2align 6
.amdhsa_kernel k2_gemm1_kernel
  .amdhsa_next_free_vgpr 256
  .amdhsa_next_free_sgpr 102
  .amdhsa_accum_offset 256
  .amdhsa_group_segment_fixed_size 0
  .amdhsa_kernarg_size 128
  .amdhsa_user_sgpr_count 2
  .amdhsa_user_sgpr_kernarg_segment_ptr 1
  .amdhsa_system_sgpr_workgroup_id_x 1
.end_amdhsa_kernel
.p2align 6
.amdhsa_kernel k3_gemm2_kernel
  .amdhsa_next_free_vgpr 256
  .amdhsa_next_free_sgpr 102
  .amdhsa_accum_offset 256
  .amdhsa_group_segment_fixed_size 0
  .amdhsa_kernarg_size 128
  .amdhsa_user_sgpr_count 2
  .amdhsa_user_sgpr_kernarg_segment_ptr 1
  .amdhsa_system_sgpr_workgroup_id_x 1
.end_amdhsa_kernel
.p2align 6
.amdhsa_kernel k4_gemm3_kernel
  .amdhsa_next_free_vgpr 256
  .amdhsa_next_free_sgpr 102
  .amdhsa_accum_offset 256
  .amdhsa_group_segment_fixed_size 0
  .amdhsa_kernarg_size 128
  .amdhsa_user_sgpr_count 2
  .amdhsa_user_sgpr_kernarg_segment_ptr 1
  .amdhsa_system_sgpr_workgroup_id_x 1
.end_amdhsa_kernel
```
